```python
import torch

def _softmax(x, axis=-1):
    return torch.softmax(x, dim=axis)
def _gelu(x):
    return torch.nn.functional.gelu(x, approximate="tanh")
def _silu(x):
    return torch.nn.functional.silu(x)
def _sigmoid(x):
    return torch.sigmoid(x)
def _layernorm(x, axis=-1, eps=1e-5):
    m = x.mean(dim=axis, keepdim=True)
    v = x.var(dim=axis, keepdim=True, unbiased=False)
    return (x - m) / torch.sqrt(v + eps)
def _scatter_add(tgt, idx, src, axis=0):
    return tgt.clone().index_add_(axis, idx, src)
def _segment_sum(src, seg, n):
    out = torch.zeros((n,) + src.shape[1:], dtype=src.dtype)
    return out.index_add_(0, seg, src)
def _pad(x, pw):
    flat = tuple(v for pair in reversed(pw) for v in pair)
    return torch.nn.functional.pad(x, flat)

kernel_name = 'parallel_sum__softmax_full_mha__swiglu_ffn__prompt'

def setup_inputs():

    _w = (lambda a: (lambda t: t.to(torch.bfloat16) if t.is_floating_point() else t)(torch.as_tensor(a)))
    def _A_setup():
        B, S, D = 1, 2048, 448
        return {
            "x": _w((lambda *s: torch.randn(*s, dtype=torch.bfloat16) * 0.05)(B, S, D)),
            "wqkv": _w((lambda *s: torch.randn(*s, dtype=torch.bfloat16) * 0.2)(D, 3 * D)),
            "wo": _w((lambda *s: torch.randn(*s, dtype=torch.bfloat16) * 0.1)(D, D)),
        }
    _A_in = _A_setup()

    def _B_setup():
        B, S, D, F = 1, 2048, 448, 1792
        return {
            "x": _w((lambda *s: torch.randn(*s, dtype=torch.bfloat16) * 0.05)(B, S, D)),
            "w_gate": _w((lambda *s: torch.randn(*s, dtype=torch.bfloat16) * 0.1)(D, F)),
            "w_up": _w((lambda *s: torch.randn(*s, dtype=torch.bfloat16) * 0.1)(D, F)),
            "w_down": _w((lambda *s: torch.randn(*s, dtype=torch.bfloat16) * 0.1)(F, D)),
        }
    _B_in = _B_setup()

    return {
        "A_x": _A_in["x"],
        "A_wqkv": _A_in["wqkv"],
        "A_wo": _A_in["wo"],
        "B_x": _B_in["x"],
        "B_w_gate": _B_in["w_gate"],
        "B_w_up": _B_in["w_up"],
        "B_w_down": _B_in["w_down"],
    }

def reference(A_x, A_wqkv, A_wo, B_x, B_w_gate, B_w_up, B_w_down):
    def _A_ref(x, wqkv, wo):
        B, S, D = x.shape
        H = 16; Dh = D // H
        qkv = (lambda x, *d: x.permute(*d))((x @ wqkv).reshape(B, S, 3, H, Dh), 2, 0, 3, 1, 4)
        q, k, v = qkv[0], qkv[1], qkv[2]
        scale = Dh ** -0.5
        scores = torch.einsum("bhqd,bhkd->bhqk", q, k) * scale
        p = _softmax(scores, axis=-1)
        o = torch.einsum("bhqk,bhkd->bhqd", p, v)
        return (lambda x, *d: x.permute(*d))(o, 0, 2, 1, 3).reshape(B, S, D) @ wo

    def _B_ref(x, w_gate, w_up, w_down):
        g = _silu(x @ w_gate)
        u = x @ w_up
        return (g * u) @ w_down

    x = A_x
    xn = _layernorm(x, axis=-1)
    return x + _A_ref(xn, A_wqkv, A_wo) + _B_ref(xn, B_w_gate, B_w_up, B_w_down)
```

```asm
; @launch grid=(256,1,1) block=(512,1,1) lds=156672
.amdgcn_target "amdgcn-amd-amdhsa--gfx950"
.text
.globl parallel_sum__softmax_full_mha__swiglu_ffn__prompt_kernel
.p2align 8
.type parallel_sum__softmax_full_mha__swiglu_ffn__prompt_kernel,@function
parallel_sum__softmax_full_mha__swiglu_ffn__prompt_kernel:
    s_cmp_ge_u32 s2, 256
    s_cbranch_scc1 parallel_sum__softmax_full_mha__swiglu_ffn__prompt_kernel_done
    s_load_dwordx2 s[56:57], s[0:1], 0
    s_load_dwordx2 s[58:59], s[0:1], 8
    s_load_dwordx4 s[60:63], s[0:1], 32
    s_load_dwordx2 s[70:71], s[0:1], 72
    s_load_dwordx2 s[72:73], s[0:1], 64
    s_load_dwordx2 s[66:67], s[0:1], 16
    s_load_dwordx2 s[64:65], s[0:1], 48
    v_and_b32 v1, 63, v0
    v_lshrrev_b32 v9, 6, v0
    v_lshlrev_b32 v2, 4, v1
    v_readfirstlane_b32 s3, v9
    s_and_b32 s35, s2, 7
    s_lshr_b32 s36, s2, 3
    s_and_b32 s24, s35, 1
    s_lshl_b32 s24, s24, 3
    s_and_b32 s37, s36, 7
    s_add_u32 s24, s24, s37
    s_lshr_b32 s25, s35, 1
    s_lshl_b32 s25, s25, 2
    s_lshr_b32 s37, s36, 4
    s_add_u32 s25, s25, s37
    s_bfe_u32 s37, s36, 0x10003
    s_lshl_b32 s37, s37, 1
    s_add_u32 s25, s25, s37
    v_lshrrev_b32 v9, 2, v1
    v_and_b32 v10, 3, v1
    v_bfe_u32 v11, v1, 4, 2
    v_xor_b32 v11, v11, v10
    s_lshl_b32 s35, s24, 7
    s_lshl_b32 s36, s3, 4
    s_add_u32 s35, s35, s36
    v_add_u32 v12, s35, v9
    v_mul_u32_u24 v12, 896, v12
    v_lshl_add_u32 v6, v11, 4, v12
    s_lshl_b32 s37, s3, 10
    s_waitcnt lgkmcnt(0)
    s_mov_b32 s4, s56
    s_and_b32 s5, s57, 0xffff
    s_mov_b32 s6, 1835008
    s_mov_b32 s7, 0x20000
    v_mov_b32 v158, 0
    v_mov_b32 v159, 0
    s_add_u32 m0, s37, 0
    s_movk_i32 s35, 0
    buffer_load_dwordx4 v6, s[4:7], s35 offen lds
    s_add_u32 m0, s37, 8192
    s_movk_i32 s35, 64
    buffer_load_dwordx4 v6, s[4:7], s35 offen lds
    s_add_u32 m0, s37, 16384
    s_movk_i32 s35, 128
    buffer_load_dwordx4 v6, s[4:7], s35 offen lds
    s_add_u32 m0, s37, 24576
    s_movk_i32 s35, 192
    buffer_load_dwordx4 v6, s[4:7], s35 offen lds
    s_add_u32 m0, s37, 32768
    s_movk_i32 s35, 256
    buffer_load_dwordx4 v6, s[4:7], s35 offen lds
    s_add_u32 m0, s37, 40960
    s_movk_i32 s35, 320
    buffer_load_dwordx4 v6, s[4:7], s35 offen lds
    s_add_u32 m0, s37, 49152
    s_movk_i32 s35, 384
    buffer_load_dwordx4 v6, s[4:7], s35 offen lds
    s_add_u32 m0, s37, 57344
    s_movk_i32 s35, 448
    buffer_load_dwordx4 v6, s[4:7], s35 offen lds
    s_add_u32 m0, s37, 65536
    s_movk_i32 s35, 512
    buffer_load_dwordx4 v6, s[4:7], s35 offen lds
    s_add_u32 m0, s37, 73728
    s_movk_i32 s35, 576
    buffer_load_dwordx4 v6, s[4:7], s35 offen lds
    s_add_u32 m0, s37, 81920
    s_movk_i32 s35, 640
    buffer_load_dwordx4 v6, s[4:7], s35 offen lds
    s_add_u32 m0, s37, 90112
    s_movk_i32 s35, 704
    buffer_load_dwordx4 v6, s[4:7], s35 offen lds
    s_add_u32 m0, s37, 98304
    s_movk_i32 s35, 768
    buffer_load_dwordx4 v6, s[4:7], s35 offen lds
    s_add_u32 m0, s37, 106496
    s_movk_i32 s35, 832
    buffer_load_dwordx4 v6, s[4:7], s35 offen lds
    s_or_b32 s35, s2, s3
    s_cmp_lg_u32 s35, 0
    s_cbranch_scc1 parallel_sum__softmax_full_mha__swiglu_ffn__prompt_kernel_notag
    s_memrealtime s[52:53]
    s_mov_b32 s12, s72
    s_and_b32 s13, s73, 0xffff
    s_mov_b32 s14, 256
    s_mov_b32 s15, 0x20000
    s_waitcnt lgkmcnt(0)
    s_lshl_b32 s35, s52, 2
    s_or_b32 s35, s35, 0x80000000
    v_mov_b32 v12, s35
    v_mov_b32 v13, 0
    s_mov_b64 exec, 1
    buffer_store_dword v12, v13, s[12:15], 0 offen sc0 sc1
    s_mov_b64 exec, -1
parallel_sum__softmax_full_mha__swiglu_ffn__prompt_kernel_notag:
    v_and_b32 v12, 15, v1
    v_lshlrev_b32 v12, 2, v12
    v_add_u32 v12, 155648, v12
    ds_write_b32 v12, v158
    s_mov_b32 s20, s70
    s_and_b32 s21, s71, 0xffff
    s_mov_b32 s22, 33554432
    s_mov_b32 s23, 0x20000
    s_mov_b32 s16, s58
    s_and_b32 s17, s59, 0xffff
    s_mov_b32 s18, 1204224
    s_mov_b32 s19, 0x20000
    v_add_u32 v7, s37, v2
    s_and_b32 s27, s3, 1
    s_bfe_u32 s28, s3, 0x10001
    s_lshr_b32 s48, s3, 2
    s_lshr_b32 s49, s25, 1
    s_and_b32 s38, s25, 1
    s_xor_b32 s38, s38, 1
    s_cmp_eq_u32 s27, 0
    s_cselect_b32 s8, s60, s62
    s_cselect_b32 s9, s61, s63
    s_and_b32 s9, s9, 0xffff
    s_mov_b32 s10, 1605632
    s_mov_b32 s11, 0x20000
    s_lshl_b32 s35, s49, 1
    s_add_u32 s35, s35, s28
    s_mul_i32 s36, s49, 112
    s_cmp_eq_u32 s48, 0
    s_cselect_b32 s37, 1792, 0
    s_cselect_b32 s39, 32, 0
    s_cmp_eq_u32 s38, 1
    s_cselect_b32 s37, s37, 896
    s_cselect_b32 s39, s39, 16
    s_add_u32 s36, s36, s37
    s_add_u32 s39, s39, s35
    v_lshrrev_b32 v11, 3, v1
    s_lshl_b32 s37, s28, 3
    v_add_u32 v11, s37, v11
    v_mul_u32_u24 v11, 2688, v11
    v_and_b32 v12, 7, v1
    v_bfe_u32 v13, v1, 4, 1
    v_lshlrev_b32 v13, 2, v13
    v_xor_b32 v12, v12, v13
    v_lshl_add_u32 v11, v12, 4, v11
    v_add_u32 v152, s36, v11
    s_lshl_b32 s35, s48, 1
    s_add_u32 s35, s35, s28
    s_lshl_b32 s36, s27, 2
    s_add_u32 s36, s36, s35
    s_lshl_b32 s37, s27, 1
    s_add_u32 s37, s37, s48
    s_lshl_b32 s32, s37, 1
    s_add_u32 s32, s32, s28
    s_cmp_eq_u32 s38, 1
    s_cselect_b32 s32, s36, s32
    s_cselect_b32 s37, s27, s37
    s_cselect_b32 s35, s35, s28
    s_lshl_b32 s32, s32, 10
    s_add_u32 s32, s32, 114688
    s_mul_i32 s30, s37, 43008
    v_lshrrev_b32 v11, 5, v1
    v_lshlrev_b32 v11, 9, v11
    v_bfe_u32 v12, v1, 2, 2
    v_lshl_add_u32 v11, v12, 6, v11
    v_bfe_u32 v12, v1, 4, 1
    v_lshl_add_u32 v11, v12, 5, v11
    v_lshl_add_u32 v11, v10, 3, v11
    s_lshl_b32 s35, s28, 11
    s_mul_i32 s37, s28, 56
    s_cmp_eq_u32 s38, 1
    s_cselect_b32 s35, s35, 0
    s_cselect_b32 s37, 0, s37
    s_add_u32 s35, s35, 114688
    v_bfe_u32 v12, v1, 4, 1
    v_lshlrev_b32 v12, 5, v12
    v_lshl_add_u32 v12, v10, 3, v12
    v_add_u32 v12, s37, v12
    v_lshrrev_b32 v13, 4, v12
    v_bfe_u32 v154, v1, 3, 1
    v_lshlrev_b32 v154, 2, v154
    v_xor_b32 v13, v13, v154
    v_and_b32 v12, 15, v12
    v_lshl_add_u32 v12, v13, 4, v12
    v_bfe_u32 v13, v1, 2, 2
    v_lshl_add_u32 v12, v13, 7, v12
    v_lshrrev_b32 v13, 5, v1
    v_lshl_add_u32 v12, v13, 10, v12
    v_add_u32 v154, s35, v12
    s_movk_i32 s37, 56
    v_bfe_u32 v12, v1, 4, 1
    v_lshlrev_b32 v12, 5, v12
    v_lshl_add_u32 v12, v10, 3, v12
    v_add_u32 v12, s37, v12
    v_lshrrev_b32 v13, 4, v12
    v_bfe_u32 v163, v1, 3, 1
    v_lshlrev_b32 v163, 2, v163
    v_xor_b32 v13, v13, v163
    v_and_b32 v12, 15, v12
    v_lshl_add_u32 v12, v13, 4, v12
    v_bfe_u32 v13, v1, 2, 2
    v_lshl_add_u32 v12, v13, 7, v12
    v_lshrrev_b32 v13, 5, v1
    v_lshl_add_u32 v12, v13, 10, v12
    v_add_u32 v163, s35, v12
    s_mul_i32 s35, s49, 3
    s_lshl_b32 s36, s28, 1
    s_cmp_eq_u32 s48, 0
    s_cselect_b32 s37, s36, 1
    s_add_u32 s35, s35, s37
    s_add_u32 s36, s36, s48
    s_lshl_b32 s45, s49, 2
    s_add_u32 s45, s45, 24
    s_add_u32 s45, s45, s36
    s_cmp_eq_u32 s38, 1
    s_cselect_b32 s45, s35, s45
    s_cselect_b32 s37, s37, s36
    s_lshl_b32 s35, s45, 6
    v_mul_u32_u24 v12, 3584, v9
    v_lshl_add_u32 v12, v10, 4, v12
    v_add_u32 v153, s35, v12
    s_lshl_b32 s37, s37, 11
    s_add_u32 s37, s37, 114688
    v_add_u32 v5, s37, v11
    s_lshl_b32 s33, s27, 10
    s_add_u32 s33, s33, s37
    s_lshl_b32 s45, s45, 1
    s_mov_b32 s31, 0
    s_and_b32 s26, s38, s48
    s_and_b32 s26, s26, s28
    s_mov_b32 s46, 0
    s_mov_b32 s47, -1
    v_and_b32 v11, 31, v1
    v_lshrrev_b32 v12, 5, v1
    v_bfe_u32 v13, v1, 2, 2
    v_xor_b32 v12, v12, v13
    v_lshlrev_b32 v12, 4, v12
    v_lshl_add_u32 v11, v11, 6, v12
    s_lshl_b32 s35, s27, 12
    v_add_u32 v3, s35, v11
    v_xor_b32 v4, 32, v3
    s_lshl_b32 s35, s48, 11
    v_add_u32 v155, s35, v3
    v_xor_b32 v157, 32, v155
    v_lshrrev_b32 v11, 4, v1
    v_lshlrev_b32 v11, 4, v11
    v_bfe_u32 v12, v1, 3, 1
    v_add_u32 v11, v11, v12
    v_and_b32 v12, 7, v1
    v_lshlrev_b32 v12, 4, v12
    v_mul_u32_u24 v160, 3584, v11
    v_add_u32 v160, v160, v12
    v_mul_u32_u24 v161, 2688, v11
    v_add_u32 v161, v161, v12
    s_lshl_b32 s43, s24, 2
    s_lshl_b32 s35, s27, 1
    s_add_u32 s43, s43, s35
    s_add_u32 s44, s43, 1
    v_mov_b32 v13, 0x3f803f80
    v_mov_b32 v9, 0
    v_mov_b32 v10, 0
    v_mov_b32 v11, 0
    v_mov_b32 v12, 0
    v_add_u32 v6, 0x10000, v7
    s_cmp_eq_u32 s38, 1
    s_mov_b32 s51, 172032
    s_cselect_b32 s51, 86016, s51
    s_waitcnt vmcnt(13)
    ds_read_b128 v[16:19], v7 offset:0
    s_waitcnt vmcnt(12)
    ds_read_b128 v[20:23], v7 offset:8192
    s_waitcnt lgkmcnt(1)
    v_dot2c_f32_bf16 v9, v16, v13
    v_dot2c_f32_bf16 v11, v16, v16
    v_dot2c_f32_bf16 v10, v17, v13
    v_dot2c_f32_bf16 v12, v17, v17
    v_dot2c_f32_bf16 v9, v18, v13
    v_dot2c_f32_bf16 v11, v18, v18
    v_dot2c_f32_bf16 v10, v19, v13
    v_dot2c_f32_bf16 v12, v19, v19
    s_waitcnt vmcnt(11)
    ds_read_b128 v[16:19], v7 offset:16384
    s_waitcnt lgkmcnt(1)
    v_dot2c_f32_bf16 v9, v20, v13
    v_dot2c_f32_bf16 v11, v20, v20
    v_dot2c_f32_bf16 v10, v21, v13
    v_dot2c_f32_bf16 v12, v21, v21
    v_dot2c_f32_bf16 v9, v22, v13
    v_dot2c_f32_bf16 v11, v22, v22
    v_dot2c_f32_bf16 v10, v23, v13
    v_dot2c_f32_bf16 v12, v23, v23
    s_waitcnt vmcnt(10)
    ds_read_b128 v[20:23], v7 offset:24576
    s_waitcnt lgkmcnt(1)
    v_dot2c_f32_bf16 v9, v16, v13
    v_dot2c_f32_bf16 v11, v16, v16
    v_dot2c_f32_bf16 v10, v17, v13
    v_dot2c_f32_bf16 v12, v17, v17
    v_dot2c_f32_bf16 v9, v18, v13
    v_dot2c_f32_bf16 v11, v18, v18
    v_dot2c_f32_bf16 v10, v19, v13
    v_dot2c_f32_bf16 v12, v19, v19
    s_waitcnt vmcnt(9)
    ds_read_b128 v[16:19], v7 offset:32768
    s_waitcnt lgkmcnt(1)
    v_dot2c_f32_bf16 v9, v20, v13
    v_dot2c_f32_bf16 v11, v20, v20
    v_dot2c_f32_bf16 v10, v21, v13
    v_dot2c_f32_bf16 v12, v21, v21
    v_dot2c_f32_bf16 v9, v22, v13
    v_dot2c_f32_bf16 v11, v22, v22
    v_dot2c_f32_bf16 v10, v23, v13
    v_dot2c_f32_bf16 v12, v23, v23
    s_waitcnt vmcnt(8)
    ds_read_b128 v[20:23], v7 offset:40960
    s_waitcnt lgkmcnt(1)
    v_dot2c_f32_bf16 v9, v16, v13
    v_dot2c_f32_bf16 v11, v16, v16
    v_dot2c_f32_bf16 v10, v17, v13
    v_dot2c_f32_bf16 v12, v17, v17
    v_dot2c_f32_bf16 v9, v18, v13
    v_dot2c_f32_bf16 v11, v18, v18
    v_dot2c_f32_bf16 v10, v19, v13
    v_dot2c_f32_bf16 v12, v19, v19
    s_waitcnt vmcnt(7)
    ds_read_b128 v[16:19], v7 offset:49152
    s_waitcnt lgkmcnt(1)
    v_dot2c_f32_bf16 v9, v20, v13
    v_dot2c_f32_bf16 v11, v20, v20
    v_dot2c_f32_bf16 v10, v21, v13
    v_dot2c_f32_bf16 v12, v21, v21
    v_dot2c_f32_bf16 v9, v22, v13
    v_dot2c_f32_bf16 v11, v22, v22
    v_dot2c_f32_bf16 v10, v23, v13
    v_dot2c_f32_bf16 v12, v23, v23
    s_waitcnt vmcnt(6)
    ds_read_b128 v[20:23], v7 offset:57344
    s_waitcnt lgkmcnt(1)
    v_dot2c_f32_bf16 v9, v16, v13
    v_dot2c_f32_bf16 v11, v16, v16
    v_dot2c_f32_bf16 v10, v17, v13
    v_dot2c_f32_bf16 v12, v17, v17
    v_dot2c_f32_bf16 v9, v18, v13
    v_dot2c_f32_bf16 v11, v18, v18
    v_dot2c_f32_bf16 v10, v19, v13
    v_dot2c_f32_bf16 v12, v19, v19
    s_waitcnt vmcnt(5)
    ds_read_b128 v[16:19], v6 offset:0
    s_waitcnt lgkmcnt(1)
    v_dot2c_f32_bf16 v9, v20, v13
    v_dot2c_f32_bf16 v11, v20, v20
    v_dot2c_f32_bf16 v10, v21, v13
    v_dot2c_f32_bf16 v12, v21, v21
    v_dot2c_f32_bf16 v9, v22, v13
    v_dot2c_f32_bf16 v11, v22, v22
    v_dot2c_f32_bf16 v10, v23, v13
    v_dot2c_f32_bf16 v12, v23, v23
    s_waitcnt vmcnt(4)
    ds_read_b128 v[20:23], v6 offset:8192
    s_waitcnt lgkmcnt(1)
    v_dot2c_f32_bf16 v9, v16, v13
    v_dot2c_f32_bf16 v11, v16, v16
    v_dot2c_f32_bf16 v10, v17, v13
    v_dot2c_f32_bf16 v12, v17, v17
    v_dot2c_f32_bf16 v9, v18, v13
    v_dot2c_f32_bf16 v11, v18, v18
    v_dot2c_f32_bf16 v10, v19, v13
    v_dot2c_f32_bf16 v12, v19, v19
    s_waitcnt vmcnt(3)
    ds_read_b128 v[16:19], v6 offset:16384
    s_waitcnt lgkmcnt(1)
    v_dot2c_f32_bf16 v9, v20, v13
    v_dot2c_f32_bf16 v11, v20, v20
    v_dot2c_f32_bf16 v10, v21, v13
    v_dot2c_f32_bf16 v12, v21, v21
    v_dot2c_f32_bf16 v9, v22, v13
    v_dot2c_f32_bf16 v11, v22, v22
    v_dot2c_f32_bf16 v10, v23, v13
    v_dot2c_f32_bf16 v12, v23, v23
    s_waitcnt vmcnt(2)
    ds_read_b128 v[20:23], v6 offset:24576
    s_waitcnt lgkmcnt(1)
    v_dot2c_f32_bf16 v9, v16, v13
    v_dot2c_f32_bf16 v11, v16, v16
    v_dot2c_f32_bf16 v10, v17, v13
    v_dot2c_f32_bf16 v12, v17, v17
    v_dot2c_f32_bf16 v9, v18, v13
    v_dot2c_f32_bf16 v11, v18, v18
    v_dot2c_f32_bf16 v10, v19, v13
    v_dot2c_f32_bf16 v12, v19, v19
    s_waitcnt vmcnt(1)
    ds_read_b128 v[16:19], v6 offset:32768
    s_waitcnt lgkmcnt(1)
    v_dot2c_f32_bf16 v9, v20, v13
    v_dot2c_f32_bf16 v11, v20, v20
    v_dot2c_f32_bf16 v10, v21, v13
    v_dot2c_f32_bf16 v12, v21, v21
    v_dot2c_f32_bf16 v9, v22, v13
    v_dot2c_f32_bf16 v11, v22, v22
    v_dot2c_f32_bf16 v10, v23, v13
    v_dot2c_f32_bf16 v12, v23, v23
    s_waitcnt vmcnt(0)
    ds_read_b128 v[20:23], v6 offset:40960
    s_waitcnt lgkmcnt(1)
    v_dot2c_f32_bf16 v9, v16, v13
    v_dot2c_f32_bf16 v11, v16, v16
    v_dot2c_f32_bf16 v10, v17, v13
    v_dot2c_f32_bf16 v12, v17, v17
    v_dot2c_f32_bf16 v9, v18, v13
    v_dot2c_f32_bf16 v11, v18, v18
    v_dot2c_f32_bf16 v10, v19, v13
    v_dot2c_f32_bf16 v12, v19, v19
    s_waitcnt lgkmcnt(0)
    v_dot2c_f32_bf16 v9, v20, v13
    v_dot2c_f32_bf16 v11, v20, v20
    v_dot2c_f32_bf16 v10, v21, v13
    v_dot2c_f32_bf16 v12, v21, v21
    v_dot2c_f32_bf16 v9, v22, v13
    v_dot2c_f32_bf16 v11, v22, v22
    v_dot2c_f32_bf16 v10, v23, v13
    v_dot2c_f32_bf16 v12, v23, v23
    ds_read_b128 v[24:27], v7
    s_nop 0
    v_add_f32 v9, v9, v10
    v_add_f32 v11, v11, v12
    s_nop 1
    v_add_f32_dpp v9, v9, v9 quad_perm:[1,0,3,2] row_mask:0xf bank_mask:0xf
    v_add_f32_dpp v11, v11, v11 quad_perm:[1,0,3,2] row_mask:0xf bank_mask:0xf
    s_nop 1
    v_add_f32_dpp v9, v9, v9 quad_perm:[2,3,0,1] row_mask:0xf bank_mask:0xf
    v_add_f32_dpp v11, v11, v11 quad_perm:[2,3,0,1] row_mask:0xf bank_mask:0xf
    v_mul_f32 v9, 0x3b124925, v9
    v_mul_f32 v11, 0x3b124925, v11
    v_fma_f32 v11, -v9, v9, v11
    v_max_f32 v11, 0, v11
    v_add_f32 v11, 0x3727c5ac, v11
    v_rsq_f32 v14, v11
    s_nop 0
    v_mul_f32 v9, v9, v14
    v_sub_f32 v15, 0, v9
    s_mov_b32 s34, 6
parallel_sum__softmax_full_mha__swiglu_ffn__prompt_kernel_ln_1:
    ds_read_b128 v[28:31], v7 offset:8192
    s_waitcnt lgkmcnt(1)
    v_lshlrev_b32 v32, 16, v24
    v_and_b32 v33, 0xffff0000, v24
    v_lshlrev_b32 v34, 16, v25
    v_and_b32 v35, 0xffff0000, v25
    v_lshlrev_b32 v36, 16, v26
    v_and_b32 v37, 0xffff0000, v26
    v_lshlrev_b32 v38, 16, v27
    v_and_b32 v39, 0xffff0000, v27
    v_fma_f32 v32, v32, v14, v15
    v_fma_f32 v33, v33, v14, v15
    v_fma_f32 v34, v34, v14, v15
    v_fma_f32 v35, v35, v14, v15
    v_fma_f32 v36, v36, v14, v15
    v_fma_f32 v37, v37, v14, v15
    v_fma_f32 v38, v38, v14, v15
    v_fma_f32 v39, v39, v14, v15
    v_cvt_pk_bf16_f32 v24, v32, v33
    v_cvt_pk_bf16_f32 v25, v34, v35
    v_cvt_pk_bf16_f32 v26, v36, v37
    v_cvt_pk_bf16_f32 v27, v38, v39
    ds_write_b128 v7, v[24:27]
    ds_read_b128 v[24:27], v7 offset:16384
    s_waitcnt lgkmcnt(2)
    v_lshlrev_b32 v32, 16, v28
    v_and_b32 v33, 0xffff0000, v28
    v_lshlrev_b32 v34, 16, v29
    v_and_b32 v35, 0xffff0000, v29
    v_lshlrev_b32 v36, 16, v30
    v_and_b32 v37, 0xffff0000, v30
    v_lshlrev_b32 v38, 16, v31
    v_and_b32 v39, 0xffff0000, v31
    v_fma_f32 v32, v32, v14, v15
    v_fma_f32 v33, v33, v14, v15
    v_fma_f32 v34, v34, v14, v15
    v_fma_f32 v35, v35, v14, v15
    v_fma_f32 v36, v36, v14, v15
    v_fma_f32 v37, v37, v14, v15
    v_fma_f32 v38, v38, v14, v15
    v_fma_f32 v39, v39, v14, v15
    v_cvt_pk_bf16_f32 v28, v32, v33
    v_cvt_pk_bf16_f32 v29, v34, v35
    v_cvt_pk_bf16_f32 v30, v36, v37
    v_cvt_pk_bf16_f32 v31, v38, v39
    ds_write_b128 v7, v[28:31] offset:8192
    v_add_u32 v7, 16384, v7
    s_sub_u32 s34, s34, 1
    s_cmp_lg_u32 s34, 0
    s_cbranch_scc1 parallel_sum__softmax_full_mha__swiglu_ffn__prompt_kernel_ln_1
    ds_read_b128 v[28:31], v7 offset:8192
    s_waitcnt lgkmcnt(1)
    v_lshlrev_b32 v32, 16, v24
    v_and_b32 v33, 0xffff0000, v24
    v_lshlrev_b32 v34, 16, v25
    v_and_b32 v35, 0xffff0000, v25
    v_lshlrev_b32 v36, 16, v26
    v_and_b32 v37, 0xffff0000, v26
    v_lshlrev_b32 v38, 16, v27
    v_and_b32 v39, 0xffff0000, v27
    v_fma_f32 v32, v32, v14, v15
    v_fma_f32 v33, v33, v14, v15
    v_fma_f32 v34, v34, v14, v15
    v_fma_f32 v35, v35, v14, v15
    v_fma_f32 v36, v36, v14, v15
    v_fma_f32 v37, v37, v14, v15
    v_fma_f32 v38, v38, v14, v15
    v_fma_f32 v39, v39, v14, v15
    v_cvt_pk_bf16_f32 v24, v32, v33
    v_cvt_pk_bf16_f32 v25, v34, v35
    v_cvt_pk_bf16_f32 v26, v36, v37
    v_cvt_pk_bf16_f32 v27, v38, v39
    ds_write_b128 v7, v[24:27]
    s_waitcnt lgkmcnt(1)
    v_lshlrev_b32 v32, 16, v28
    v_and_b32 v33, 0xffff0000, v28
    v_lshlrev_b32 v34, 16, v29
    v_and_b32 v35, 0xffff0000, v29
    v_lshlrev_b32 v36, 16, v30
    v_and_b32 v37, 0xffff0000, v30
    v_lshlrev_b32 v38, 16, v31
    v_and_b32 v39, 0xffff0000, v31
    v_fma_f32 v32, v32, v14, v15
    v_fma_f32 v33, v33, v14, v15
    v_fma_f32 v34, v34, v14, v15
    v_fma_f32 v35, v35, v14, v15
    v_fma_f32 v36, v36, v14, v15
    v_fma_f32 v37, v37, v14, v15
    v_fma_f32 v38, v38, v14, v15
    v_fma_f32 v39, v39, v14, v15
    v_cvt_pk_bf16_f32 v28, v32, v33
    v_cvt_pk_bf16_f32 v29, v34, v35
    v_cvt_pk_bf16_f32 v30, v36, v37
    v_cvt_pk_bf16_f32 v31, v38, v39
    ds_write_b128 v7, v[28:31] offset:8192
    s_cmp_ge_u32 s3, 4
    s_cbranch_scc1 parallel_sum__softmax_full_mha__swiglu_ffn__prompt_kernel_qskip_2
    s_cmp_eq_u32 s38, 1
    s_mov_b32 s42, 43008
    s_cselect_b32 s42, 4294965504, s42
    v_add_u32 v162, s42, v152
    s_add_u32 m0, s32, 0
    s_nop 0
    buffer_load_dwordx4 v152, s[16:19], s30 offen lds
    s_add_u32 m0, s32, 2048
    s_nop 0
    buffer_load_dwordx4 v162, s[16:19], s30 offen lds
    s_add_u32 s30, s30, s51
    s_add_u32 m0, s32, 8192
    s_nop 0
    buffer_load_dwordx4 v152, s[16:19], s30 offen lds
    s_add_u32 m0, s32, 10240
    s_nop 0
    buffer_load_dwordx4 v162, s[16:19], s30 offen lds
    s_add_u32 s30, s30, s51
    s_add_u32 m0, s32, 16384
    s_nop 0
    buffer_load_dwordx4 v152, s[16:19], s30 offen lds
    s_add_u32 m0, s32, 18432
    s_nop 0
    buffer_load_dwordx4 v162, s[16:19], s30 offen lds
    s_add_u32 s30, s30, s51
    s_add_u32 m0, s32, 24576
    s_nop 0
    buffer_load_dwordx4 v152, s[16:19], s30 offen lds
    s_add_u32 m0, s32, 26624
    s_nop 0
    buffer_load_dwordx4 v162, s[16:19], s30 offen lds
    s_add_u32 s30, s30, s51
    s_and_b32 s35, s24, 7
    s_lshl_b32 s35, s35, 1
    s_mul_i32 s36, s49, 112
    s_cmp_eq_u32 s27, 0
    s_cselect_b32 s37, 1792, 0
    s_cmp_eq_u32 s38, 1
    s_cselect_b32 s37, s37, 896
    s_add_u32 s36, s36, s37
    s_lshl_b32 s37, s28, 6
    s_add_u32 s37, s37, s35
    s_mul_i32 s37, s37, 2688
    s_add_u32 s40, s37, s36
    s_mul_i32 s36, s49, 192
    s_lshl_b32 s37, s49, 8
    s_add_u32 s37, s37, 1536
    s_cmp_eq_u32 s38, 1
    s_cselect_b32 s36, s36, s37
    s_lshl_b32 s37, s28, 7
    s_add_u32 s36, s36, s37
    s_mul_i32 s37, s35, 3584
    s_add_u32 s41, s36, s37
    buffer_load_dwordx4 v[164:167], v161, s[16:19], s40 offen
    s_add_u32 s40, s40, 344064
    buffer_load_dwordx4 v[168:171], v161, s[16:19], s40 offen
    s_add_u32 s40, s40, 344064
    buffer_load_dwordx4 v[172:175], v161, s[16:19], s40 offen
    s_add_u32 s40, s40, 344064
    buffer_load_dwordx4 v[176:179], v161, s[16:19], s40 offen
    s_add_u32 s40, s40, 344064
    buffer_load_dwordx4 v[180:183], v160, s[8:11], s41 offen
    s_add_u32 s41, s41, 229376
    buffer_load_dwordx4 v[184:187], v160, s[8:11], s41 offen
    s_add_u32 s41, s41, 229376
    buffer_load_dwordx4 v[188:191], v160, s[8:11], s41 offen
    s_add_u32 s41, s41, 229376
    buffer_load_dwordx4 v[192:195], v160, s[8:11], s41 offen
    s_add_u32 s41, s41, 229376
    buffer_load_dwordx4 v[196:199], v160, s[8:11], s41 offen
    s_add_u32 s41, s41, 229376
    buffer_load_dwordx4 v[200:203], v160, s[8:11], s41 offen
    s_add_u32 s41, s41, 229376
    buffer_load_dwordx4 v[204:207], v160, s[8:11], s41 offen
    s_add_u32 s41, s41, 229376
    s_cmp_eq_u32 s38, 1
    s_cbranch_scc1 parallel_sum__softmax_full_mha__swiglu_ffn__prompt_kernel_wb_4
    s_and_b32 s35, s2, 127
    s_lshl_b32 s35, s35, 2
    s_add_u32 s35, s35, s3
    s_lshl_b32 s35, s35, 12
    s_mov_b32 s12, s64
    s_and_b32 s13, s65, 0xffff
    s_mov_b32 s14, 1605632
    s_mov_b32 s15, 0x20000
    s_cmp_lt_u32 s35, 1605632
    s_cselect_b32 s12, s12, s66
    s_cselect_b32 s13, s13, s67
    s_cselect_b32 s14, s14, 401408
    s_cselect_b32 s36, 0, 1605632
    s_and_b32 s13, s13, 0xffff
    s_sub_u32 s42, s35, s36
    buffer_load_dwordx4 v[208:211], v2, s[12:15], s42 offen
    buffer_load_dwordx4 v[212:215], v2, s[12:15], s42 offen offset:1024
    buffer_load_dwordx4 v[216:219], v2, s[12:15], s42 offen offset:2048
    buffer_load_dwordx4 v[220:223], v2, s[12:15], s42 offen offset:3072
parallel_sum__softmax_full_mha__swiglu_ffn__prompt_kernel_wb_4:
    s_branch parallel_sum__softmax_full_mha__swiglu_ffn__prompt_kernel_qjoin_3
parallel_sum__softmax_full_mha__swiglu_ffn__prompt_kernel_qskip_2:
    s_lshl_b32 s35, s51, 2
    s_add_u32 s30, s30, s35
parallel_sum__softmax_full_mha__swiglu_ffn__prompt_kernel_qjoin_3:
    s_lshl_b32 s35, s38, 1
    s_add_u32 s35, s35, s48
    s_cmp_eq_u32 s35, 3
    s_cbranch_scc1 parallel_sum__softmax_full_mha__swiglu_ffn__prompt_kernel_VH1
    s_cmp_eq_u32 s35, 0
    s_cbranch_scc1 parallel_sum__softmax_full_mha__swiglu_ffn__prompt_kernel_VK0
    s_cmp_eq_u32 s35, 1
    s_cbranch_scc1 parallel_sum__softmax_full_mha__swiglu_ffn__prompt_kernel_VK1
    s_cmp_eq_u32 s28, 1
    s_cbranch_scc1 parallel_sum__softmax_full_mha__swiglu_ffn__prompt_kernel_VQ0
parallel_sum__softmax_full_mha__swiglu_ffn__prompt_kernel_VV0:
    s_waitcnt vmcnt(17) lgkmcnt(0)
    s_barrier
    ds_read_b64_tr_b16 v[24:25], v154 offset:0
    ds_read_b64_tr_b16 v[26:27], v154 offset:512
    ds_read_b64_tr_b16 v[28:29], v163 offset:0
    ds_read_b64_tr_b16 v[30:31], v163 offset:512
    ds_read_b128 v[16:19], v3 offset:0
    ds_read_b128 v[20:23], v3 offset:2048
    ds_read_b64_tr_b16 v[40:41], v154 offset:4096
    ds_read_b64_tr_b16 v[42:43], v154 offset:4608
    ds_read_b64_tr_b16 v[44:45], v163 offset:4096
    ds_read_b64_tr_b16 v[46:47], v163 offset:4608
    ds_read_b128 v[32:35], v4 offset:0
    ds_read_b128 v[36:39], v4 offset:2048
    s_mov_b32 s52, s72
    s_and_b32 s53, s73, 0xffff
    s_mov_b32 s54, 256
    s_mov_b32 s55, 0x20000
    buffer_load_dword v156, v158, s[52:55], 0 offen sc0 sc1
    s_waitcnt lgkmcnt(0)
    v_mfma_f32_32x32x16_bf16 v[56:71], v[16:19], v[24:27], 0
    v_mfma_f32_32x32x16_bf16 v[72:87], v[20:23], v[24:27], 0
    s_waitcnt vmcnt(16)
    s_barrier
    v_mfma_f32_32x32x16_bf16 v[88:103], v[16:19], v[28:31], 0
    ds_read_b64_tr_b16 v[224:225], v154 offset:8192
    ds_read_b64_tr_b16 v[226:227], v154 offset:8704
    ds_read_b64_tr_b16 v[228:229], v163 offset:8192
    ds_read_b64_tr_b16 v[230:231], v163 offset:8704
    v_mfma_f32_32x32x16_bf16 v[104:119], v[20:23], v[28:31], 0
    ds_read_b128 v[216:219], v3 offset:8192
    ds_read_b128 v[220:223], v3 offset:10240
    ds_read_b64_tr_b16 v[240:241], v154 offset:12288
    ds_read_b64_tr_b16 v[242:243], v154 offset:12800
    v_mfma_f32_32x32x16_bf16 v[56:71], v[32:35], v[40:43], v[56:71]
    ds_read_b64_tr_b16 v[244:245], v163 offset:12288
    ds_read_b64_tr_b16 v[246:247], v163 offset:12800
    ds_read_b128 v[232:235], v4 offset:8192
    ds_read_b128 v[236:239], v4 offset:10240
    v_mfma_f32_32x32x16_bf16 v[72:87], v[36:39], v[40:43], v[72:87]
    v_mfma_f32_32x32x16_bf16 v[88:103], v[32:35], v[44:47], v[88:103]
    v_mfma_f32_32x32x16_bf16 v[104:119], v[36:39], v[44:47], v[104:119]
    s_waitcnt lgkmcnt(0)
    v_mfma_f32_32x32x16_bf16 v[56:71], v[216:219], v[224:227], v[56:71]
    v_mfma_f32_32x32x16_bf16 v[72:87], v[220:223], v[224:227], v[72:87]
    s_waitcnt vmcnt(14)
    s_barrier
    v_mfma_f32_32x32x16_bf16 v[88:103], v[216:219], v[228:231], v[88:103]
    ds_read_b64_tr_b16 v[24:25], v154 offset:16384
    ds_read_b64_tr_b16 v[26:27], v154 offset:16896
    ds_read_b64_tr_b16 v[28:29], v163 offset:16384
    ds_read_b64_tr_b16 v[30:31], v163 offset:16896
    v_mfma_f32_32x32x16_bf16 v[104:119], v[220:223], v[228:231], v[104:119]
    ds_read_b128 v[16:19], v3 offset:16384
    ds_read_b128 v[20:23], v3 offset:18432
    ds_read_b64_tr_b16 v[40:41], v154 offset:20480
    ds_read_b64_tr_b16 v[42:43], v154 offset:20992
    v_mfma_f32_32x32x16_bf16 v[56:71], v[232:235], v[240:243], v[56:71]
    ds_read_b64_tr_b16 v[44:45], v163 offset:20480
    ds_read_b64_tr_b16 v[46:47], v163 offset:20992
    ds_read_b128 v[32:35], v4 offset:16384
    ds_read_b128 v[36:39], v4 offset:18432
    v_mfma_f32_32x32x16_bf16 v[72:87], v[236:239], v[240:243], v[72:87]
    v_mfma_f32_32x32x16_bf16 v[88:103], v[232:235], v[244:247], v[88:103]
    v_mfma_f32_32x32x16_bf16 v[104:119], v[236:239], v[244:247], v[104:119]
    s_waitcnt lgkmcnt(0)
    v_mfma_f32_32x32x16_bf16 v[56:71], v[16:19], v[24:27], v[56:71]
    v_mfma_f32_32x32x16_bf16 v[72:87], v[20:23], v[24:27], v[72:87]
    s_waitcnt vmcnt(12)
    s_barrier
    v_mfma_f32_32x32x16_bf16 v[88:103], v[16:19], v[28:31], v[88:103]
    ds_read_b64_tr_b16 v[224:225], v154 offset:24576
    ds_read_b64_tr_b16 v[226:227], v154 offset:25088
    ds_read_b64_tr_b16 v[228:229], v163 offset:24576
    ds_read_b64_tr_b16 v[230:231], v163 offset:25088
    v_mfma_f32_32x32x16_bf16 v[104:119], v[20:23], v[28:31], v[104:119]
    ds_read_b128 v[216:219], v3 offset:24576
    ds_read_b128 v[220:223], v3 offset:26624
    ds_read_b64_tr_b16 v[240:241], v154 offset:28672
    ds_read_b64_tr_b16 v[242:243], v154 offset:29184
    v_mfma_f32_32x32x16_bf16 v[56:71], v[32:35], v[40:43], v[56:71]
    ds_read_b64_tr_b16 v[244:245], v163 offset:28672
    ds_read_b64_tr_b16 v[246:247], v163 offset:29184
    ds_read_b128 v[232:235], v4 offset:24576
    ds_read_b128 v[236:239], v4 offset:26624
    v_mfma_f32_32x32x16_bf16 v[72:87], v[36:39], v[40:43], v[72:87]
    v_mfma_f32_32x32x16_bf16 v[88:103], v[32:35], v[44:47], v[88:103]
    v_mfma_f32_32x32x16_bf16 v[104:119], v[36:39], v[44:47], v[104:119]
    s_waitcnt lgkmcnt(0)
    v_mfma_f32_32x32x16_bf16 v[56:71], v[216:219], v[224:227], v[56:71]
    v_mfma_f32_32x32x16_bf16 v[72:87], v[220:223], v[224:227], v[72:87]
    s_waitcnt vmcnt(20)
    s_barrier
    v_mfma_f32_32x32x16_bf16 v[88:103], v[216:219], v[228:231], v[88:103]
    v_add_u32 v3, 32768, v3
    v_add_u32 v4, 32768, v4
    ds_read_b64_tr_b16 v[24:25], v154 offset:32768
    ds_read_b64_tr_b16 v[26:27], v154 offset:33280
    ds_read_b64_tr_b16 v[28:29], v163 offset:32768
    v_mfma_f32_32x32x16_bf16 v[104:119], v[220:223], v[228:231], v[104:119]
    ds_read_b64_tr_b16 v[30:31], v163 offset:33280
    ds_read_b128 v[16:19], v3 offset:0
    ds_read_b128 v[20:23], v3 offset:2048
    ds_read_b64_tr_b16 v[40:41], v154 offset:36864
    ds_read_b64_tr_b16 v[42:43], v154 offset:37376
    v_mfma_f32_32x32x16_bf16 v[56:71], v[232:235], v[240:243], v[56:71]
    ds_read_b64_tr_b16 v[44:45], v163 offset:36864
    ds_read_b64_tr_b16 v[46:47], v163 offset:37376
    ds_read_b128 v[32:35], v4 offset:0
    ds_read_b128 v[36:39], v4 offset:2048
    v_mfma_f32_32x32x16_bf16 v[72:87], v[236:239], v[240:243], v[72:87]
    v_mfma_f32_32x32x16_bf16 v[88:103], v[232:235], v[244:247], v[88:103]
    v_mfma_f32_32x32x16_bf16 v[104:119], v[236:239], v[244:247], v[104:119]
    s_waitcnt lgkmcnt(0)
    v_mfma_f32_32x32x16_bf16 v[56:71], v[16:19], v[24:27], v[56:71]
    v_mfma_f32_32x32x16_bf16 v[72:87], v[20:23], v[24:27], v[72:87]
    s_waitcnt vmcnt(20)
    s_barrier
    v_mfma_f32_32x32x16_bf16 v[88:103], v[16:19], v[28:31], v[88:103]
    ds_read_b64_tr_b16 v[224:225], v154 offset:0
    ds_read_b64_tr_b16 v[226:227], v154 offset:512
    ds_read_b64_tr_b16 v[228:229], v163 offset:0
    ds_read_b64_tr_b16 v[230:231], v163 offset:512
    v_mfma_f32_32x32x16_bf16 v[104:119], v[20:23], v[28:31], v[104:119]
    ds_read_b128 v[216:219], v3 offset:8192
    ds_read_b128 v[220:223], v3 offset:10240
    ds_read_b64_tr_b16 v[240:241], v154 offset:4096
    ds_read_b64_tr_b16 v[242:243], v154 offset:4608
    v_mfma_f32_32x32x16_bf16 v[56:71], v[32:35], v[40:43], v[56:71]
    ds_read_b64_tr_b16 v[244:245], v163 offset:4096
    ds_read_b64_tr_b16 v[246:247], v163 offset:4608
    ds_read_b128 v[232:235], v4 offset:8192
    ds_read_b128 v[236:239], v4 offset:10240
    v_mfma_f32_32x32x16_bf16 v[72:87], v[36:39], v[40:43], v[72:87]
    v_mfma_f32_32x32x16_bf16 v[88:103], v[32:35], v[44:47], v[88:103]
    v_mfma_f32_32x32x16_bf16 v[104:119], v[36:39], v[44:47], v[104:119]
    s_waitcnt lgkmcnt(0)
    v_mfma_f32_32x32x16_bf16 v[56:71], v[216:219], v[224:227], v[56:71]
    v_mfma_f32_32x32x16_bf16 v[72:87], v[220:223], v[224:227], v[72:87]
    s_waitcnt vmcnt(20)
    s_barrier
    v_mfma_f32_32x32x16_bf16 v[88:103], v[216:219], v[228:231], v[88:103]
    ds_read_b64_tr_b16 v[24:25], v154 offset:8192
    ds_read_b64_tr_b16 v[26:27], v154 offset:8704
    ds_read_b64_tr_b16 v[28:29], v163 offset:8192
    ds_read_b64_tr_b16 v[30:31], v163 offset:8704
    v_mfma_f32_32x32x16_bf16 v[104:119], v[220:223], v[228:231], v[104:119]
    ds_read_b128 v[16:19], v3 offset:16384
    ds_read_b128 v[20:23], v3 offset:18432
    ds_read_b64_tr_b16 v[40:41], v154 offset:12288
    ds_read_b64_tr_b16 v[42:43], v154 offset:12800
    v_mfma_f32_32x32x16_bf16 v[56:71], v[232:235], v[240:243], v[56:71]
    ds_read_b64_tr_b16 v[44:45], v163 offset:12288
    ds_read_b64_tr_b16 v[46:47], v163 offset:12800
    ds_read_b128 v[32:35], v4 offset:16384
    ds_read_b128 v[36:39], v4 offset:18432
    v_mfma_f32_32x32x16_bf16 v[72:87], v[236:239], v[240:243], v[72:87]
    v_mfma_f32_32x32x16_bf16 v[88:103], v[232:235], v[244:247], v[88:103]
    v_mfma_f32_32x32x16_bf16 v[104:119], v[236:239], v[244:247], v[104:119]
    s_waitcnt lgkmcnt(0)
    v_mfma_f32_32x32x16_bf16 v[56:71], v[16:19], v[24:27], v[56:71]
    v_mfma_f32_32x32x16_bf16 v[72:87], v[20:23], v[24:27], v[72:87]
    s_waitcnt vmcnt(20)
    s_barrier
    v_mfma_f32_32x32x16_bf16 v[88:103], v[16:19], v[28:31], v[88:103]
    ds_read_b64_tr_b16 v[224:225], v154 offset:16384
    ds_read_b64_tr_b16 v[226:227], v154 offset:16896
    ds_read_b64_tr_b16 v[228:229], v163 offset:16384
    ds_read_b64_tr_b16 v[230:231], v163 offset:16896
    v_mfma_f32_32x32x16_bf16 v[104:119], v[20:23], v[28:31], v[104:119]
    ds_read_b128 v[216:219], v3 offset:24576
    ds_read_b128 v[220:223], v3 offset:26624
    ds_read_b64_tr_b16 v[240:241], v154 offset:20480
    ds_read_b64_tr_b16 v[242:243], v154 offset:20992
    v_mfma_f32_32x32x16_bf16 v[56:71], v[32:35], v[40:43], v[56:71]
    ds_read_b64_tr_b16 v[244:245], v163 offset:20480
    ds_read_b64_tr_b16 v[246:247], v163 offset:20992
    ds_read_b128 v[232:235], v4 offset:24576
    ds_read_b128 v[236:239], v4 offset:26624
    v_mfma_f32_32x32x16_bf16 v[72:87], v[36:39], v[40:43], v[72:87]
    v_mfma_f32_32x32x16_bf16 v[88:103], v[32:35], v[44:47], v[88:103]
    v_mfma_f32_32x32x16_bf16 v[104:119], v[36:39], v[44:47], v[104:119]
    s_waitcnt lgkmcnt(0)
    v_mfma_f32_32x32x16_bf16 v[56:71], v[216:219], v[224:227], v[56:71]
    v_mfma_f32_32x32x16_bf16 v[72:87], v[220:223], v[224:227], v[72:87]
    s_waitcnt vmcnt(20)
    s_barrier
    v_mfma_f32_32x32x16_bf16 v[88:103], v[216:219], v[228:231], v[88:103]
    v_add_u32 v3, 32768, v3
    v_add_u32 v4, 32768, v4
    ds_read_b64_tr_b16 v[24:25], v154 offset:24576
    ds_read_b64_tr_b16 v[26:27], v154 offset:25088
    ds_read_b64_tr_b16 v[28:29], v163 offset:24576
    v_mfma_f32_32x32x16_bf16 v[104:119], v[220:223], v[228:231], v[104:119]
    ds_read_b64_tr_b16 v[30:31], v163 offset:25088
    ds_read_b128 v[16:19], v3 offset:0
    ds_read_b128 v[20:23], v3 offset:2048
    ds_read_b64_tr_b16 v[40:41], v154 offset:28672
    ds_read_b64_tr_b16 v[42:43], v154 offset:29184
    v_mfma_f32_32x32x16_bf16 v[56:71], v[232:235], v[240:243], v[56:71]
    ds_read_b64_tr_b16 v[44:45], v163 offset:28672
    ds_read_b64_tr_b16 v[46:47], v163 offset:29184
    ds_read_b128 v[32:35], v4 offset:0
    ds_read_b128 v[36:39], v4 offset:2048
    v_mfma_f32_32x32x16_bf16 v[72:87], v[236:239], v[240:243], v[72:87]
    v_mfma_f32_32x32x16_bf16 v[88:103], v[232:235], v[244:247], v[88:103]
    v_mfma_f32_32x32x16_bf16 v[104:119], v[236:239], v[244:247], v[104:119]
    s_waitcnt lgkmcnt(0)
    v_mfma_f32_32x32x16_bf16 v[56:71], v[16:19], v[24:27], v[56:71]
    v_mfma_f32_32x32x16_bf16 v[72:87], v[20:23], v[24:27], v[72:87]
    s_waitcnt vmcnt(20)
    s_barrier
    v_mfma_f32_32x32x16_bf16 v[88:103], v[16:19], v[28:31], v[88:103]
    ds_read_b64_tr_b16 v[224:225], v154 offset:32768
    ds_read_b64_tr_b16 v[226:227], v154 offset:33280
    ds_read_b64_tr_b16 v[228:229], v163 offset:32768
    ds_read_b64_tr_b16 v[230:231], v163 offset:33280
    v_mfma_f32_32x32x16_bf16 v[104:119], v[20:23], v[28:31], v[104:119]
    ds_read_b128 v[216:219], v3 offset:8192
    ds_read_b128 v[220:223], v3 offset:10240
    ds_read_b64_tr_b16 v[240:241], v154 offset:36864
    ds_read_b64_tr_b16 v[242:243], v154 offset:37376
    v_mfma_f32_32x32x16_bf16 v[56:71], v[32:35], v[40:43], v[56:71]
    ds_read_b64_tr_b16 v[244:245], v163 offset:36864
    ds_read_b64_tr_b16 v[246:247], v163 offset:37376
    ds_read_b128 v[232:235], v4 offset:8192
    ds_read_b128 v[236:239], v4 offset:10240
    v_mfma_f32_32x32x16_bf16 v[72:87], v[36:39], v[40:43], v[72:87]
    v_mfma_f32_32x32x16_bf16 v[88:103], v[32:35], v[44:47], v[88:103]
    v_mfma_f32_32x32x16_bf16 v[104:119], v[36:39], v[44:47], v[104:119]
    s_waitcnt lgkmcnt(0)
    v_mfma_f32_32x32x16_bf16 v[56:71], v[216:219], v[224:227], v[56:71]
    v_mfma_f32_32x32x16_bf16 v[72:87], v[220:223], v[224:227], v[72:87]
    s_waitcnt vmcnt(20)
    s_barrier
    v_mfma_f32_32x32x16_bf16 v[88:103], v[216:219], v[228:231], v[88:103]
    ds_read_b64_tr_b16 v[24:25], v154 offset:0
    ds_read_b64_tr_b16 v[26:27], v154 offset:512
    ds_read_b64_tr_b16 v[28:29], v163 offset:0
    ds_read_b64_tr_b16 v[30:31], v163 offset:512
    v_mfma_f32_32x32x16_bf16 v[104:119], v[220:223], v[228:231], v[104:119]
    ds_read_b128 v[16:19], v3 offset:16384
    ds_read_b128 v[20:23], v3 offset:18432
    ds_read_b64_tr_b16 v[40:41], v154 offset:4096
    ds_read_b64_tr_b16 v[42:43], v154 offset:4608
    v_mfma_f32_32x32x16_bf16 v[56:71], v[232:235], v[240:243], v[56:71]
    ds_read_b64_tr_b16 v[44:45], v163 offset:4096
    ds_read_b64_tr_b16 v[46:47], v163 offset:4608
    ds_read_b128 v[32:35], v4 offset:16384
    ds_read_b128 v[36:39], v4 offset:18432
    v_mfma_f32_32x32x16_bf16 v[72:87], v[236:239], v[240:243], v[72:87]
    v_mfma_f32_32x32x16_bf16 v[88:103], v[232:235], v[244:247], v[88:103]
    v_mfma_f32_32x32x16_bf16 v[104:119], v[236:239], v[244:247], v[104:119]
    s_waitcnt lgkmcnt(0)
    v_mfma_f32_32x32x16_bf16 v[56:71], v[16:19], v[24:27], v[56:71]
    v_mfma_f32_32x32x16_bf16 v[72:87], v[20:23], v[24:27], v[72:87]
    s_waitcnt vmcnt(20)
    s_barrier
    v_mfma_f32_32x32x16_bf16 v[88:103], v[16:19], v[28:31], v[88:103]
    ds_read_b64_tr_b16 v[224:225], v154 offset:8192
    ds_read_b64_tr_b16 v[226:227], v154 offset:8704
    ds_read_b64_tr_b16 v[228:229], v163 offset:8192
    ds_read_b64_tr_b16 v[230:231], v163 offset:8704
    v_mfma_f32_32x32x16_bf16 v[104:119], v[20:23], v[28:31], v[104:119]
    ds_read_b128 v[216:219], v3 offset:24576
    ds_read_b128 v[220:223], v3 offset:26624
    ds_read_b64_tr_b16 v[240:241], v154 offset:12288
    ds_read_b64_tr_b16 v[242:243], v154 offset:12800
    v_mfma_f32_32x32x16_bf16 v[56:71], v[32:35], v[40:43], v[56:71]
    ds_read_b64_tr_b16 v[244:245], v163 offset:12288
    ds_read_b64_tr_b16 v[246:247], v163 offset:12800
    ds_read_b128 v[232:235], v4 offset:24576
    ds_read_b128 v[236:239], v4 offset:26624
    v_mfma_f32_32x32x16_bf16 v[72:87], v[36:39], v[40:43], v[72:87]
    v_mfma_f32_32x32x16_bf16 v[88:103], v[32:35], v[44:47], v[88:103]
    v_mfma_f32_32x32x16_bf16 v[104:119], v[36:39], v[44:47], v[104:119]
    s_waitcnt lgkmcnt(0)
    v_mfma_f32_32x32x16_bf16 v[56:71], v[216:219], v[224:227], v[56:71]
    v_mfma_f32_32x32x16_bf16 v[72:87], v[220:223], v[224:227], v[72:87]
    s_waitcnt vmcnt(20)
    s_barrier
    v_mfma_f32_32x32x16_bf16 v[88:103], v[216:219], v[228:231], v[88:103]
    v_add_u32 v3, 32768, v3
    v_add_u32 v4, 32768, v4
    ds_read_b64_tr_b16 v[24:25], v154 offset:16384
    ds_read_b64_tr_b16 v[26:27], v154 offset:16896
    ds_read_b64_tr_b16 v[28:29], v163 offset:16384
    v_mfma_f32_32x32x16_bf16 v[104:119], v[220:223], v[228:231], v[104:119]
    ds_read_b64_tr_b16 v[30:31], v163 offset:16896
    ds_read_b128 v[16:19], v3 offset:0
    ds_read_b128 v[20:23], v3 offset:2048
    ds_read_b64_tr_b16 v[40:41], v154 offset:20480
    ds_read_b64_tr_b16 v[42:43], v154 offset:20992
    v_mfma_f32_32x32x16_bf16 v[56:71], v[232:235], v[240:243], v[56:71]
    ds_read_b64_tr_b16 v[44:45], v163 offset:20480
    ds_read_b64_tr_b16 v[46:47], v163 offset:20992
    ds_read_b128 v[32:35], v4 offset:0
    ds_read_b128 v[36:39], v4 offset:2048
    v_mfma_f32_32x32x16_bf16 v[72:87], v[236:239], v[240:243], v[72:87]
    v_mfma_f32_32x32x16_bf16 v[88:103], v[232:235], v[244:247], v[88:103]
    v_mfma_f32_32x32x16_bf16 v[104:119], v[236:239], v[244:247], v[104:119]
    s_waitcnt lgkmcnt(0)
    v_mfma_f32_32x32x16_bf16 v[56:71], v[16:19], v[24:27], v[56:71]
    v_mfma_f32_32x32x16_bf16 v[72:87], v[20:23], v[24:27], v[72:87]
    s_waitcnt vmcnt(20)
    s_barrier
    v_mfma_f32_32x32x16_bf16 v[88:103], v[16:19], v[28:31], v[88:103]
    ds_read_b64_tr_b16 v[224:225], v154 offset:24576
    ds_read_b64_tr_b16 v[226:227], v154 offset:25088
    ds_read_b64_tr_b16 v[228:229], v163 offset:24576
    ds_read_b64_tr_b16 v[230:231], v163 offset:25088
    v_mfma_f32_32x32x16_bf16 v[104:119], v[20:23], v[28:31], v[104:119]
    ds_read_b128 v[216:219], v3 offset:8192
    ds_read_b128 v[220:223], v3 offset:10240
    ds_read_b64_tr_b16 v[240:241], v154 offset:28672
    ds_read_b64_tr_b16 v[242:243], v154 offset:29184
    v_mfma_f32_32x32x16_bf16 v[56:71], v[32:35], v[40:43], v[56:71]
    ds_read_b64_tr_b16 v[244:245], v163 offset:28672
    ds_read_b64_tr_b16 v[246:247], v163 offset:29184
    ds_read_b128 v[232:235], v4 offset:8192
    ds_read_b128 v[236:239], v4 offset:10240
    v_mfma_f32_32x32x16_bf16 v[72:87], v[36:39], v[40:43], v[72:87]
    v_mfma_f32_32x32x16_bf16 v[88:103], v[32:35], v[44:47], v[88:103]
    v_mfma_f32_32x32x16_bf16 v[104:119], v[36:39], v[44:47], v[104:119]
    s_waitcnt lgkmcnt(0)
    v_mfma_f32_32x32x16_bf16 v[56:71], v[216:219], v[224:227], v[56:71]
    v_mfma_f32_32x32x16_bf16 v[72:87], v[220:223], v[224:227], v[72:87]
    v_mfma_f32_32x32x16_bf16 v[88:103], v[216:219], v[228:231], v[88:103]
    v_mfma_f32_32x32x16_bf16 v[104:119], v[220:223], v[228:231], v[104:119]
    v_mfma_f32_32x32x16_bf16 v[56:71], v[232:235], v[240:243], v[56:71]
    v_mfma_f32_32x32x16_bf16 v[72:87], v[236:239], v[240:243], v[72:87]
    v_mfma_f32_32x32x16_bf16 v[88:103], v[232:235], v[244:247], v[88:103]
    v_mfma_f32_32x32x16_bf16 v[104:119], v[236:239], v[244:247], v[104:119]
    s_nop 0
    s_barrier
    s_waitcnt vmcnt(0)
    v_readfirstlane_b32 s74, v156
    s_nop 3
    s_cmp_lg_u32 s74, 0
    s_cbranch_scc1 parallel_sum__softmax_full_mha__swiglu_ffn__prompt_kernel_havetag_5
    s_mov_b32 s52, s72
    s_and_b32 s53, s73, 0xffff
    s_mov_b32 s54, 256
    s_mov_b32 s55, 0x20000
    s_mov_b32 s36, 524288
    v_mov_b32 v10, 0
parallel_sum__softmax_full_mha__swiglu_ffn__prompt_kernel_tag_6:
    buffer_load_dword v9, v10, s[52:55], 0 offen sc0 sc1
    s_waitcnt vmcnt(0)
    v_readfirstlane_b32 s74, v9
    s_nop 1
    s_sub_u32 s36, s36, 1
    s_cmp_eq_u32 s36, 0
    s_cbranch_scc1 parallel_sum__softmax_full_mha__swiglu_ffn__prompt_kernel_tagx_7
    s_cmp_eq_u32 s74, 0
    s_cbranch_scc1 parallel_sum__softmax_full_mha__swiglu_ffn__prompt_kernel_tag_6
parallel_sum__softmax_full_mha__swiglu_ffn__prompt_kernel_tagx_7:
parallel_sum__softmax_full_mha__swiglu_ffn__prompt_kernel_havetag_5:
    v_subrev_u32 v3, 98304, v3
    v_subrev_u32 v4, 98304, v4
    s_add_u32 m0, s33, 0
    s_nop 0
    buffer_load_dwordx4 v153, s[8:11], s31 offen lds
    s_add_u32 s31, s31, 57344
    s_add_u32 m0, s33, 6144
    s_nop 0
    buffer_load_dwordx4 v153, s[8:11], s31 offen lds
    s_add_u32 s31, s31, 57344
    s_add_u32 m0, s33, 12288
    s_nop 0
    buffer_load_dwordx4 v153, s[8:11], s31 offen lds
    s_add_u32 s31, s31, 57344
    s_add_u32 m0, s33, 18432
    s_nop 0
    buffer_load_dwordx4 v153, s[8:11], s31 offen lds
    s_add_u32 s31, s31, 57344
    s_add_u32 m0, s33, 24576
    s_nop 0
    buffer_load_dwordx4 v153, s[8:11], s31 offen lds
    s_add_u32 s31, s31, 57344
    s_add_u32 m0, s33, 30720
    s_nop 0
    buffer_load_dwordx4 v153, s[8:11], s31 offen lds
    s_add_u32 s31, s31, 57344
    s_nop 7
    s_lshl_b32 s39, s49, 1
    s_add_u32 s39, s39, 32
    v_cmp_eq_u32 vcc, 28, v1
    v_cmp_eq_u32 s[4:5], 60, v1
    s_nop 3
    s_or_b64 s[4:5], s[4:5], vcc
    v_cvt_pk_bf16_f32 v56, v56, v57
    v_cvt_pk_bf16_f32 v57, v58, v59
    v_cvt_pk_bf16_f32 v58, v60, v61
    v_cvt_pk_bf16_f32 v59, v62, v63
    v_cvt_pk_bf16_f32 v60, v64, v65
    v_cvt_pk_bf16_f32 v61, v66, v67
    v_cvt_pk_bf16_f32 v62, v68, v69
    v_cvt_pk_bf16_f32 v63, v70, v71
    s_mov_b64 exec, s[4:5]
    v_mov_b32 v56, 0x3f803f80
    v_mov_b32 v57, 0x3f803f80
    v_mov_b32 v58, 0x3f803f80
    v_mov_b32 v59, 0x3f803f80
    v_mov_b32 v60, 0x3f803f80
    v_mov_b32 v61, 0x3f803f80
    v_mov_b32 v62, 0x3f803f80
    v_mov_b32 v63, 0x3f803f80
    s_mov_b64 exec, -1
    s_add_u32 s35, s39, 0
    s_lshl_b32 s35, s35, 6
    s_add_u32 s35, s35, s43
    s_lshl_b32 s35, s35, 11
    buffer_store_dwordx4 v[56:59], v2, s[20:23], s35 offen sc0 sc1
    buffer_store_dwordx4 v[60:63], v2, s[20:23], s35 offen offset:1024 sc0 sc1
    v_cvt_pk_bf16_f32 v72, v72, v73
    v_cvt_pk_bf16_f32 v73, v74, v75
    v_cvt_pk_bf16_f32 v74, v76, v77
    v_cvt_pk_bf16_f32 v75, v78, v79
    v_cvt_pk_bf16_f32 v76, v80, v81
    v_cvt_pk_bf16_f32 v77, v82, v83
    v_cvt_pk_bf16_f32 v78, v84, v85
    v_cvt_pk_bf16_f32 v79, v86, v87
    s_mov_b64 exec, s[4:5]
    v_mov_b32 v72, 0x3f803f80
    v_mov_b32 v73, 0x3f803f80
    v_mov_b32 v74, 0x3f803f80
    v_mov_b32 v75, 0x3f803f80
    v_mov_b32 v76, 0x3f803f80
    v_mov_b32 v77, 0x3f803f80
    v_mov_b32 v78, 0x3f803f80
    v_mov_b32 v79, 0x3f803f80
    s_mov_b64 exec, -1
    s_add_u32 s35, s39, 0
    s_lshl_b32 s35, s35, 6
    s_add_u32 s35, s35, s44
    s_lshl_b32 s35, s35, 11
    buffer_store_dwordx4 v[72:75], v2, s[20:23], s35 offen sc0 sc1
    buffer_store_dwordx4 v[76:79], v2, s[20:23], s35 offen offset:1024 sc0 sc1
    v_cvt_pk_bf16_f32 v88, v88, v89
    v_cvt_pk_bf16_f32 v89, v90, v91
    v_cvt_pk_bf16_f32 v90, v92, v93
    v_cvt_pk_bf16_f32 v91, v94, v95
    v_cvt_pk_bf16_f32 v92, v96, v97
    v_cvt_pk_bf16_f32 v93, v98, v99
    v_cvt_pk_bf16_f32 v94, v100, v101
    v_cvt_pk_bf16_f32 v95, v102, v103
    s_mov_b64 exec, s[4:5]
    v_mov_b32 v88, 0x3f803f80
    v_mov_b32 v89, 0x3f803f80
    v_mov_b32 v90, 0x3f803f80
    v_mov_b32 v91, 0x3f803f80
    v_mov_b32 v92, 0x3f803f80
    v_mov_b32 v93, 0x3f803f80
    v_mov_b32 v94, 0x3f803f80
    v_mov_b32 v95, 0x3f803f80
    s_mov_b64 exec, -1
    s_add_u32 s35, s39, 1
    s_lshl_b32 s35, s35, 6
    s_add_u32 s35, s35, s43
    s_lshl_b32 s35, s35, 11
    buffer_store_dwordx4 v[88:91], v2, s[20:23], s35 offen sc0 sc1
    buffer_store_dwordx4 v[92:95], v2, s[20:23], s35 offen offset:1024 sc0 sc1
    v_cvt_pk_bf16_f32 v104, v104, v105
    v_cvt_pk_bf16_f32 v105, v106, v107
    v_cvt_pk_bf16_f32 v106, v108, v109
    v_cvt_pk_bf16_f32 v107, v110, v111
    v_cvt_pk_bf16_f32 v108, v112, v113
    v_cvt_pk_bf16_f32 v109, v114, v115
    v_cvt_pk_bf16_f32 v110, v116, v117
    v_cvt_pk_bf16_f32 v111, v118, v119
    s_mov_b64 exec, s[4:5]
    v_mov_b32 v104, 0x3f803f80
    v_mov_b32 v105, 0x3f803f80
    v_mov_b32 v106, 0x3f803f80
    v_mov_b32 v107, 0x3f803f80
    v_mov_b32 v108, 0x3f803f80
    v_mov_b32 v109, 0x3f803f80
    v_mov_b32 v110, 0x3f803f80
    v_mov_b32 v111, 0x3f803f80
    s_mov_b64 exec, -1
    s_add_u32 s35, s39, 1
    s_lshl_b32 s35, s35, 6
    s_add_u32 s35, s35, s44
    s_lshl_b32 s35, s35, 11
    buffer_store_dwordx4 v[104:107], v2, s[20:23], s35 offen sc0 sc1
    buffer_store_dwordx4 v[108:111], v2, s[20:23], s35 offen offset:1024 sc0 sc1
    s_waitcnt vmcnt(12) lgkmcnt(0)
    s_barrier
    ds_read_b64_tr_b16 v[184:185], v5 offset:0
    ds_read_b64_tr_b16 v[186:187], v5 offset:256
    ds_read_b64_tr_b16 v[188:189], v5 offset:1024
    ds_read_b64_tr_b16 v[190:191], v5 offset:1280
    ds_read_b128 v[176:179], v3 offset:0
    ds_read_b128 v[180:183], v3 offset:2048
    ds_read_b64_tr_b16 v[200:201], v5 offset:6144
    ds_read_b64_tr_b16 v[202:203], v5 offset:6400
    ds_read_b64_tr_b16 v[204:205], v5 offset:7168
    ds_read_b64_tr_b16 v[206:207], v5 offset:7424
    ds_read_b128 v[192:195], v4 offset:0
    ds_read_b128 v[196:199], v4 offset:2048
    s_waitcnt lgkmcnt(0)
    v_mfma_f32_32x32x16_bf16 v[56:71], v[184:187], v[176:179], 0
    v_mfma_f32_32x32x16_bf16 v[72:87], v[184:187], v[180:183], 0
    s_waitcnt vmcnt(10)
    s_barrier
    v_mfma_f32_32x32x16_bf16 v[88:103], v[188:191], v[176:179], 0
    ds_read_b64_tr_b16 v[216:217], v5 offset:12288
    ds_read_b64_tr_b16 v[218:219], v5 offset:12544
    ds_read_b64_tr_b16 v[220:221], v5 offset:13312
    ds_read_b64_tr_b16 v[222:223], v5 offset:13568
    v_mfma_f32_32x32x16_bf16 v[104:119], v[188:191], v[180:183], 0
    ds_read_b128 v[208:211], v3 offset:8192
    ds_read_b128 v[212:215], v3 offset:10240
    ds_read_b64_tr_b16 v[232:233], v5 offset:18432
    ds_read_b64_tr_b16 v[234:235], v5 offset:18688
    v_mfma_f32_32x32x16_bf16 v[56:71], v[200:203], v[192:195], v[56:71]
    ds_read_b64_tr_b16 v[236:237], v5 offset:19456
    ds_read_b64_tr_b16 v[238:239], v5 offset:19712
    ds_read_b128 v[224:227], v4 offset:8192
    ds_read_b128 v[228:231], v4 offset:10240
    v_mfma_f32_32x32x16_bf16 v[72:87], v[200:203], v[196:199], v[72:87]
    v_mfma_f32_32x32x16_bf16 v[88:103], v[204:207], v[192:195], v[88:103]
    v_mfma_f32_32x32x16_bf16 v[104:119], v[204:207], v[196:199], v[104:119]
    s_add_u32 m0, s33, 0
    s_nop 0
    buffer_load_dwordx4 v153, s[8:11], s31 offen lds
    s_add_u32 s31, s31, 57344
    s_add_u32 m0, s33, 6144
    s_nop 0
    buffer_load_dwordx4 v153, s[8:11], s31 offen lds
    s_add_u32 s31, s31, 57344
    s_waitcnt lgkmcnt(0)
    v_mfma_f32_32x32x16_bf16 v[56:71], v[216:219], v[208:211], v[56:71]
    v_mfma_f32_32x32x16_bf16 v[72:87], v[216:219], v[212:215], v[72:87]
    s_waitcnt vmcnt(10)
    s_barrier
    v_mfma_f32_32x32x16_bf16 v[88:103], v[220:223], v[208:211], v[88:103]
    ds_read_b64_tr_b16 v[184:185], v5 offset:24576
    ds_read_b64_tr_b16 v[186:187], v5 offset:24832
    ds_read_b64_tr_b16 v[188:189], v5 offset:25600
    ds_read_b64_tr_b16 v[190:191], v5 offset:25856
    v_mfma_f32_32x32x16_bf16 v[104:119], v[220:223], v[212:215], v[104:119]
    ds_read_b128 v[176:179], v3 offset:16384
    ds_read_b128 v[180:183], v3 offset:18432
    ds_read_b64_tr_b16 v[200:201], v5 offset:30720
    ds_read_b64_tr_b16 v[202:203], v5 offset:30976
    v_mfma_f32_32x32x16_bf16 v[56:71], v[232:235], v[224:227], v[56:71]
    ds_read_b64_tr_b16 v[204:205], v5 offset:31744
    ds_read_b64_tr_b16 v[206:207], v5 offset:32000
    ds_read_b128 v[192:195], v4 offset:16384
    ds_read_b128 v[196:199], v4 offset:18432
    v_mfma_f32_32x32x16_bf16 v[72:87], v[232:235], v[228:231], v[72:87]
    v_mfma_f32_32x32x16_bf16 v[88:103], v[236:239], v[224:227], v[88:103]
    v_mfma_f32_32x32x16_bf16 v[104:119], v[236:239], v[228:231], v[104:119]
    s_add_u32 m0, s33, 12288
    s_nop 0
    buffer_load_dwordx4 v153, s[8:11], s31 offen lds
    s_add_u32 s31, s31, 57344
    s_add_u32 m0, s33, 18432
    s_nop 0
    buffer_load_dwordx4 v153, s[8:11], s31 offen lds
    s_add_u32 s31, s31, 57344
    s_waitcnt lgkmcnt(0)
    v_mfma_f32_32x32x16_bf16 v[56:71], v[184:187], v[176:179], v[56:71]
    v_mfma_f32_32x32x16_bf16 v[72:87], v[184:187], v[180:183], v[72:87]
    s_waitcnt vmcnt(2)
    s_barrier
    v_mfma_f32_32x32x16_bf16 v[88:103], v[188:191], v[176:179], v[88:103]
    ds_read_b64_tr_b16 v[216:217], v5 offset:0
    ds_read_b64_tr_b16 v[218:219], v5 offset:256
    ds_read_b64_tr_b16 v[220:221], v5 offset:1024
    ds_read_b64_tr_b16 v[222:223], v5 offset:1280
    v_mfma_f32_32x32x16_bf16 v[104:119], v[188:191], v[180:183], v[104:119]
    ds_read_b128 v[208:211], v3 offset:24576
    ds_read_b128 v[212:215], v3 offset:26624
    ds_read_b64_tr_b16 v[232:233], v5 offset:6144
    ds_read_b64_tr_b16 v[234:235], v5 offset:6400
    v_mfma_f32_32x32x16_bf16 v[56:71], v[200:203], v[192:195], v[56:71]
    ds_read_b64_tr_b16 v[236:237], v5 offset:7168
    ds_read_b64_tr_b16 v[238:239], v5 offset:7424
    ds_read_b128 v[224:227], v4 offset:24576
    ds_read_b128 v[228:231], v4 offset:26624
    v_mfma_f32_32x32x16_bf16 v[72:87], v[200:203], v[196:199], v[72:87]
    v_mfma_f32_32x32x16_bf16 v[88:103], v[204:207], v[192:195], v[88:103]
    v_mfma_f32_32x32x16_bf16 v[104:119], v[204:207], v[196:199], v[104:119]
    s_add_u32 m0, s33, 24576
    s_nop 0
    buffer_load_dwordx4 v153, s[8:11], s31 offen lds
    s_add_u32 s31, s31, 57344
    s_add_u32 m0, s33, 30720
    s_nop 0
    buffer_load_dwordx4 v153, s[8:11], s31 offen lds
    s_add_u32 s31, s31, 57344
    s_waitcnt lgkmcnt(0)
    v_mfma_f32_32x32x16_bf16 v[56:71], v[216:219], v[208:211], v[56:71]
    v_mfma_f32_32x32x16_bf16 v[72:87], v[216:219], v[212:215], v[72:87]
    s_waitcnt vmcnt(2)
    s_barrier
    v_mfma_f32_32x32x16_bf16 v[88:103], v[220:223], v[208:211], v[88:103]
    v_add_u32 v3, 32768, v3
    v_add_u32 v4, 32768, v4
    ds_read_b64_tr_b16 v[184:185], v5 offset:12288
    ds_read_b64_tr_b16 v[186:187], v5 offset:12544
    ds_read_b64_tr_b16 v[188:189], v5 offset:13312
    v_mfma_f32_32x32x16_bf16 v[104:119], v[220:223], v[212:215], v[104:119]
    ds_read_b64_tr_b16 v[190:191], v5 offset:13568
    ds_read_b128 v[176:179], v3 offset:0
    ds_read_b128 v[180:183], v3 offset:2048
    ds_read_b64_tr_b16 v[200:201], v5 offset:18432
    ds_read_b64_tr_b16 v[202:203], v5 offset:18688
    v_mfma_f32_32x32x16_bf16 v[56:71], v[232:235], v[224:227], v[56:71]
    ds_read_b64_tr_b16 v[204:205], v5 offset:19456
    ds_read_b64_tr_b16 v[206:207], v5 offset:19712
    ds_read_b128 v[192:195], v4 offset:0
    ds_read_b128 v[196:199], v4 offset:2048
    v_mfma_f32_32x32x16_bf16 v[72:87], v[232:235], v[228:231], v[72:87]
    v_mfma_f32_32x32x16_bf16 v[88:103], v[236:239], v[224:227], v[88:103]
    v_mfma_f32_32x32x16_bf16 v[104:119], v[236:239], v[228:231], v[104:119]
    s_add_u32 m0, s33, 0
    s_nop 0
    buffer_load_dwordx4 v153, s[8:11], s31 offen lds
    s_add_u32 s31, s31, 57344
    s_add_u32 m0, s33, 6144
    s_nop 0
    buffer_load_dwordx4 v153, s[8:11], s31 offen lds
    s_add_u32 s31, s31, 57344
    v_mov_b32 v9, 155648
    v_mov_b32 v10, 1
    s_mov_b64 exec, 1
    ds_add_rtn_u32 v10, v9, v10
    s_waitcnt lgkmcnt(0)
    s_mov_b64 exec, -1
    v_readfirstlane_b32 s35, v10
    s_nop 3
    s_cmp_lg_u32 s35, 7
    s_cbranch_scc1 parallel_sum__softmax_full_mha__swiglu_ffn__prompt_kernel_arr_8
    s_lshl_b32 s35, s2, 6
    s_add_u32 s35, s35, 25296896
    v_mov_b32 v9, s74
    v_mov_b32 v10, 0
    s_mov_b64 exec, 1
    buffer_store_dword v9, v10, s[20:23], s35 offen sc0 sc1
    s_mov_b64 exec, -1
parallel_sum__softmax_full_mha__swiglu_ffn__prompt_kernel_arr_8:
    s_waitcnt lgkmcnt(0)
    v_mfma_f32_32x32x16_bf16 v[56:71], v[184:187], v[176:179], v[56:71]
    v_mfma_f32_32x32x16_bf16 v[72:87], v[184:187], v[180:183], v[72:87]
    s_waitcnt vmcnt(2)
    s_barrier
    v_mfma_f32_32x32x16_bf16 v[88:103], v[188:191], v[176:179], v[88:103]
    ds_read_b64_tr_b16 v[216:217], v5 offset:24576
    ds_read_b64_tr_b16 v[218:219], v5 offset:24832
    ds_read_b64_tr_b16 v[220:221], v5 offset:25600
    ds_read_b64_tr_b16 v[222:223], v5 offset:25856
    v_mfma_f32_32x32x16_bf16 v[104:119], v[188:191], v[180:183], v[104:119]
    ds_read_b128 v[208:211], v3 offset:8192
    ds_read_b128 v[212:215], v3 offset:10240
    ds_read_b64_tr_b16 v[232:233], v5 offset:30720
    ds_read_b64_tr_b16 v[234:235], v5 offset:30976
    v_mfma_f32_32x32x16_bf16 v[56:71], v[200:203], v[192:195], v[56:71]
    ds_read_b64_tr_b16 v[236:237], v5 offset:31744
    ds_read_b64_tr_b16 v[238:239], v5 offset:32000
    ds_read_b128 v[224:227], v4 offset:8192
    ds_read_b128 v[228:231], v4 offset:10240
    v_mfma_f32_32x32x16_bf16 v[72:87], v[200:203], v[196:199], v[72:87]
    v_mfma_f32_32x32x16_bf16 v[88:103], v[204:207], v[192:195], v[88:103]
    v_mfma_f32_32x32x16_bf16 v[104:119], v[204:207], v[196:199], v[104:119]
    s_add_u32 m0, s33, 12288
    s_nop 0
    buffer_load_dwordx4 v153, s[8:11], s31 offen lds
    s_add_u32 s31, s31, 57344
    s_add_u32 m0, s33, 18432
    s_nop 0
    buffer_load_dwordx4 v153, s[8:11], s31 offen lds
    s_add_u32 s31, s31, 57344
    s_waitcnt lgkmcnt(0)
    v_mfma_f32_32x32x16_bf16 v[56:71], v[216:219], v[208:211], v[56:71]
    v_mfma_f32_32x32x16_bf16 v[72:87], v[216:219], v[212:215], v[72:87]
    s_waitcnt vmcnt(2)
    s_barrier
    v_mfma_f32_32x32x16_bf16 v[88:103], v[220:223], v[208:211], v[88:103]
    ds_read_b64_tr_b16 v[184:185], v5 offset:0
    ds_read_b64_tr_b16 v[186:187], v5 offset:256
    ds_read_b64_tr_b16 v[188:189], v5 offset:1024
    ds_read_b64_tr_b16 v[190:191], v5 offset:1280
    v_mfma_f32_32x32x16_bf16 v[104:119], v[220:223], v[212:215], v[104:119]
    ds_read_b128 v[176:179], v3 offset:16384
    ds_read_b128 v[180:183], v3 offset:18432
    ds_read_b64_tr_b16 v[200:201], v5 offset:6144
    ds_read_b64_tr_b16 v[202:203], v5 offset:6400
    v_mfma_f32_32x32x16_bf16 v[56:71], v[232:235], v[224:227], v[56:71]
    ds_read_b64_tr_b16 v[204:205], v5 offset:7168
    ds_read_b64_tr_b16 v[206:207], v5 offset:7424
    ds_read_b128 v[192:195], v4 offset:16384
    ds_read_b128 v[196:199], v4 offset:18432
    v_mfma_f32_32x32x16_bf16 v[72:87], v[232:235], v[228:231], v[72:87]
    v_mfma_f32_32x32x16_bf16 v[88:103], v[236:239], v[224:227], v[88:103]
    v_mfma_f32_32x32x16_bf16 v[104:119], v[236:239], v[228:231], v[104:119]
    s_add_u32 m0, s33, 24576
    s_nop 0
    buffer_load_dwordx4 v153, s[8:11], s31 offen lds
    s_add_u32 s31, s31, 57344
    s_add_u32 m0, s33, 30720
    s_nop 0
    buffer_load_dwordx4 v153, s[8:11], s31 offen lds
    s_add_u32 s31, s31, 57344
    s_waitcnt lgkmcnt(0)
    v_mfma_f32_32x32x16_bf16 v[56:71], v[184:187], v[176:179], v[56:71]
    v_mfma_f32_32x32x16_bf16 v[72:87], v[184:187], v[180:183], v[72:87]
    s_waitcnt vmcnt(2)
    s_barrier
    v_mfma_f32_32x32x16_bf16 v[88:103], v[188:191], v[176:179], v[88:103]
    ds_read_b64_tr_b16 v[216:217], v5 offset:12288
    ds_read_b64_tr_b16 v[218:219], v5 offset:12544
    ds_read_b64_tr_b16 v[220:221], v5 offset:13312
    ds_read_b64_tr_b16 v[222:223], v5 offset:13568
    v_mfma_f32_32x32x16_bf16 v[104:119], v[188:191], v[180:183], v[104:119]
    ds_read_b128 v[208:211], v3 offset:24576
    ds_read_b128 v[212:215], v3 offset:26624
    ds_read_b64_tr_b16 v[232:233], v5 offset:18432
    ds_read_b64_tr_b16 v[234:235], v5 offset:18688
    v_mfma_f32_32x32x16_bf16 v[56:71], v[200:203], v[192:195], v[56:71]
    ds_read_b64_tr_b16 v[236:237], v5 offset:19456
    ds_read_b64_tr_b16 v[238:239], v5 offset:19712
    ds_read_b128 v[224:227], v4 offset:24576
    ds_read_b128 v[228:231], v4 offset:26624
    v_mfma_f32_32x32x16_bf16 v[72:87], v[200:203], v[196:199], v[72:87]
    v_mfma_f32_32x32x16_bf16 v[88:103], v[204:207], v[192:195], v[88:103]
    v_mfma_f32_32x32x16_bf16 v[104:119], v[204:207], v[196:199], v[104:119]
    s_add_u32 m0, s33, 0
    s_nop 0
    buffer_load_dwordx4 v153, s[8:11], s31 offen lds
    s_add_u32 s31, s31, 57344
    s_add_u32 m0, s33, 6144
    s_nop 0
    buffer_load_dwordx4 v153, s[8:11], s31 offen lds
    s_add_u32 s31, s31, 57344
    s_waitcnt lgkmcnt(0)
    v_mfma_f32_32x32x16_bf16 v[56:71], v[216:219], v[208:211], v[56:71]
    v_mfma_f32_32x32x16_bf16 v[72:87], v[216:219], v[212:215], v[72:87]
    s_waitcnt vmcnt(2)
    s_barrier
    v_mfma_f32_32x32x16_bf16 v[88:103], v[220:223], v[208:211], v[88:103]
    v_add_u32 v3, 32768, v3
    v_add_u32 v4, 32768, v4
    ds_read_b64_tr_b16 v[184:185], v5 offset:24576
    ds_read_b64_tr_b16 v[186:187], v5 offset:24832
    ds_read_b64_tr_b16 v[188:189], v5 offset:25600
    v_mfma_f32_32x32x16_bf16 v[104:119], v[220:223], v[212:215], v[104:119]
    ds_read_b64_tr_b16 v[190:191], v5 offset:25856
    ds_read_b128 v[176:179], v3 offset:0
    ds_read_b128 v[180:183], v3 offset:2048
    ds_read_b64_tr_b16 v[200:201], v5 offset:30720
    ds_read_b64_tr_b16 v[202:203], v5 offset:30976
    v_mfma_f32_32x32x16_bf16 v[56:71], v[232:235], v[224:227], v[56:71]
    ds_read_b64_tr_b16 v[204:205], v5 offset:31744
    ds_read_b64_tr_b16 v[206:207], v5 offset:32000
    ds_read_b128 v[192:195], v4 offset:0
    ds_read_b128 v[196:199], v4 offset:2048
    v_mfma_f32_32x32x16_bf16 v[72:87], v[232:235], v[228:231], v[72:87]
    v_mfma_f32_32x32x16_bf16 v[88:103], v[236:239], v[224:227], v[88:103]
    v_mfma_f32_32x32x16_bf16 v[104:119], v[236:239], v[228:231], v[104:119]
    s_add_u32 m0, s33, 12288
    s_nop 0
    buffer_load_dwordx4 v153, s[8:11], s31 offen lds
    s_add_u32 s31, s31, 57344
    s_add_u32 m0, s33, 18432
    s_nop 0
    buffer_load_dwordx4 v153, s[8:11], s31 offen lds
    s_add_u32 s31, s31, 57344
    s_waitcnt lgkmcnt(0)
    v_mfma_f32_32x32x16_bf16 v[56:71], v[184:187], v[176:179], v[56:71]
    v_mfma_f32_32x32x16_bf16 v[72:87], v[184:187], v[180:183], v[72:87]
    s_waitcnt vmcnt(2)
    s_barrier
    v_mfma_f32_32x32x16_bf16 v[88:103], v[188:191], v[176:179], v[88:103]
    ds_read_b64_tr_b16 v[216:217], v5 offset:0
    ds_read_b64_tr_b16 v[218:219], v5 offset:256
    ds_read_b64_tr_b16 v[220:221], v5 offset:1024
    ds_read_b64_tr_b16 v[222:223], v5 offset:1280
    v_mfma_f32_32x32x16_bf16 v[104:119], v[188:191], v[180:183], v[104:119]
    ds_read_b128 v[208:211], v3 offset:8192
    ds_read_b128 v[212:215], v3 offset:10240
    ds_read_b64_tr_b16 v[232:233], v5 offset:6144
    ds_read_b64_tr_b16 v[234:235], v5 offset:6400
    v_mfma_f32_32x32x16_bf16 v[56:71], v[200:203], v[192:195], v[56:71]
    ds_read_b64_tr_b16 v[236:237], v5 offset:7168
    ds_read_b64_tr_b16 v[238:239], v5 offset:7424
    ds_read_b128 v[224:227], v4 offset:8192
    ds_read_b128 v[228:231], v4 offset:10240
    v_mfma_f32_32x32x16_bf16 v[72:87], v[200:203], v[196:199], v[72:87]
    v_mfma_f32_32x32x16_bf16 v[88:103], v[204:207], v[192:195], v[88:103]
    v_mfma_f32_32x32x16_bf16 v[104:119], v[204:207], v[196:199], v[104:119]
    s_add_u32 m0, s33, 24576
    s_nop 0
    buffer_load_dwordx4 v153, s[8:11], s31 offen lds
    s_add_u32 s31, s31, 57344
    s_add_u32 m0, s33, 30720
    s_nop 0
    buffer_load_dwordx4 v153, s[8:11], s31 offen lds
    s_add_u32 s31, s31, 57344
    s_waitcnt lgkmcnt(0)
    v_mfma_f32_32x32x16_bf16 v[56:71], v[216:219], v[208:211], v[56:71]
    v_mfma_f32_32x32x16_bf16 v[72:87], v[216:219], v[212:215], v[72:87]
    s_waitcnt vmcnt(2)
    s_barrier
    v_mfma_f32_32x32x16_bf16 v[88:103], v[220:223], v[208:211], v[88:103]
    ds_read_b64_tr_b16 v[184:185], v5 offset:12288
    ds_read_b64_tr_b16 v[186:187], v5 offset:12544
    ds_read_b64_tr_b16 v[188:189], v5 offset:13312
    ds_read_b64_tr_b16 v[190:191], v5 offset:13568
    v_mfma_f32_32x32x16_bf16 v[104:119], v[220:223], v[212:215], v[104:119]
    ds_read_b128 v[176:179], v3 offset:16384
    ds_read_b128 v[180:183], v3 offset:18432
    ds_read_b64_tr_b16 v[200:201], v5 offset:18432
    ds_read_b64_tr_b16 v[202:203], v5 offset:18688
    v_mfma_f32_32x32x16_bf16 v[56:71], v[232:235], v[224:227], v[56:71]
    ds_read_b64_tr_b16 v[204:205], v5 offset:19456
    ds_read_b64_tr_b16 v[206:207], v5 offset:19712
    ds_read_b128 v[192:195], v4 offset:16384
    ds_read_b128 v[196:199], v4 offset:18432
    v_mfma_f32_32x32x16_bf16 v[72:87], v[232:235], v[228:231], v[72:87]
    v_mfma_f32_32x32x16_bf16 v[88:103], v[236:239], v[224:227], v[88:103]
    v_mfma_f32_32x32x16_bf16 v[104:119], v[236:239], v[228:231], v[104:119]
    s_add_u32 m0, s33, 0
    s_nop 0
    buffer_load_dwordx4 v153, s[8:11], s31 offen lds
    s_add_u32 s31, s31, 57344
    s_add_u32 m0, s33, 6144
    s_nop 0
    buffer_load_dwordx4 v153, s[8:11], s31 offen lds
    s_add_u32 s31, s31, 57344
    s_waitcnt lgkmcnt(0)
    v_mfma_f32_32x32x16_bf16 v[56:71], v[184:187], v[176:179], v[56:71]
    v_mfma_f32_32x32x16_bf16 v[72:87], v[184:187], v[180:183], v[72:87]
    s_waitcnt vmcnt(2)
    s_barrier
    v_mfma_f32_32x32x16_bf16 v[88:103], v[188:191], v[176:179], v[88:103]
    ds_read_b64_tr_b16 v[216:217], v5 offset:24576
    ds_read_b64_tr_b16 v[218:219], v5 offset:24832
    ds_read_b64_tr_b16 v[220:221], v5 offset:25600
    ds_read_b64_tr_b16 v[222:223], v5 offset:25856
    v_mfma_f32_32x32x16_bf16 v[104:119], v[188:191], v[180:183], v[104:119]
    ds_read_b128 v[208:211], v3 offset:24576
    ds_read_b128 v[212:215], v3 offset:26624
    ds_read_b64_tr_b16 v[232:233], v5 offset:30720
    ds_read_b64_tr_b16 v[234:235], v5 offset:30976
    v_mfma_f32_32x32x16_bf16 v[56:71], v[200:203], v[192:195], v[56:71]
    ds_read_b64_tr_b16 v[236:237], v5 offset:31744
    ds_read_b64_tr_b16 v[238:239], v5 offset:32000
    ds_read_b128 v[224:227], v4 offset:24576
    ds_read_b128 v[228:231], v4 offset:26624
    v_mfma_f32_32x32x16_bf16 v[72:87], v[200:203], v[196:199], v[72:87]
    v_mfma_f32_32x32x16_bf16 v[88:103], v[204:207], v[192:195], v[88:103]
    v_mfma_f32_32x32x16_bf16 v[104:119], v[204:207], v[196:199], v[104:119]
    s_add_u32 m0, s33, 12288
    s_nop 0
    buffer_load_dwordx4 v153, s[8:11], s31 offen lds
    s_add_u32 s31, s31, 57344
    s_add_u32 m0, s33, 18432
    s_nop 0
    buffer_load_dwordx4 v153, s[8:11], s31 offen lds
    s_add_u32 s31, s31, 57344
    s_waitcnt lgkmcnt(0)
    v_mfma_f32_32x32x16_bf16 v[56:71], v[216:219], v[208:211], v[56:71]
    v_mfma_f32_32x32x16_bf16 v[72:87], v[216:219], v[212:215], v[72:87]
    s_waitcnt vmcnt(2)
    s_barrier
    v_mfma_f32_32x32x16_bf16 v[88:103], v[220:223], v[208:211], v[88:103]
    v_add_u32 v3, 32768, v3
    v_add_u32 v4, 32768, v4
    ds_read_b64_tr_b16 v[184:185], v5 offset:0
    ds_read_b64_tr_b16 v[186:187], v5 offset:256
    ds_read_b64_tr_b16 v[188:189], v5 offset:1024
    v_mfma_f32_32x32x16_bf16 v[104:119], v[220:223], v[212:215], v[104:119]
    ds_read_b64_tr_b16 v[190:191], v5 offset:1280
    ds_read_b128 v[176:179], v3 offset:0
    ds_read_b128 v[180:183], v3 offset:2048
    ds_read_b64_tr_b16 v[200:201], v5 offset:6144
    ds_read_b64_tr_b16 v[202:203], v5 offset:6400
    v_mfma_f32_32x32x16_bf16 v[56:71], v[232:235], v[224:227], v[56:71]
    ds_read_b64_tr_b16 v[204:205], v5 offset:7168
    ds_read_b64_tr_b16 v[206:207], v5 offset:7424
    ds_read_b128 v[192:195], v4 offset:0
    ds_read_b128 v[196:199], v4 offset:2048
    v_mfma_f32_32x32x16_bf16 v[72:87], v[232:235], v[228:231], v[72:87]
    v_mfma_f32_32x32x16_bf16 v[88:103], v[236:239], v[224:227], v[88:103]
    v_mfma_f32_32x32x16_bf16 v[104:119], v[236:239], v[228:231], v[104:119]
    s_waitcnt lgkmcnt(0)
    v_mfma_f32_32x32x16_bf16 v[56:71], v[184:187], v[176:179], v[56:71]
    v_mfma_f32_32x32x16_bf16 v[72:87], v[184:187], v[180:183], v[72:87]
    s_waitcnt vmcnt(0)
    s_barrier
    v_mfma_f32_32x32x16_bf16 v[88:103], v[188:191], v[176:179], v[88:103]
    ds_read_b64_tr_b16 v[216:217], v5 offset:12288
    ds_read_b64_tr_b16 v[218:219], v5 offset:12544
    ds_read_b64_tr_b16 v[220:221], v5 offset:13312
    ds_read_b64_tr_b16 v[222:223], v5 offset:13568
    v_mfma_f32_32x32x16_bf16 v[104:119], v[188:191], v[180:183], v[104:119]
    ds_read_b128 v[208:211], v3 offset:8192
    ds_read_b128 v[212:215], v3 offset:10240
    ds_read_b64_tr_b16 v[232:233], v5 offset:18432
    ds_read_b64_tr_b16 v[234:235], v5 offset:18688
    v_mfma_f32_32x32x16_bf16 v[56:71], v[200:203], v[192:195], v[56:71]
    ds_read_b64_tr_b16 v[236:237], v5 offset:19456
    ds_read_b64_tr_b16 v[238:239], v5 offset:19712
    ds_read_b128 v[224:227], v4 offset:8192
    ds_read_b128 v[228:231], v4 offset:10240
    v_mfma_f32_32x32x16_bf16 v[72:87], v[200:203], v[196:199], v[72:87]
    v_mfma_f32_32x32x16_bf16 v[88:103], v[204:207], v[192:195], v[88:103]
    v_mfma_f32_32x32x16_bf16 v[104:119], v[204:207], v[196:199], v[104:119]
    s_waitcnt lgkmcnt(0)
    v_mfma_f32_32x32x16_bf16 v[56:71], v[216:219], v[208:211], v[56:71]
    v_mfma_f32_32x32x16_bf16 v[72:87], v[216:219], v[212:215], v[72:87]
    v_mfma_f32_32x32x16_bf16 v[88:103], v[220:223], v[208:211], v[88:103]
    v_mfma_f32_32x32x16_bf16 v[104:119], v[220:223], v[212:215], v[104:119]
    v_mfma_f32_32x32x16_bf16 v[56:71], v[232:235], v[224:227], v[56:71]
    v_mfma_f32_32x32x16_bf16 v[72:87], v[232:235], v[228:231], v[72:87]
    v_mfma_f32_32x32x16_bf16 v[88:103], v[236:239], v[224:227], v[88:103]
    v_mfma_f32_32x32x16_bf16 v[104:119], v[236:239], v[228:231], v[104:119]
    s_barrier
    s_nop 10
    s_and_b32 s24, s2, 7
    s_lshr_b32 s25, s2, 3
    s_and_b32 s16, s25, 1
    s_lshl_b32 s24, s24, 1
    s_add_u32 s16, s16, s24
    s_lshr_b32 s17, s25, 1
    s_mov_b32 s30, 0
    s_mov_b32 s31, -1
    s_lshl_b32 s24, s16, 6
    s_lshl_b32 s25, s17, 2
    s_add_u32 s50, s24, s25
    s_lshl_b32 s50, s50, 11
    s_lshl_b32 s26, s24, 11
    s_add_u32 s26, s26, 2097152
    s_lshl_b32 s25, s3, 15
    s_add_u32 s27, s26, s25
    s_add_u32 s18, s27, 2097152
    s_mov_b32 s4, s70
    s_and_b32 s5, s71, 0xffff
    s_mov_b32 s6, 33554432
    s_mov_b32 s7, 0x20000
    s_mov_b32 s8, s70
    s_and_b32 s9, s71, 0xffff
    s_mov_b32 s10, 0
    s_mov_b32 s11, 0x20000
    s_mov_b32 s12, s70
    s_and_b32 s13, s71, 0xffff
    s_mov_b32 s14, 0
    s_mov_b32 s15, 0x20000
    s_add_u32 s10, s27, 32768
    s_add_u32 s14, s18, 32768
    s_mov_b32 s29, 0
    v_and_b32 v5, 15, v1
    s_and_b32 s24, s16, 0xfffe
    v_bfe_u32 v6, v1, 4, 1
    v_add_u32 v6, s24, v6
    v_lshrrev_b32 v7, 3, v5
    v_lshrrev_b32 v9, 2, v6
    v_lshl_add_u32 v7, v9, 1, v7
    v_and_b32 v9, 7, v5
    v_lshl_add_u32 v7, v9, 3, v7
    v_and_b32 v9, 1, v6
    v_lshl_add_u32 v7, v9, 7, v7
    v_bfe_u32 v9, v6, 1, 1
    v_lshl_add_u32 v7, v9, 6, v7
    v_lshlrev_b32 v7, 6, v7
    v_add_u32 v7, 25296896, v7
    buffer_load_dword v220, v7, s[4:7], 0 offen sc0 sc1
    v_mov_b32 v221, v7
    s_mov_b32 s36, 0xbfb8aa3b
    v_mul_f32 v16, s36, v56
    v_mul_f32 v17, s36, v57
    v_mul_f32 v18, s36, v58
    v_mul_f32 v19, s36, v59
    v_exp_f32 v16, v16
    v_exp_f32 v17, v17
    v_exp_f32 v18, v18
    v_exp_f32 v19, v19
    v_mul_f32 v56, v56, v88
    v_mul_f32 v57, v57, v89
    v_mul_f32 v58, v58, v90
    v_mul_f32 v59, v59, v91
    v_add_f32 v16, 1.0, v16
    v_add_f32 v17, 1.0, v17
    v_add_f32 v18, 1.0, v18
    v_add_f32 v19, 1.0, v19
    v_rcp_f32 v16, v16
    v_rcp_f32 v17, v17
    v_rcp_f32 v18, v18
    v_rcp_f32 v19, v19
    s_nop 0
    v_mul_f32 v56, v56, v16
    v_mul_f32 v57, v57, v17
    v_mul_f32 v58, v58, v18
    v_mul_f32 v59, v59, v19
    v_mul_f32 v16, s36, v60
    v_mul_f32 v17, s36, v61
    v_mul_f32 v18, s36, v62
    v_mul_f32 v19, s36, v63
    v_exp_f32 v16, v16
    v_exp_f32 v17, v17
    v_exp_f32 v18, v18
    v_exp_f32 v19, v19
    v_mul_f32 v60, v60, v92
    v_mul_f32 v61, v61, v93
    v_mul_f32 v62, v62, v94
    v_mul_f32 v63, v63, v95
    v_add_f32 v16, 1.0, v16
    v_add_f32 v17, 1.0, v17
    v_add_f32 v18, 1.0, v18
    v_add_f32 v19, 1.0, v19
    v_rcp_f32 v16, v16
    v_rcp_f32 v17, v17
    v_rcp_f32 v18, v18
    v_rcp_f32 v19, v19
    s_nop 0
    v_mul_f32 v60, v60, v16
    v_mul_f32 v61, v61, v17
    v_mul_f32 v62, v62, v18
    v_mul_f32 v63, v63, v19
    v_mul_f32 v16, s36, v64
    v_mul_f32 v17, s36, v65
    v_mul_f32 v18, s36, v66
    v_mul_f32 v19, s36, v67
    v_exp_f32 v16, v16
    v_exp_f32 v17, v17
    v_exp_f32 v18, v18
    v_exp_f32 v19, v19
    v_mul_f32 v64, v64, v96
    v_mul_f32 v65, v65, v97
    v_mul_f32 v66, v66, v98
    v_mul_f32 v67, v67, v99
    v_add_f32 v16, 1.0, v16
    v_add_f32 v17, 1.0, v17
    v_add_f32 v18, 1.0, v18
    v_add_f32 v19, 1.0, v19
    v_rcp_f32 v16, v16
    v_rcp_f32 v17, v17
    v_rcp_f32 v18, v18
    v_rcp_f32 v19, v19
    s_nop 0
    v_mul_f32 v64, v64, v16
    v_mul_f32 v65, v65, v17
    v_mul_f32 v66, v66, v18
    v_mul_f32 v67, v67, v19
    v_mul_f32 v16, s36, v68
    v_mul_f32 v17, s36, v69
    v_mul_f32 v18, s36, v70
    v_mul_f32 v19, s36, v71
    v_exp_f32 v16, v16
    v_exp_f32 v17, v17
    v_exp_f32 v18, v18
    v_exp_f32 v19, v19
    v_mul_f32 v68, v68, v100
    v_mul_f32 v69, v69, v101
    v_mul_f32 v70, v70, v102
    v_mul_f32 v71, v71, v103
    v_add_f32 v16, 1.0, v16
    v_add_f32 v17, 1.0, v17
    v_add_f32 v18, 1.0, v18
    v_add_f32 v19, 1.0, v19
    v_rcp_f32 v16, v16
    v_rcp_f32 v17, v17
    v_rcp_f32 v18, v18
    v_rcp_f32 v19, v19
    s_nop 0
    v_mul_f32 v68, v68, v16
    v_mul_f32 v69, v69, v17
    v_mul_f32 v70, v70, v18
    v_mul_f32 v71, v71, v19
    v_cvt_pk_bf16_f32 v88, v56, v57
    v_cvt_pk_bf16_f32 v89, v58, v59
    v_cvt_pk_bf16_f32 v90, v60, v61
    v_cvt_pk_bf16_f32 v91, v62, v63
    v_cvt_pk_bf16_f32 v92, v64, v65
    v_cvt_pk_bf16_f32 v93, v66, v67
    v_cvt_pk_bf16_f32 v94, v68, v69
    v_cvt_pk_bf16_f32 v95, v70, v71
    s_waitcnt vmcnt(0)
    v_cmp_ne_u32 vcc, s74, v220
    s_nop 3
    s_cmp_eq_u64 vcc, 0
    s_cbranch_scc1 parallel_sum__softmax_full_mha__swiglu_ffn__prompt_kernel_qok_9
    s_add_u32 s37, s74, 0
    s_mov_b32 s36, 524288
    s_mov_b32 s68, 0xffffffff
    s_mov_b32 s69, 0xffffffff
parallel_sum__softmax_full_mha__swiglu_ffn__prompt_kernel_poll_10:
    buffer_load_dword v220, v221, s[4:7], 0 offen sc0 sc1
    s_waitcnt vmcnt(0)
    v_cmp_ne_u32 vcc, s37, v220
    s_nop 3
    s_and_b64 vcc, vcc, s[68:69]
    s_sub_u32 s36, s36, 1
    s_cmp_eq_u32 s36, 0
    s_cbranch_scc1 parallel_sum__softmax_full_mha__swiglu_ffn__prompt_kernel_pollx_11
    s_cmp_lg_u64 vcc, 0
    s_cbranch_scc0 parallel_sum__softmax_full_mha__swiglu_ffn__prompt_kernel_pollx_11
    s_sleep 1
    s_branch parallel_sum__softmax_full_mha__swiglu_ffn__prompt_kernel_poll_10
parallel_sum__softmax_full_mha__swiglu_ffn__prompt_kernel_pollx_11:
parallel_sum__softmax_full_mha__swiglu_ffn__prompt_kernel_qok_9:
    buffer_load_dwordx4 v[120:123], v2, s[4:7], s50 offen offset:0 sc1
    buffer_load_dwordx4 v[124:127], v2, s[4:7], s50 offen offset:1024 sc1
    buffer_load_dwordx4 v[128:131], v2, s[4:7], s50 offen offset:2048 sc1
    buffer_load_dwordx4 v[132:135], v2, s[4:7], s50 offen offset:3072 sc1
    s_add_u32 s24, s50, 4096
    buffer_load_dwordx4 v[136:139], v2, s[4:7], s24 offen offset:0 sc1
    buffer_load_dwordx4 v[140:143], v2, s[4:7], s24 offen offset:1024 sc1
    buffer_load_dwordx4 v[144:147], v2, s[4:7], s24 offen offset:2048 sc1
    buffer_load_dwordx4 v[148:151], v2, s[4:7], s24 offen offset:3072 sc1
    buffer_load_dwordx4 v[200:203], v2, s[4:7], s26 offen sc1
    buffer_load_dwordx4 v[204:207], v2, s[4:7], s26 offen offset:1024 sc1
    s_mov_b32 s36, 0xbfb8aa3b
    v_mul_f32 v16, s36, v72
    v_mul_f32 v17, s36, v73
    v_mul_f32 v18, s36, v74
    v_mul_f32 v19, s36, v75
    v_exp_f32 v16, v16
    v_exp_f32 v17, v17
    v_exp_f32 v18, v18
    v_exp_f32 v19, v19
    v_mul_f32 v72, v72, v104
    v_mul_f32 v73, v73, v105
    v_mul_f32 v74, v74, v106
    v_mul_f32 v75, v75, v107
    v_add_f32 v16, 1.0, v16
    v_add_f32 v17, 1.0, v17
    v_add_f32 v18, 1.0, v18
    v_add_f32 v19, 1.0, v19
    v_rcp_f32 v16, v16
    v_rcp_f32 v17, v17
    v_rcp_f32 v18, v18
    v_rcp_f32 v19, v19
    s_nop 0
    v_mul_f32 v72, v72, v16
    v_mul_f32 v73, v73, v17
    v_mul_f32 v74, v74, v18
    v_mul_f32 v75, v75, v19
    v_mul_f32 v16, s36, v76
    v_mul_f32 v17, s36, v77
    v_mul_f32 v18, s36, v78
    v_mul_f32 v19, s36, v79
    v_exp_f32 v16, v16
    v_exp_f32 v17, v17
    v_exp_f32 v18, v18
    v_exp_f32 v19, v19
    v_mul_f32 v76, v76, v108
    v_mul_f32 v77, v77, v109
    v_mul_f32 v78, v78, v110
    v_mul_f32 v79, v79, v111
    v_add_f32 v16, 1.0, v16
    v_add_f32 v17, 1.0, v17
    v_add_f32 v18, 1.0, v18
    v_add_f32 v19, 1.0, v19
    v_rcp_f32 v16, v16
    v_rcp_f32 v17, v17
    v_rcp_f32 v18, v18
    v_rcp_f32 v19, v19
    s_nop 0
    v_mul_f32 v76, v76, v16
    v_mul_f32 v77, v77, v17
    v_mul_f32 v78, v78, v18
    v_mul_f32 v79, v79, v19
    v_mul_f32 v16, s36, v80
    v_mul_f32 v17, s36, v81
    v_mul_f32 v18, s36, v82
    v_mul_f32 v19, s36, v83
    v_exp_f32 v16, v16
    v_exp_f32 v17, v17
    v_exp_f32 v18, v18
    v_exp_f32 v19, v19
    v_mul_f32 v80, v80, v112
    v_mul_f32 v81, v81, v113
    v_mul_f32 v82, v82, v114
    v_mul_f32 v83, v83, v115
    v_add_f32 v16, 1.0, v16
    v_add_f32 v17, 1.0, v17
    v_add_f32 v18, 1.0, v18
    v_add_f32 v19, 1.0, v19
    v_rcp_f32 v16, v16
    v_rcp_f32 v17, v17
    v_rcp_f32 v18, v18
    v_rcp_f32 v19, v19
    s_nop 0
    v_mul_f32 v80, v80, v16
    v_mul_f32 v81, v81, v17
    v_mul_f32 v82, v82, v18
    v_mul_f32 v83, v83, v19
    v_mul_f32 v16, s36, v84
    v_mul_f32 v17, s36, v85
    v_mul_f32 v18, s36, v86
    v_mul_f32 v19, s36, v87
    v_exp_f32 v16, v16
    v_exp_f32 v17, v17
    v_exp_f32 v18, v18
    v_exp_f32 v19, v19
    v_mul_f32 v84, v84, v116
    v_mul_f32 v85, v85, v117
    v_mul_f32 v86, v86, v118
    v_mul_f32 v87, v87, v119
    v_add_f32 v16, 1.0, v16
    v_add_f32 v17, 1.0, v17
    v_add_f32 v18, 1.0, v18
    v_add_f32 v19, 1.0, v19
    v_rcp_f32 v16, v16
    v_rcp_f32 v17, v17
    v_rcp_f32 v18, v18
    v_rcp_f32 v19, v19
    s_nop 0
    v_mul_f32 v84, v84, v16
    v_mul_f32 v85, v85, v17
    v_mul_f32 v86, v86, v18
    v_mul_f32 v87, v87, v19
    v_cvt_pk_bf16_f32 v104, v72, v73
    v_cvt_pk_bf16_f32 v105, v74, v75
    v_cvt_pk_bf16_f32 v106, v76, v77
    v_cvt_pk_bf16_f32 v107, v78, v79
    v_cvt_pk_bf16_f32 v108, v80, v81
    v_cvt_pk_bf16_f32 v109, v82, v83
    v_cvt_pk_bf16_f32 v110, v84, v85
    v_cvt_pk_bf16_f32 v111, v86, v87
    s_mul_i32 s35, s43, 144
    s_add_u32 s35, s35, s45
    s_lshl_b32 s35, s35, 10
    s_add_u32 s35, s35, 6291456
    buffer_store_dwordx4 v[88:91], v2, s[20:23], s35 offen sc0 sc1
    buffer_store_dwordx4 v[92:95], v2, s[20:23], s35 offen offset:1024 sc0 sc1
    s_mul_i32 s35, s44, 144
    s_add_u32 s35, s35, s45
    s_lshl_b32 s35, s35, 10
    s_add_u32 s35, s35, 6291456
    buffer_store_dwordx4 v[104:107], v2, s[20:23], s35 offen sc0 sc1
    buffer_store_dwordx4 v[108:111], v2, s[20:23], s35 offen offset:1024 sc0 sc1
    s_mov_b32 s48, s27
    s_mov_b32 s49, s18
    buffer_load_dwordx4 v[152:155], v2, s[8:11], s48 offen sc1
    buffer_load_dwordx4 v[156:159], v2, s[8:11], s48 offen offset:1024 sc1
    buffer_load_dwordx4 v[160:163], v2, s[12:15], s49 offen sc1
    buffer_load_dwordx4 v[164:167], v2, s[12:15], s49 offen offset:1024 sc1
    s_add_u32 s48, s48, 2048
    s_add_u32 s49, s49, 2048
    buffer_load_dwordx4 v[168:171], v2, s[8:11], s48 offen sc1
    buffer_load_dwordx4 v[172:175], v2, s[8:11], s48 offen offset:1024 sc1
    buffer_load_dwordx4 v[176:179], v2, s[12:15], s49 offen sc1
    buffer_load_dwordx4 v[180:183], v2, s[12:15], s49 offen offset:1024 sc1
    s_add_u32 s48, s48, 2048
    s_add_u32 s49, s49, 2048
    buffer_load_dwordx4 v[184:187], v2, s[8:11], s48 offen sc1
    buffer_load_dwordx4 v[188:191], v2, s[8:11], s48 offen offset:1024 sc1
    buffer_load_dwordx4 v[192:195], v2, s[12:15], s49 offen sc1
    buffer_load_dwordx4 v[196:199], v2, s[12:15], s49 offen offset:1024 sc1
    s_add_u32 s48, s48, 2048
    s_add_u32 s49, s49, 2048
    s_branch parallel_sum__softmax_full_mha__swiglu_ffn__prompt_kernel_phaseB_attn
parallel_sum__softmax_full_mha__swiglu_ffn__prompt_kernel_VQ0:
    s_waitcnt vmcnt(17) lgkmcnt(0)
    s_barrier
    ds_read_b64_tr_b16 v[24:25], v154 offset:0
    ds_read_b64_tr_b16 v[26:27], v154 offset:512
    ds_read_b64_tr_b16 v[28:29], v163 offset:0
    ds_read_b64_tr_b16 v[30:31], v163 offset:512
    ds_read_b128 v[16:19], v3 offset:0
    ds_read_b128 v[20:23], v3 offset:2048
    ds_read_b64_tr_b16 v[40:41], v154 offset:4096
    ds_read_b64_tr_b16 v[42:43], v154 offset:4608
    ds_read_b64_tr_b16 v[44:45], v163 offset:4096
    ds_read_b64_tr_b16 v[46:47], v163 offset:4608
    ds_read_b128 v[32:35], v4 offset:0
    ds_read_b128 v[36:39], v4 offset:2048
    s_mov_b32 s52, s72
    s_and_b32 s53, s73, 0xffff
    s_mov_b32 s54, 256
    s_mov_b32 s55, 0x20000
    buffer_load_dword v156, v158, s[52:55], 0 offen sc0 sc1
    s_waitcnt lgkmcnt(0)
    v_mfma_f32_32x32x16_bf16 v[56:71], v[24:27], v[16:19], 0
    v_mfma_f32_32x32x16_bf16 v[72:87], v[24:27], v[20:23], 0
    s_waitcnt vmcnt(16)
    s_barrier
    v_mfma_f32_32x32x16_bf16 v[88:103], v[28:31], v[16:19], 0
    ds_read_b64_tr_b16 v[224:225], v154 offset:8192
    ds_read_b64_tr_b16 v[226:227], v154 offset:8704
    ds_read_b64_tr_b16 v[228:229], v163 offset:8192
    ds_read_b64_tr_b16 v[230:231], v163 offset:8704
    v_mfma_f32_32x32x16_bf16 v[104:119], v[28:31], v[20:23], 0
    ds_read_b128 v[216:219], v3 offset:8192
    ds_read_b128 v[220:223], v3 offset:10240
    ds_read_b64_tr_b16 v[240:241], v154 offset:12288
    ds_read_b64_tr_b16 v[242:243], v154 offset:12800
    v_mfma_f32_32x32x16_bf16 v[56:71], v[40:43], v[32:35], v[56:71]
    ds_read_b64_tr_b16 v[244:245], v163 offset:12288
    ds_read_b64_tr_b16 v[246:247], v163 offset:12800
    ds_read_b128 v[232:235], v4 offset:8192
    ds_read_b128 v[236:239], v4 offset:10240
    v_mfma_f32_32x32x16_bf16 v[72:87], v[40:43], v[36:39], v[72:87]
    v_mfma_f32_32x32x16_bf16 v[88:103], v[44:47], v[32:35], v[88:103]
    v_mfma_f32_32x32x16_bf16 v[104:119], v[44:47], v[36:39], v[104:119]
    s_waitcnt lgkmcnt(0)
    v_mfma_f32_32x32x16_bf16 v[56:71], v[224:227], v[216:219], v[56:71]
    v_mfma_f32_32x32x16_bf16 v[72:87], v[224:227], v[220:223], v[72:87]
    s_waitcnt vmcnt(14)
    s_barrier
    v_mfma_f32_32x32x16_bf16 v[88:103], v[228:231], v[216:219], v[88:103]
    ds_read_b64_tr_b16 v[24:25], v154 offset:16384
    ds_read_b64_tr_b16 v[26:27], v154 offset:16896
    ds_read_b64_tr_b16 v[28:29], v163 offset:16384
    ds_read_b64_tr_b16 v[30:31], v163 offset:16896
    v_mfma_f32_32x32x16_bf16 v[104:119], v[228:231], v[220:223], v[104:119]
    ds_read_b128 v[16:19], v3 offset:16384
    ds_read_b128 v[20:23], v3 offset:18432
    ds_read_b64_tr_b16 v[40:41], v154 offset:20480
    ds_read_b64_tr_b16 v[42:43], v154 offset:20992
    v_mfma_f32_32x32x16_bf16 v[56:71], v[240:243], v[232:235], v[56:71]
    ds_read_b64_tr_b16 v[44:45], v163 offset:20480
    ds_read_b64_tr_b16 v[46:47], v163 offset:20992
    ds_read_b128 v[32:35], v4 offset:16384
    ds_read_b128 v[36:39], v4 offset:18432
    v_mfma_f32_32x32x16_bf16 v[72:87], v[240:243], v[236:239], v[72:87]
    v_mfma_f32_32x32x16_bf16 v[88:103], v[244:247], v[232:235], v[88:103]
    v_mfma_f32_32x32x16_bf16 v[104:119], v[244:247], v[236:239], v[104:119]
    s_waitcnt lgkmcnt(0)
    v_mfma_f32_32x32x16_bf16 v[56:71], v[24:27], v[16:19], v[56:71]
    v_mfma_f32_32x32x16_bf16 v[72:87], v[24:27], v[20:23], v[72:87]
    s_waitcnt vmcnt(12)
    s_barrier
    v_mfma_f32_32x32x16_bf16 v[88:103], v[28:31], v[16:19], v[88:103]
    ds_read_b64_tr_b16 v[224:225], v154 offset:24576
    ds_read_b64_tr_b16 v[226:227], v154 offset:25088
    ds_read_b64_tr_b16 v[228:229], v163 offset:24576
    ds_read_b64_tr_b16 v[230:231], v163 offset:25088
    v_mfma_f32_32x32x16_bf16 v[104:119], v[28:31], v[20:23], v[104:119]
    ds_read_b128 v[216:219], v3 offset:24576
    ds_read_b128 v[220:223], v3 offset:26624
    ds_read_b64_tr_b16 v[240:241], v154 offset:28672
    ds_read_b64_tr_b16 v[242:243], v154 offset:29184
    v_mfma_f32_32x32x16_bf16 v[56:71], v[40:43], v[32:35], v[56:71]
    ds_read_b64_tr_b16 v[244:245], v163 offset:28672
    ds_read_b64_tr_b16 v[246:247], v163 offset:29184
    ds_read_b128 v[232:235], v4 offset:24576
    ds_read_b128 v[236:239], v4 offset:26624
    v_mfma_f32_32x32x16_bf16 v[72:87], v[40:43], v[36:39], v[72:87]
    v_mfma_f32_32x32x16_bf16 v[88:103], v[44:47], v[32:35], v[88:103]
    v_mfma_f32_32x32x16_bf16 v[104:119], v[44:47], v[36:39], v[104:119]
    s_waitcnt lgkmcnt(0)
    v_mfma_f32_32x32x16_bf16 v[56:71], v[224:227], v[216:219], v[56:71]
    v_mfma_f32_32x32x16_bf16 v[72:87], v[224:227], v[220:223], v[72:87]
    s_waitcnt vmcnt(20)
    s_barrier
    v_mfma_f32_32x32x16_bf16 v[88:103], v[228:231], v[216:219], v[88:103]
    v_add_u32 v3, 32768, v3
    v_add_u32 v4, 32768, v4
    ds_read_b64_tr_b16 v[24:25], v154 offset:32768
    ds_read_b64_tr_b16 v[26:27], v154 offset:33280
    ds_read_b64_tr_b16 v[28:29], v163 offset:32768
    v_mfma_f32_32x32x16_bf16 v[104:119], v[228:231], v[220:223], v[104:119]
    ds_read_b64_tr_b16 v[30:31], v163 offset:33280
    ds_read_b128 v[16:19], v3 offset:0
    ds_read_b128 v[20:23], v3 offset:2048
    ds_read_b64_tr_b16 v[40:41], v154 offset:36864
    ds_read_b64_tr_b16 v[42:43], v154 offset:37376
    v_mfma_f32_32x32x16_bf16 v[56:71], v[240:243], v[232:235], v[56:71]
    ds_read_b64_tr_b16 v[44:45], v163 offset:36864
    ds_read_b64_tr_b16 v[46:47], v163 offset:37376
    ds_read_b128 v[32:35], v4 offset:0
    ds_read_b128 v[36:39], v4 offset:2048
    v_mfma_f32_32x32x16_bf16 v[72:87], v[240:243], v[236:239], v[72:87]
    v_mfma_f32_32x32x16_bf16 v[88:103], v[244:247], v[232:235], v[88:103]
    v_mfma_f32_32x32x16_bf16 v[104:119], v[244:247], v[236:239], v[104:119]
    s_waitcnt lgkmcnt(0)
    v_mfma_f32_32x32x16_bf16 v[56:71], v[24:27], v[16:19], v[56:71]
    v_mfma_f32_32x32x16_bf16 v[72:87], v[24:27], v[20:23], v[72:87]
    s_waitcnt vmcnt(20)
    s_barrier
    v_mfma_f32_32x32x16_bf16 v[88:103], v[28:31], v[16:19], v[88:103]
    ds_read_b64_tr_b16 v[224:225], v154 offset:0
    ds_read_b64_tr_b16 v[226:227], v154 offset:512
    ds_read_b64_tr_b16 v[228:229], v163 offset:0
    ds_read_b64_tr_b16 v[230:231], v163 offset:512
    v_mfma_f32_32x32x16_bf16 v[104:119], v[28:31], v[20:23], v[104:119]
    ds_read_b128 v[216:219], v3 offset:8192
    ds_read_b128 v[220:223], v3 offset:10240
    ds_read_b64_tr_b16 v[240:241], v154 offset:4096
    ds_read_b64_tr_b16 v[242:243], v154 offset:4608
    v_mfma_f32_32x32x16_bf16 v[56:71], v[40:43], v[32:35], v[56:71]
    ds_read_b64_tr_b16 v[244:245], v163 offset:4096
    ds_read_b64_tr_b16 v[246:247], v163 offset:4608
    ds_read_b128 v[232:235], v4 offset:8192
    ds_read_b128 v[236:239], v4 offset:10240
    v_mfma_f32_32x32x16_bf16 v[72:87], v[40:43], v[36:39], v[72:87]
    v_mfma_f32_32x32x16_bf16 v[88:103], v[44:47], v[32:35], v[88:103]
    v_mfma_f32_32x32x16_bf16 v[104:119], v[44:47], v[36:39], v[104:119]
    s_waitcnt lgkmcnt(0)
    v_mfma_f32_32x32x16_bf16 v[56:71], v[224:227], v[216:219], v[56:71]
    v_mfma_f32_32x32x16_bf16 v[72:87], v[224:227], v[220:223], v[72:87]
    s_waitcnt vmcnt(20)
    s_barrier
    v_mfma_f32_32x32x16_bf16 v[88:103], v[228:231], v[216:219], v[88:103]
    ds_read_b64_tr_b16 v[24:25], v154 offset:8192
    ds_read_b64_tr_b16 v[26:27], v154 offset:8704
    ds_read_b64_tr_b16 v[28:29], v163 offset:8192
    ds_read_b64_tr_b16 v[30:31], v163 offset:8704
    v_mfma_f32_32x32x16_bf16 v[104:119], v[228:231], v[220:223], v[104:119]
    ds_read_b128 v[16:19], v3 offset:16384
    ds_read_b128 v[20:23], v3 offset:18432
    ds_read_b64_tr_b16 v[40:41], v154 offset:12288
    ds_read_b64_tr_b16 v[42:43], v154 offset:12800
    v_mfma_f32_32x32x16_bf16 v[56:71], v[240:243], v[232:235], v[56:71]
    ds_read_b64_tr_b16 v[44:45], v163 offset:12288
    ds_read_b64_tr_b16 v[46:47], v163 offset:12800
    ds_read_b128 v[32:35], v4 offset:16384
    ds_read_b128 v[36:39], v4 offset:18432
    v_mfma_f32_32x32x16_bf16 v[72:87], v[240:243], v[236:239], v[72:87]
    v_mfma_f32_32x32x16_bf16 v[88:103], v[244:247], v[232:235], v[88:103]
    v_mfma_f32_32x32x16_bf16 v[104:119], v[244:247], v[236:239], v[104:119]
    s_waitcnt lgkmcnt(0)
    v_mfma_f32_32x32x16_bf16 v[56:71], v[24:27], v[16:19], v[56:71]
    v_mfma_f32_32x32x16_bf16 v[72:87], v[24:27], v[20:23], v[72:87]
    s_waitcnt vmcnt(20)
    s_barrier
    v_mfma_f32_32x32x16_bf16 v[88:103], v[28:31], v[16:19], v[88:103]
    ds_read_b64_tr_b16 v[224:225], v154 offset:16384
    ds_read_b64_tr_b16 v[226:227], v154 offset:16896
    ds_read_b64_tr_b16 v[228:229], v163 offset:16384
    ds_read_b64_tr_b16 v[230:231], v163 offset:16896
    v_mfma_f32_32x32x16_bf16 v[104:119], v[28:31], v[20:23], v[104:119]
    ds_read_b128 v[216:219], v3 offset:24576
    ds_read_b128 v[220:223], v3 offset:26624
    ds_read_b64_tr_b16 v[240:241], v154 offset:20480
    ds_read_b64_tr_b16 v[242:243], v154 offset:20992
    v_mfma_f32_32x32x16_bf16 v[56:71], v[40:43], v[32:35], v[56:71]
    ds_read_b64_tr_b16 v[244:245], v163 offset:20480
    ds_read_b64_tr_b16 v[246:247], v163 offset:20992
    ds_read_b128 v[232:235], v4 offset:24576
    ds_read_b128 v[236:239], v4 offset:26624
    v_mfma_f32_32x32x16_bf16 v[72:87], v[40:43], v[36:39], v[72:87]
    v_mfma_f32_32x32x16_bf16 v[88:103], v[44:47], v[32:35], v[88:103]
    v_mfma_f32_32x32x16_bf16 v[104:119], v[44:47], v[36:39], v[104:119]
    s_waitcnt lgkmcnt(0)
    v_mfma_f32_32x32x16_bf16 v[56:71], v[224:227], v[216:219], v[56:71]
    v_mfma_f32_32x32x16_bf16 v[72:87], v[224:227], v[220:223], v[72:87]
    s_waitcnt vmcnt(20)
    s_barrier
    v_mfma_f32_32x32x16_bf16 v[88:103], v[228:231], v[216:219], v[88:103]
    v_add_u32 v3, 32768, v3
    v_add_u32 v4, 32768, v4
    ds_read_b64_tr_b16 v[24:25], v154 offset:24576
    ds_read_b64_tr_b16 v[26:27], v154 offset:25088
    ds_read_b64_tr_b16 v[28:29], v163 offset:24576
    v_mfma_f32_32x32x16_bf16 v[104:119], v[228:231], v[220:223], v[104:119]
    ds_read_b64_tr_b16 v[30:31], v163 offset:25088
    ds_read_b128 v[16:19], v3 offset:0
    ds_read_b128 v[20:23], v3 offset:2048
    ds_read_b64_tr_b16 v[40:41], v154 offset:28672
    ds_read_b64_tr_b16 v[42:43], v154 offset:29184
    v_mfma_f32_32x32x16_bf16 v[56:71], v[240:243], v[232:235], v[56:71]
    ds_read_b64_tr_b16 v[44:45], v163 offset:28672
    ds_read_b64_tr_b16 v[46:47], v163 offset:29184
    ds_read_b128 v[32:35], v4 offset:0
    ds_read_b128 v[36:39], v4 offset:2048
    v_mfma_f32_32x32x16_bf16 v[72:87], v[240:243], v[236:239], v[72:87]
    v_mfma_f32_32x32x16_bf16 v[88:103], v[244:247], v[232:235], v[88:103]
    v_mfma_f32_32x32x16_bf16 v[104:119], v[244:247], v[236:239], v[104:119]
    s_waitcnt lgkmcnt(0)
    v_mfma_f32_32x32x16_bf16 v[56:71], v[24:27], v[16:19], v[56:71]
    v_mfma_f32_32x32x16_bf16 v[72:87], v[24:27], v[20:23], v[72:87]
    s_waitcnt vmcnt(20)
    s_barrier
    v_mfma_f32_32x32x16_bf16 v[88:103], v[28:31], v[16:19], v[88:103]
    ds_read_b64_tr_b16 v[224:225], v154 offset:32768
    ds_read_b64_tr_b16 v[226:227], v154 offset:33280
    ds_read_b64_tr_b16 v[228:229], v163 offset:32768
    ds_read_b64_tr_b16 v[230:231], v163 offset:33280
    v_mfma_f32_32x32x16_bf16 v[104:119], v[28:31], v[20:23], v[104:119]
    ds_read_b128 v[216:219], v3 offset:8192
    ds_read_b128 v[220:223], v3 offset:10240
    ds_read_b64_tr_b16 v[240:241], v154 offset:36864
    ds_read_b64_tr_b16 v[242:243], v154 offset:37376
    v_mfma_f32_32x32x16_bf16 v[56:71], v[40:43], v[32:35], v[56:71]
    ds_read_b64_tr_b16 v[244:245], v163 offset:36864
    ds_read_b64_tr_b16 v[246:247], v163 offset:37376
    ds_read_b128 v[232:235], v4 offset:8192
    ds_read_b128 v[236:239], v4 offset:10240
    v_mfma_f32_32x32x16_bf16 v[72:87], v[40:43], v[36:39], v[72:87]
    v_mfma_f32_32x32x16_bf16 v[88:103], v[44:47], v[32:35], v[88:103]
    v_mfma_f32_32x32x16_bf16 v[104:119], v[44:47], v[36:39], v[104:119]
    s_waitcnt lgkmcnt(0)
    v_mfma_f32_32x32x16_bf16 v[56:71], v[224:227], v[216:219], v[56:71]
    v_mfma_f32_32x32x16_bf16 v[72:87], v[224:227], v[220:223], v[72:87]
    s_waitcnt vmcnt(20)
    s_barrier
    v_mfma_f32_32x32x16_bf16 v[88:103], v[228:231], v[216:219], v[88:103]
    ds_read_b64_tr_b16 v[24:25], v154 offset:0
    ds_read_b64_tr_b16 v[26:27], v154 offset:512
    ds_read_b64_tr_b16 v[28:29], v163 offset:0
    ds_read_b64_tr_b16 v[30:31], v163 offset:512
    v_mfma_f32_32x32x16_bf16 v[104:119], v[228:231], v[220:223], v[104:119]
    ds_read_b128 v[16:19], v3 offset:16384
    ds_read_b128 v[20:23], v3 offset:18432
    ds_read_b64_tr_b16 v[40:41], v154 offset:4096
    ds_read_b64_tr_b16 v[42:43], v154 offset:4608
    v_mfma_f32_32x32x16_bf16 v[56:71], v[240:243], v[232:235], v[56:71]
    ds_read_b64_tr_b16 v[44:45], v163 offset:4096
    ds_read_b64_tr_b16 v[46:47], v163 offset:4608
    ds_read_b128 v[32:35], v4 offset:16384
    ds_read_b128 v[36:39], v4 offset:18432
    v_mfma_f32_32x32x16_bf16 v[72:87], v[240:243], v[236:239], v[72:87]
    v_mfma_f32_32x32x16_bf16 v[88:103], v[244:247], v[232:235], v[88:103]
    v_mfma_f32_32x32x16_bf16 v[104:119], v[244:247], v[236:239], v[104:119]
    s_waitcnt lgkmcnt(0)
    v_mfma_f32_32x32x16_bf16 v[56:71], v[24:27], v[16:19], v[56:71]
    v_mfma_f32_32x32x16_bf16 v[72:87], v[24:27], v[20:23], v[72:87]
    s_waitcnt vmcnt(20)
    s_barrier
    v_mfma_f32_32x32x16_bf16 v[88:103], v[28:31], v[16:19], v[88:103]
    ds_read_b64_tr_b16 v[224:225], v154 offset:8192
    ds_read_b64_tr_b16 v[226:227], v154 offset:8704
    ds_read_b64_tr_b16 v[228:229], v163 offset:8192
    ds_read_b64_tr_b16 v[230:231], v163 offset:8704
    v_mfma_f32_32x32x16_bf16 v[104:119], v[28:31], v[20:23], v[104:119]
    ds_read_b128 v[216:219], v3 offset:24576
    ds_read_b128 v[220:223], v3 offset:26624
    ds_read_b64_tr_b16 v[240:241], v154 offset:12288
    ds_read_b64_tr_b16 v[242:243], v154 offset:12800
    v_mfma_f32_32x32x16_bf16 v[56:71], v[40:43], v[32:35], v[56:71]
    ds_read_b64_tr_b16 v[244:245], v163 offset:12288
    ds_read_b64_tr_b16 v[246:247], v163 offset:12800
    ds_read_b128 v[232:235], v4 offset:24576
    ds_read_b128 v[236:239], v4 offset:26624
    v_mfma_f32_32x32x16_bf16 v[72:87], v[40:43], v[36:39], v[72:87]
    v_mfma_f32_32x32x16_bf16 v[88:103], v[44:47], v[32:35], v[88:103]
    v_mfma_f32_32x32x16_bf16 v[104:119], v[44:47], v[36:39], v[104:119]
    s_waitcnt lgkmcnt(0)
    v_mfma_f32_32x32x16_bf16 v[56:71], v[224:227], v[216:219], v[56:71]
    v_mfma_f32_32x32x16_bf16 v[72:87], v[224:227], v[220:223], v[72:87]
    s_waitcnt vmcnt(20)
    s_barrier
    v_mfma_f32_32x32x16_bf16 v[88:103], v[228:231], v[216:219], v[88:103]
    v_add_u32 v3, 32768, v3
    v_add_u32 v4, 32768, v4
    ds_read_b64_tr_b16 v[24:25], v154 offset:16384
    ds_read_b64_tr_b16 v[26:27], v154 offset:16896
    ds_read_b64_tr_b16 v[28:29], v163 offset:16384
    v_mfma_f32_32x32x16_bf16 v[104:119], v[228:231], v[220:223], v[104:119]
    ds_read_b64_tr_b16 v[30:31], v163 offset:16896
    ds_read_b128 v[16:19], v3 offset:0
    ds_read_b128 v[20:23], v3 offset:2048
    ds_read_b64_tr_b16 v[40:41], v154 offset:20480
    ds_read_b64_tr_b16 v[42:43], v154 offset:20992
    v_mfma_f32_32x32x16_bf16 v[56:71], v[240:243], v[232:235], v[56:71]
    ds_read_b64_tr_b16 v[44:45], v163 offset:20480
    ds_read_b64_tr_b16 v[46:47], v163 offset:20992
    ds_read_b128 v[32:35], v4 offset:0
    ds_read_b128 v[36:39], v4 offset:2048
    v_mfma_f32_32x32x16_bf16 v[72:87], v[240:243], v[236:239], v[72:87]
    v_mfma_f32_32x32x16_bf16 v[88:103], v[244:247], v[232:235], v[88:103]
    v_mfma_f32_32x32x16_bf16 v[104:119], v[244:247], v[236:239], v[104:119]
    s_waitcnt lgkmcnt(0)
    v_mfma_f32_32x32x16_bf16 v[56:71], v[24:27], v[16:19], v[56:71]
    v_mfma_f32_32x32x16_bf16 v[72:87], v[24:27], v[20:23], v[72:87]
    s_waitcnt vmcnt(20)
    s_barrier
    v_mfma_f32_32x32x16_bf16 v[88:103], v[28:31], v[16:19], v[88:103]
    ds_read_b64_tr_b16 v[224:225], v154 offset:24576
    ds_read_b64_tr_b16 v[226:227], v154 offset:25088
    ds_read_b64_tr_b16 v[228:229], v163 offset:24576
    ds_read_b64_tr_b16 v[230:231], v163 offset:25088
    v_mfma_f32_32x32x16_bf16 v[104:119], v[28:31], v[20:23], v[104:119]
    ds_read_b128 v[216:219], v3 offset:8192
    ds_read_b128 v[220:223], v3 offset:10240
    ds_read_b64_tr_b16 v[240:241], v154 offset:28672
    ds_read_b64_tr_b16 v[242:243], v154 offset:29184
    v_mfma_f32_32x32x16_bf16 v[56:71], v[40:43], v[32:35], v[56:71]
    ds_read_b64_tr_b16 v[244:245], v163 offset:28672
    ds_read_b64_tr_b16 v[246:247], v163 offset:29184
    ds_read_b128 v[232:235], v4 offset:8192
    ds_read_b128 v[236:239], v4 offset:10240
    v_mfma_f32_32x32x16_bf16 v[72:87], v[40:43], v[36:39], v[72:87]
    v_mfma_f32_32x32x16_bf16 v[88:103], v[44:47], v[32:35], v[88:103]
    v_mfma_f32_32x32x16_bf16 v[104:119], v[44:47], v[36:39], v[104:119]
    s_waitcnt lgkmcnt(0)
    v_mfma_f32_32x32x16_bf16 v[56:71], v[224:227], v[216:219], v[56:71]
    v_mfma_f32_32x32x16_bf16 v[72:87], v[224:227], v[220:223], v[72:87]
    v_mfma_f32_32x32x16_bf16 v[88:103], v[228:231], v[216:219], v[88:103]
    v_mfma_f32_32x32x16_bf16 v[104:119], v[228:231], v[220:223], v[104:119]
    v_mfma_f32_32x32x16_bf16 v[56:71], v[240:243], v[232:235], v[56:71]
    v_mfma_f32_32x32x16_bf16 v[72:87], v[240:243], v[236:239], v[72:87]
    v_mfma_f32_32x32x16_bf16 v[88:103], v[244:247], v[232:235], v[88:103]
    v_mfma_f32_32x32x16_bf16 v[104:119], v[244:247], v[236:239], v[104:119]
    s_nop 0
    s_barrier
    s_waitcnt vmcnt(0)
    v_readfirstlane_b32 s74, v156
    s_nop 3
    s_cmp_lg_u32 s74, 0
    s_cbranch_scc1 parallel_sum__softmax_full_mha__swiglu_ffn__prompt_kernel_havetag_12
    s_mov_b32 s52, s72
    s_and_b32 s53, s73, 0xffff
    s_mov_b32 s54, 256
    s_mov_b32 s55, 0x20000
    s_mov_b32 s36, 524288
    v_mov_b32 v10, 0
parallel_sum__softmax_full_mha__swiglu_ffn__prompt_kernel_tag_13:
    buffer_load_dword v9, v10, s[52:55], 0 offen sc0 sc1
    s_waitcnt vmcnt(0)
    v_readfirstlane_b32 s74, v9
    s_nop 1
    s_sub_u32 s36, s36, 1
    s_cmp_eq_u32 s36, 0
    s_cbranch_scc1 parallel_sum__softmax_full_mha__swiglu_ffn__prompt_kernel_tagx_14
    s_cmp_eq_u32 s74, 0
    s_cbranch_scc1 parallel_sum__softmax_full_mha__swiglu_ffn__prompt_kernel_tag_13
parallel_sum__softmax_full_mha__swiglu_ffn__prompt_kernel_tagx_14:
parallel_sum__softmax_full_mha__swiglu_ffn__prompt_kernel_havetag_12:
    v_subrev_u32 v3, 98304, v3
    v_subrev_u32 v4, 98304, v4
    s_add_u32 m0, s33, 0
    s_nop 0
    buffer_load_dwordx4 v153, s[8:11], s31 offen lds
    s_add_u32 s31, s31, 57344
    s_add_u32 m0, s33, 6144
    s_nop 0
    buffer_load_dwordx4 v153, s[8:11], s31 offen lds
    s_add_u32 s31, s31, 57344
    s_add_u32 m0, s33, 12288
    s_nop 0
    buffer_load_dwordx4 v153, s[8:11], s31 offen lds
    s_add_u32 s31, s31, 57344
    s_add_u32 m0, s33, 18432
    s_nop 0
    buffer_load_dwordx4 v153, s[8:11], s31 offen lds
    s_add_u32 s31, s31, 57344
    s_add_u32 m0, s33, 24576
    s_nop 0
    buffer_load_dwordx4 v153, s[8:11], s31 offen lds
    s_add_u32 s31, s31, 57344
    s_add_u32 m0, s33, 30720
    s_nop 0
    buffer_load_dwordx4 v153, s[8:11], s31 offen lds
    s_add_u32 s31, s31, 57344
    s_nop 7
    s_lshl_b32 s39, s49, 1
    s_mov_b32 s40, 0x3e8b97f6
    v_mul_f32 v56, s40, v56
    v_mul_f32 v57, s40, v57
    v_mul_f32 v58, s40, v58
    v_mul_f32 v59, s40, v59
    v_mul_f32 v60, s40, v60
    v_mul_f32 v61, s40, v61
    v_mul_f32 v62, s40, v62
    v_mul_f32 v63, s40, v63
    v_mul_f32 v64, s40, v64
    v_mul_f32 v65, s40, v65
    v_mul_f32 v66, s40, v66
    v_mul_f32 v67, s40, v67
    v_mul_f32 v68, s40, v68
    v_mul_f32 v69, s40, v69
    v_mul_f32 v70, s40, v70
    v_mul_f32 v71, s40, v71
    v_cvt_pk_bf16_f32 v56, v56, v57
    v_cvt_pk_bf16_f32 v57, v58, v59
    v_cvt_pk_bf16_f32 v58, v60, v61
    v_cvt_pk_bf16_f32 v59, v62, v63
    v_cvt_pk_bf16_f32 v60, v64, v65
    v_cvt_pk_bf16_f32 v61, v66, v67
    v_cvt_pk_bf16_f32 v62, v68, v69
    v_cvt_pk_bf16_f32 v63, v70, v71
    s_mov_b64 exec, s[46:47]
    v_mov_b32 v62, 0
    v_mov_b32 v63, 0
    s_mov_b64 exec, -1
    s_add_u32 s35, s39, 0
    s_lshl_b32 s35, s35, 6
    s_add_u32 s35, s35, s43
    s_lshl_b32 s35, s35, 11
    buffer_store_dwordx4 v[56:59], v2, s[20:23], s35 offen sc0 sc1
    buffer_store_dwordx4 v[60:63], v2, s[20:23], s35 offen offset:1024 sc0 sc1
    v_mul_f32 v72, s40, v72
    v_mul_f32 v73, s40, v73
    v_mul_f32 v74, s40, v74
    v_mul_f32 v75, s40, v75
    v_mul_f32 v76, s40, v76
    v_mul_f32 v77, s40, v77
    v_mul_f32 v78, s40, v78
    v_mul_f32 v79, s40, v79
    v_mul_f32 v80, s40, v80
    v_mul_f32 v81, s40, v81
    v_mul_f32 v82, s40, v82
    v_mul_f32 v83, s40, v83
    v_mul_f32 v84, s40, v84
    v_mul_f32 v85, s40, v85
    v_mul_f32 v86, s40, v86
    v_mul_f32 v87, s40, v87
    v_cvt_pk_bf16_f32 v72, v72, v73
    v_cvt_pk_bf16_f32 v73, v74, v75
    v_cvt_pk_bf16_f32 v74, v76, v77
    v_cvt_pk_bf16_f32 v75, v78, v79
    v_cvt_pk_bf16_f32 v76, v80, v81
    v_cvt_pk_bf16_f32 v77, v82, v83
    v_cvt_pk_bf16_f32 v78, v84, v85
    v_cvt_pk_bf16_f32 v79, v86, v87
    s_mov_b64 exec, s[46:47]
    v_mov_b32 v78, 0
    v_mov_b32 v79, 0
    s_mov_b64 exec, -1
    s_add_u32 s35, s39, 0
    s_lshl_b32 s35, s35, 6
    s_add_u32 s35, s35, s44
    s_lshl_b32 s35, s35, 11
    buffer_store_dwordx4 v[72:75], v2, s[20:23], s35 offen sc0 sc1
    buffer_store_dwordx4 v[76:79], v2, s[20:23], s35 offen offset:1024 sc0 sc1
    v_mul_f32 v88, s40, v88
    v_mul_f32 v89, s40, v89
    v_mul_f32 v90, s40, v90
    v_mul_f32 v91, s40, v91
    v_mul_f32 v92, s40, v92
    v_mul_f32 v93, s40, v93
    v_mul_f32 v94, s40, v94
    v_mul_f32 v95, s40, v95
    v_mul_f32 v96, s40, v96
    v_mul_f32 v97, s40, v97
    v_mul_f32 v98, s40, v98
    v_mul_f32 v99, s40, v99
    v_mul_f32 v100, s40, v100
    v_mul_f32 v101, s40, v101
    v_mul_f32 v102, s40, v102
    v_mul_f32 v103, s40, v103
    v_cvt_pk_bf16_f32 v88, v88, v89
    v_cvt_pk_bf16_f32 v89, v90, v91
    v_cvt_pk_bf16_f32 v90, v92, v93
    v_cvt_pk_bf16_f32 v91, v94, v95
    v_cvt_pk_bf16_f32 v92, v96, v97
    v_cvt_pk_bf16_f32 v93, v98, v99
    v_cvt_pk_bf16_f32 v94, v100, v101
    v_cvt_pk_bf16_f32 v95, v102, v103
    s_mov_b64 exec, s[46:47]
    v_mov_b32 v94, 0
    v_mov_b32 v95, 0
    s_mov_b64 exec, -1
    s_add_u32 s35, s39, 1
    s_lshl_b32 s35, s35, 6
    s_add_u32 s35, s35, s43
    s_lshl_b32 s35, s35, 11
    buffer_store_dwordx4 v[88:91], v2, s[20:23], s35 offen sc0 sc1
    buffer_store_dwordx4 v[92:95], v2, s[20:23], s35 offen offset:1024 sc0 sc1
    v_mul_f32 v104, s40, v104
    v_mul_f32 v105, s40, v105
    v_mul_f32 v106, s40, v106
    v_mul_f32 v107, s40, v107
    v_mul_f32 v108, s40, v108
    v_mul_f32 v109, s40, v109
    v_mul_f32 v110, s40, v110
    v_mul_f32 v111, s40, v111
    v_mul_f32 v112, s40, v112
    v_mul_f32 v113, s40, v113
    v_mul_f32 v114, s40, v114
    v_mul_f32 v115, s40, v115
    v_mul_f32 v116, s40, v116
    v_mul_f32 v117, s40, v117
    v_mul_f32 v118, s40, v118
    v_mul_f32 v119, s40, v119
    v_cvt_pk_bf16_f32 v104, v104, v105
    v_cvt_pk_bf16_f32 v105, v106, v107
    v_cvt_pk_bf16_f32 v106, v108, v109
    v_cvt_pk_bf16_f32 v107, v110, v111
    v_cvt_pk_bf16_f32 v108, v112, v113
    v_cvt_pk_bf16_f32 v109, v114, v115
    v_cvt_pk_bf16_f32 v110, v116, v117
    v_cvt_pk_bf16_f32 v111, v118, v119
    s_mov_b64 exec, s[46:47]
    v_mov_b32 v110, 0
    v_mov_b32 v111, 0
    s_mov_b64 exec, -1
    s_add_u32 s35, s39, 1
    s_lshl_b32 s35, s35, 6
    s_add_u32 s35, s35, s44
    s_lshl_b32 s35, s35, 11
    buffer_store_dwordx4 v[104:107], v2, s[20:23], s35 offen sc0 sc1
    buffer_store_dwordx4 v[108:111], v2, s[20:23], s35 offen offset:1024 sc0 sc1
    s_waitcnt vmcnt(12) lgkmcnt(0)
    s_barrier
    ds_read_b64_tr_b16 v[184:185], v5 offset:0
    ds_read_b64_tr_b16 v[186:187], v5 offset:256
    ds_read_b64_tr_b16 v[188:189], v5 offset:1024
    ds_read_b64_tr_b16 v[190:191], v5 offset:1280
    ds_read_b128 v[176:179], v3 offset:0
    ds_read_b128 v[180:183], v3 offset:2048
    ds_read_b64_tr_b16 v[200:201], v5 offset:6144
    ds_read_b64_tr_b16 v[202:203], v5 offset:6400
    ds_read_b64_tr_b16 v[204:205], v5 offset:7168
    ds_read_b64_tr_b16 v[206:207], v5 offset:7424
    ds_read_b128 v[192:195], v4 offset:0
    ds_read_b128 v[196:199], v4 offset:2048
    s_waitcnt lgkmcnt(0)
    v_mfma_f32_32x32x16_bf16 v[56:71], v[184:187], v[176:179], 0
    v_mfma_f32_32x32x16_bf16 v[72:87], v[184:187], v[180:183], 0
    s_waitcnt vmcnt(10)
    s_barrier
    v_mfma_f32_32x32x16_bf16 v[88:103], v[188:191], v[176:179], 0
    ds_read_b64_tr_b16 v[216:217], v5 offset:12288
    ds_read_b64_tr_b16 v[218:219], v5 offset:12544
    ds_read_b64_tr_b16 v[220:221], v5 offset:13312
    ds_read_b64_tr_b16 v[222:223], v5 offset:13568
    v_mfma_f32_32x32x16_bf16 v[104:119], v[188:191], v[180:183], 0
    ds_read_b128 v[208:211], v3 offset:8192
    ds_read_b128 v[212:215], v3 offset:10240
    ds_read_b64_tr_b16 v[232:233], v5 offset:18432
    ds_read_b64_tr_b16 v[234:235], v5 offset:18688
    v_mfma_f32_32x32x16_bf16 v[56:71], v[200:203], v[192:195], v[56:71]
    ds_read_b64_tr_b16 v[236:237], v5 offset:19456
    ds_read_b64_tr_b16 v[238:239], v5 offset:19712
    ds_read_b128 v[224:227], v4 offset:8192
    ds_read_b128 v[228:231], v4 offset:10240
    v_mfma_f32_32x32x16_bf16 v[72:87], v[200:203], v[196:199], v[72:87]
    v_mfma_f32_32x32x16_bf16 v[88:103], v[204:207], v[192:195], v[88:103]
    v_mfma_f32_32x32x16_bf16 v[104:119], v[204:207], v[196:199], v[104:119]
    s_add_u32 m0, s33, 0
    s_nop 0
    buffer_load_dwordx4 v153, s[8:11], s31 offen lds
    s_add_u32 s31, s31, 57344
    s_add_u32 m0, s33, 6144
    s_nop 0
    buffer_load_dwordx4 v153, s[8:11], s31 offen lds
    s_add_u32 s31, s31, 57344
    s_waitcnt lgkmcnt(0)
    v_mfma_f32_32x32x16_bf16 v[56:71], v[216:219], v[208:211], v[56:71]
    v_mfma_f32_32x32x16_bf16 v[72:87], v[216:219], v[212:215], v[72:87]
    s_waitcnt vmcnt(10)
    s_barrier
    v_mfma_f32_32x32x16_bf16 v[88:103], v[220:223], v[208:211], v[88:103]
    ds_read_b64_tr_b16 v[184:185], v5 offset:24576
    ds_read_b64_tr_b16 v[186:187], v5 offset:24832
    ds_read_b64_tr_b16 v[188:189], v5 offset:25600
    ds_read_b64_tr_b16 v[190:191], v5 offset:25856
    v_mfma_f32_32x32x16_bf16 v[104:119], v[220:223], v[212:215], v[104:119]
    ds_read_b128 v[176:179], v3 offset:16384
    ds_read_b128 v[180:183], v3 offset:18432
    ds_read_b64_tr_b16 v[200:201], v5 offset:30720
    ds_read_b64_tr_b16 v[202:203], v5 offset:30976
    v_mfma_f32_32x32x16_bf16 v[56:71], v[232:235], v[224:227], v[56:71]
    ds_read_b64_tr_b16 v[204:205], v5 offset:31744
    ds_read_b64_tr_b16 v[206:207], v5 offset:32000
    ds_read_b128 v[192:195], v4 offset:16384
    ds_read_b128 v[196:199], v4 offset:18432
    v_mfma_f32_32x32x16_bf16 v[72:87], v[232:235], v[228:231], v[72:87]
    v_mfma_f32_32x32x16_bf16 v[88:103], v[236:239], v[224:227], v[88:103]
    v_mfma_f32_32x32x16_bf16 v[104:119], v[236:239], v[228:231], v[104:119]
    s_add_u32 m0, s33, 12288
    s_nop 0
    buffer_load_dwordx4 v153, s[8:11], s31 offen lds
    s_add_u32 s31, s31, 57344
    s_add_u32 m0, s33, 18432
    s_nop 0
    buffer_load_dwordx4 v153, s[8:11], s31 offen lds
    s_add_u32 s31, s31, 57344
    s_waitcnt lgkmcnt(0)
    v_mfma_f32_32x32x16_bf16 v[56:71], v[184:187], v[176:179], v[56:71]
    v_mfma_f32_32x32x16_bf16 v[72:87], v[184:187], v[180:183], v[72:87]
    s_waitcnt vmcnt(2)
    s_barrier
    v_mfma_f32_32x32x16_bf16 v[88:103], v[188:191], v[176:179], v[88:103]
    ds_read_b64_tr_b16 v[216:217], v5 offset:0
    ds_read_b64_tr_b16 v[218:219], v5 offset:256
    ds_read_b64_tr_b16 v[220:221], v5 offset:1024
    ds_read_b64_tr_b16 v[222:223], v5 offset:1280
    v_mfma_f32_32x32x16_bf16 v[104:119], v[188:191], v[180:183], v[104:119]
    ds_read_b128 v[208:211], v3 offset:24576
    ds_read_b128 v[212:215], v3 offset:26624
    ds_read_b64_tr_b16 v[232:233], v5 offset:6144
    ds_read_b64_tr_b16 v[234:235], v5 offset:6400
    v_mfma_f32_32x32x16_bf16 v[56:71], v[200:203], v[192:195], v[56:71]
    ds_read_b64_tr_b16 v[236:237], v5 offset:7168
    ds_read_b64_tr_b16 v[238:239], v5 offset:7424
    ds_read_b128 v[224:227], v4 offset:24576
    ds_read_b128 v[228:231], v4 offset:26624
    v_mfma_f32_32x32x16_bf16 v[72:87], v[200:203], v[196:199], v[72:87]
    v_mfma_f32_32x32x16_bf16 v[88:103], v[204:207], v[192:195], v[88:103]
    v_mfma_f32_32x32x16_bf16 v[104:119], v[204:207], v[196:199], v[104:119]
    s_add_u32 m0, s33, 24576
    s_nop 0
    buffer_load_dwordx4 v153, s[8:11], s31 offen lds
    s_add_u32 s31, s31, 57344
    s_add_u32 m0, s33, 30720
    s_nop 0
    buffer_load_dwordx4 v153, s[8:11], s31 offen lds
    s_add_u32 s31, s31, 57344
    s_waitcnt lgkmcnt(0)
    v_mfma_f32_32x32x16_bf16 v[56:71], v[216:219], v[208:211], v[56:71]
    v_mfma_f32_32x32x16_bf16 v[72:87], v[216:219], v[212:215], v[72:87]
    s_waitcnt vmcnt(2)
    s_barrier
    v_mfma_f32_32x32x16_bf16 v[88:103], v[220:223], v[208:211], v[88:103]
    v_add_u32 v3, 32768, v3
    v_add_u32 v4, 32768, v4
    ds_read_b64_tr_b16 v[184:185], v5 offset:12288
    ds_read_b64_tr_b16 v[186:187], v5 offset:12544
    ds_read_b64_tr_b16 v[188:189], v5 offset:13312
    v_mfma_f32_32x32x16_bf16 v[104:119], v[220:223], v[212:215], v[104:119]
    ds_read_b64_tr_b16 v[190:191], v5 offset:13568
    ds_read_b128 v[176:179], v3 offset:0
    ds_read_b128 v[180:183], v3 offset:2048
    ds_read_b64_tr_b16 v[200:201], v5 offset:18432
    ds_read_b64_tr_b16 v[202:203], v5 offset:18688
    v_mfma_f32_32x32x16_bf16 v[56:71], v[232:235], v[224:227], v[56:71]
    ds_read_b64_tr_b16 v[204:205], v5 offset:19456
    ds_read_b64_tr_b16 v[206:207], v5 offset:19712
    ds_read_b128 v[192:195], v4 offset:0
    ds_read_b128 v[196:199], v4 offset:2048
    v_mfma_f32_32x32x16_bf16 v[72:87], v[232:235], v[228:231], v[72:87]
    v_mfma_f32_32x32x16_bf16 v[88:103], v[236:239], v[224:227], v[88:103]
    v_mfma_f32_32x32x16_bf16 v[104:119], v[236:239], v[228:231], v[104:119]
    s_add_u32 m0, s33, 0
    s_nop 0
    buffer_load_dwordx4 v153, s[8:11], s31 offen lds
    s_add_u32 s31, s31, 57344
    s_add_u32 m0, s33, 6144
    s_nop 0
    buffer_load_dwordx4 v153, s[8:11], s31 offen lds
    s_add_u32 s31, s31, 57344
    v_mov_b32 v9, 155648
    v_mov_b32 v10, 1
    s_mov_b64 exec, 1
    ds_add_rtn_u32 v10, v9, v10
    s_waitcnt lgkmcnt(0)
    s_mov_b64 exec, -1
    v_readfirstlane_b32 s35, v10
    s_nop 3
    s_cmp_lg_u32 s35, 7
    s_cbranch_scc1 parallel_sum__softmax_full_mha__swiglu_ffn__prompt_kernel_arr_15
    s_lshl_b32 s35, s2, 6
    s_add_u32 s35, s35, 25296896
    v_mov_b32 v9, s74
    v_mov_b32 v10, 0
    s_mov_b64 exec, 1
    buffer_store_dword v9, v10, s[20:23], s35 offen sc0 sc1
    s_mov_b64 exec, -1
parallel_sum__softmax_full_mha__swiglu_ffn__prompt_kernel_arr_15:
    s_waitcnt lgkmcnt(0)
    v_mfma_f32_32x32x16_bf16 v[56:71], v[184:187], v[176:179], v[56:71]
    v_mfma_f32_32x32x16_bf16 v[72:87], v[184:187], v[180:183], v[72:87]
    s_waitcnt vmcnt(2)
    s_barrier
    v_mfma_f32_32x32x16_bf16 v[88:103], v[188:191], v[176:179], v[88:103]
    ds_read_b64_tr_b16 v[216:217], v5 offset:24576
    ds_read_b64_tr_b16 v[218:219], v5 offset:24832
    ds_read_b64_tr_b16 v[220:221], v5 offset:25600
    ds_read_b64_tr_b16 v[222:223], v5 offset:25856
    v_mfma_f32_32x32x16_bf16 v[104:119], v[188:191], v[180:183], v[104:119]
    ds_read_b128 v[208:211], v3 offset:8192
    ds_read_b128 v[212:215], v3 offset:10240
    ds_read_b64_tr_b16 v[232:233], v5 offset:30720
    ds_read_b64_tr_b16 v[234:235], v5 offset:30976
    v_mfma_f32_32x32x16_bf16 v[56:71], v[200:203], v[192:195], v[56:71]
    ds_read_b64_tr_b16 v[236:237], v5 offset:31744
    ds_read_b64_tr_b16 v[238:239], v5 offset:32000
    ds_read_b128 v[224:227], v4 offset:8192
    ds_read_b128 v[228:231], v4 offset:10240
    v_mfma_f32_32x32x16_bf16 v[72:87], v[200:203], v[196:199], v[72:87]
    v_mfma_f32_32x32x16_bf16 v[88:103], v[204:207], v[192:195], v[88:103]
    v_mfma_f32_32x32x16_bf16 v[104:119], v[204:207], v[196:199], v[104:119]
    s_add_u32 m0, s33, 12288
    s_nop 0
    buffer_load_dwordx4 v153, s[8:11], s31 offen lds
    s_add_u32 s31, s31, 57344
    s_add_u32 m0, s33, 18432
    s_nop 0
    buffer_load_dwordx4 v153, s[8:11], s31 offen lds
    s_add_u32 s31, s31, 57344
    s_waitcnt lgkmcnt(0)
    v_mfma_f32_32x32x16_bf16 v[56:71], v[216:219], v[208:211], v[56:71]
    v_mfma_f32_32x32x16_bf16 v[72:87], v[216:219], v[212:215], v[72:87]
    s_waitcnt vmcnt(2)
    s_barrier
    v_mfma_f32_32x32x16_bf16 v[88:103], v[220:223], v[208:211], v[88:103]
    ds_read_b64_tr_b16 v[184:185], v5 offset:0
    ds_read_b64_tr_b16 v[186:187], v5 offset:256
    ds_read_b64_tr_b16 v[188:189], v5 offset:1024
    ds_read_b64_tr_b16 v[190:191], v5 offset:1280
    v_mfma_f32_32x32x16_bf16 v[104:119], v[220:223], v[212:215], v[104:119]
    ds_read_b128 v[176:179], v3 offset:16384
    ds_read_b128 v[180:183], v3 offset:18432
    ds_read_b64_tr_b16 v[200:201], v5 offset:6144
    ds_read_b64_tr_b16 v[202:203], v5 offset:6400
    v_mfma_f32_32x32x16_bf16 v[56:71], v[232:235], v[224:227], v[56:71]
    ds_read_b64_tr_b16 v[204:205], v5 offset:7168
    ds_read_b64_tr_b16 v[206:207], v5 offset:7424
    ds_read_b128 v[192:195], v4 offset:16384
    ds_read_b128 v[196:199], v4 offset:18432
    v_mfma_f32_32x32x16_bf16 v[72:87], v[232:235], v[228:231], v[72:87]
    v_mfma_f32_32x32x16_bf16 v[88:103], v[236:239], v[224:227], v[88:103]
    v_mfma_f32_32x32x16_bf16 v[104:119], v[236:239], v[228:231], v[104:119]
    s_add_u32 m0, s33, 24576
    s_nop 0
    buffer_load_dwordx4 v153, s[8:11], s31 offen lds
    s_add_u32 s31, s31, 57344
    s_add_u32 m0, s33, 30720
    s_nop 0
    buffer_load_dwordx4 v153, s[8:11], s31 offen lds
    s_add_u32 s31, s31, 57344
    s_waitcnt lgkmcnt(0)
    v_mfma_f32_32x32x16_bf16 v[56:71], v[184:187], v[176:179], v[56:71]
    v_mfma_f32_32x32x16_bf16 v[72:87], v[184:187], v[180:183], v[72:87]
    s_waitcnt vmcnt(2)
    s_barrier
    v_mfma_f32_32x32x16_bf16 v[88:103], v[188:191], v[176:179], v[88:103]
    ds_read_b64_tr_b16 v[216:217], v5 offset:12288
    ds_read_b64_tr_b16 v[218:219], v5 offset:12544
    ds_read_b64_tr_b16 v[220:221], v5 offset:13312
    ds_read_b64_tr_b16 v[222:223], v5 offset:13568
    v_mfma_f32_32x32x16_bf16 v[104:119], v[188:191], v[180:183], v[104:119]
    ds_read_b128 v[208:211], v3 offset:24576
    ds_read_b128 v[212:215], v3 offset:26624
    ds_read_b64_tr_b16 v[232:233], v5 offset:18432
    ds_read_b64_tr_b16 v[234:235], v5 offset:18688
    v_mfma_f32_32x32x16_bf16 v[56:71], v[200:203], v[192:195], v[56:71]
    ds_read_b64_tr_b16 v[236:237], v5 offset:19456
    ds_read_b64_tr_b16 v[238:239], v5 offset:19712
    ds_read_b128 v[224:227], v4 offset:24576
    ds_read_b128 v[228:231], v4 offset:26624
    v_mfma_f32_32x32x16_bf16 v[72:87], v[200:203], v[196:199], v[72:87]
    v_mfma_f32_32x32x16_bf16 v[88:103], v[204:207], v[192:195], v[88:103]
    v_mfma_f32_32x32x16_bf16 v[104:119], v[204:207], v[196:199], v[104:119]
    s_add_u32 m0, s33, 0
    s_nop 0
    buffer_load_dwordx4 v153, s[8:11], s31 offen lds
    s_add_u32 s31, s31, 57344
    s_add_u32 m0, s33, 6144
    s_nop 0
    buffer_load_dwordx4 v153, s[8:11], s31 offen lds
    s_add_u32 s31, s31, 57344
    s_waitcnt lgkmcnt(0)
    v_mfma_f32_32x32x16_bf16 v[56:71], v[216:219], v[208:211], v[56:71]
    v_mfma_f32_32x32x16_bf16 v[72:87], v[216:219], v[212:215], v[72:87]
    s_waitcnt vmcnt(2)
    s_barrier
    v_mfma_f32_32x32x16_bf16 v[88:103], v[220:223], v[208:211], v[88:103]
    v_add_u32 v3, 32768, v3
    v_add_u32 v4, 32768, v4
    ds_read_b64_tr_b16 v[184:185], v5 offset:24576
    ds_read_b64_tr_b16 v[186:187], v5 offset:24832
    ds_read_b64_tr_b16 v[188:189], v5 offset:25600
    v_mfma_f32_32x32x16_bf16 v[104:119], v[220:223], v[212:215], v[104:119]
    ds_read_b64_tr_b16 v[190:191], v5 offset:25856
    ds_read_b128 v[176:179], v3 offset:0
    ds_read_b128 v[180:183], v3 offset:2048
    ds_read_b64_tr_b16 v[200:201], v5 offset:30720
    ds_read_b64_tr_b16 v[202:203], v5 offset:30976
    v_mfma_f32_32x32x16_bf16 v[56:71], v[232:235], v[224:227], v[56:71]
    ds_read_b64_tr_b16 v[204:205], v5 offset:31744
    ds_read_b64_tr_b16 v[206:207], v5 offset:32000
    ds_read_b128 v[192:195], v4 offset:0
    ds_read_b128 v[196:199], v4 offset:2048
    v_mfma_f32_32x32x16_bf16 v[72:87], v[232:235], v[228:231], v[72:87]
    v_mfma_f32_32x32x16_bf16 v[88:103], v[236:239], v[224:227], v[88:103]
    v_mfma_f32_32x32x16_bf16 v[104:119], v[236:239], v[228:231], v[104:119]
    s_add_u32 m0, s33, 12288
    s_nop 0
    buffer_load_dwordx4 v153, s[8:11], s31 offen lds
    s_add_u32 s31, s31, 57344
    s_add_u32 m0, s33, 18432
    s_nop 0
    buffer_load_dwordx4 v153, s[8:11], s31 offen lds
    s_add_u32 s31, s31, 57344
    s_waitcnt lgkmcnt(0)
    v_mfma_f32_32x32x16_bf16 v[56:71], v[184:187], v[176:179], v[56:71]
    v_mfma_f32_32x32x16_bf16 v[72:87], v[184:187], v[180:183], v[72:87]
    s_waitcnt vmcnt(2)
    s_barrier
    v_mfma_f32_32x32x16_bf16 v[88:103], v[188:191], v[176:179], v[88:103]
    ds_read_b64_tr_b16 v[216:217], v5 offset:0
    ds_read_b64_tr_b16 v[218:219], v5 offset:256
    ds_read_b64_tr_b16 v[220:221], v5 offset:1024
    ds_read_b64_tr_b16 v[222:223], v5 offset:1280
    v_mfma_f32_32x32x16_bf16 v[104:119], v[188:191], v[180:183], v[104:119]
    ds_read_b128 v[208:211], v3 offset:8192
    ds_read_b128 v[212:215], v3 offset:10240
    ds_read_b64_tr_b16 v[232:233], v5 offset:6144
    ds_read_b64_tr_b16 v[234:235], v5 offset:6400
    v_mfma_f32_32x32x16_bf16 v[56:71], v[200:203], v[192:195], v[56:71]
    ds_read_b64_tr_b16 v[236:237], v5 offset:7168
    ds_read_b64_tr_b16 v[238:239], v5 offset:7424
    ds_read_b128 v[224:227], v4 offset:8192
    ds_read_b128 v[228:231], v4 offset:10240
    v_mfma_f32_32x32x16_bf16 v[72:87], v[200:203], v[196:199], v[72:87]
    v_mfma_f32_32x32x16_bf16 v[88:103], v[204:207], v[192:195], v[88:103]
    v_mfma_f32_32x32x16_bf16 v[104:119], v[204:207], v[196:199], v[104:119]
    s_add_u32 m0, s33, 24576
    s_nop 0
    buffer_load_dwordx4 v153, s[8:11], s31 offen lds
    s_add_u32 s31, s31, 57344
    s_add_u32 m0, s33, 30720
    s_nop 0
    buffer_load_dwordx4 v153, s[8:11], s31 offen lds
    s_add_u32 s31, s31, 57344
    s_waitcnt lgkmcnt(0)
    v_mfma_f32_32x32x16_bf16 v[56:71], v[216:219], v[208:211], v[56:71]
    v_mfma_f32_32x32x16_bf16 v[72:87], v[216:219], v[212:215], v[72:87]
    s_waitcnt vmcnt(2)
    s_barrier
    v_mfma_f32_32x32x16_bf16 v[88:103], v[220:223], v[208:211], v[88:103]
    ds_read_b64_tr_b16 v[184:185], v5 offset:12288
    ds_read_b64_tr_b16 v[186:187], v5 offset:12544
    ds_read_b64_tr_b16 v[188:189], v5 offset:13312
    ds_read_b64_tr_b16 v[190:191], v5 offset:13568
    v_mfma_f32_32x32x16_bf16 v[104:119], v[220:223], v[212:215], v[104:119]
    ds_read_b128 v[176:179], v3 offset:16384
    ds_read_b128 v[180:183], v3 offset:18432
    ds_read_b64_tr_b16 v[200:201], v5 offset:18432
    ds_read_b64_tr_b16 v[202:203], v5 offset:18688
    v_mfma_f32_32x32x16_bf16 v[56:71], v[232:235], v[224:227], v[56:71]
    ds_read_b64_tr_b16 v[204:205], v5 offset:19456
    ds_read_b64_tr_b16 v[206:207], v5 offset:19712
    ds_read_b128 v[192:195], v4 offset:16384
    ds_read_b128 v[196:199], v4 offset:18432
    v_mfma_f32_32x32x16_bf16 v[72:87], v[232:235], v[228:231], v[72:87]
    v_mfma_f32_32x32x16_bf16 v[88:103], v[236:239], v[224:227], v[88:103]
    v_mfma_f32_32x32x16_bf16 v[104:119], v[236:239], v[228:231], v[104:119]
    s_add_u32 m0, s33, 0
    s_nop 0
    buffer_load_dwordx4 v153, s[8:11], s31 offen lds
    s_add_u32 s31, s31, 57344
    s_add_u32 m0, s33, 6144
    s_nop 0
    buffer_load_dwordx4 v153, s[8:11], s31 offen lds
    s_add_u32 s31, s31, 57344
    s_waitcnt lgkmcnt(0)
    v_mfma_f32_32x32x16_bf16 v[56:71], v[184:187], v[176:179], v[56:71]
    v_mfma_f32_32x32x16_bf16 v[72:87], v[184:187], v[180:183], v[72:87]
    s_waitcnt vmcnt(2)
    s_barrier
    v_mfma_f32_32x32x16_bf16 v[88:103], v[188:191], v[176:179], v[88:103]
    ds_read_b64_tr_b16 v[216:217], v5 offset:24576
    ds_read_b64_tr_b16 v[218:219], v5 offset:24832
    ds_read_b64_tr_b16 v[220:221], v5 offset:25600
    ds_read_b64_tr_b16 v[222:223], v5 offset:25856
    v_mfma_f32_32x32x16_bf16 v[104:119], v[188:191], v[180:183], v[104:119]
    ds_read_b128 v[208:211], v3 offset:24576
    ds_read_b128 v[212:215], v3 offset:26624
    ds_read_b64_tr_b16 v[232:233], v5 offset:30720
    ds_read_b64_tr_b16 v[234:235], v5 offset:30976
    v_mfma_f32_32x32x16_bf16 v[56:71], v[200:203], v[192:195], v[56:71]
    ds_read_b64_tr_b16 v[236:237], v5 offset:31744
    ds_read_b64_tr_b16 v[238:239], v5 offset:32000
    ds_read_b128 v[224:227], v4 offset:24576
    ds_read_b128 v[228:231], v4 offset:26624
    v_mfma_f32_32x32x16_bf16 v[72:87], v[200:203], v[196:199], v[72:87]
    v_mfma_f32_32x32x16_bf16 v[88:103], v[204:207], v[192:195], v[88:103]
    v_mfma_f32_32x32x16_bf16 v[104:119], v[204:207], v[196:199], v[104:119]
    s_add_u32 m0, s33, 12288
    s_nop 0
    buffer_load_dwordx4 v153, s[8:11], s31 offen lds
    s_add_u32 s31, s31, 57344
    s_add_u32 m0, s33, 18432
    s_nop 0
    buffer_load_dwordx4 v153, s[8:11], s31 offen lds
    s_add_u32 s31, s31, 57344
    s_waitcnt lgkmcnt(0)
    v_mfma_f32_32x32x16_bf16 v[56:71], v[216:219], v[208:211], v[56:71]
    v_mfma_f32_32x32x16_bf16 v[72:87], v[216:219], v[212:215], v[72:87]
    s_waitcnt vmcnt(2)
    s_barrier
    v_mfma_f32_32x32x16_bf16 v[88:103], v[220:223], v[208:211], v[88:103]
    v_add_u32 v3, 32768, v3
    v_add_u32 v4, 32768, v4
    ds_read_b64_tr_b16 v[184:185], v5 offset:0
    ds_read_b64_tr_b16 v[186:187], v5 offset:256
    ds_read_b64_tr_b16 v[188:189], v5 offset:1024
    v_mfma_f32_32x32x16_bf16 v[104:119], v[220:223], v[212:215], v[104:119]
    ds_read_b64_tr_b16 v[190:191], v5 offset:1280
    ds_read_b128 v[176:179], v3 offset:0
    ds_read_b128 v[180:183], v3 offset:2048
    ds_read_b64_tr_b16 v[200:201], v5 offset:6144
    ds_read_b64_tr_b16 v[202:203], v5 offset:6400
    v_mfma_f32_32x32x16_bf16 v[56:71], v[232:235], v[224:227], v[56:71]
    ds_read_b64_tr_b16 v[204:205], v5 offset:7168
    ds_read_b64_tr_b16 v[206:207], v5 offset:7424
    ds_read_b128 v[192:195], v4 offset:0
    ds_read_b128 v[196:199], v4 offset:2048
    v_mfma_f32_32x32x16_bf16 v[72:87], v[232:235], v[228:231], v[72:87]
    v_mfma_f32_32x32x16_bf16 v[88:103], v[236:239], v[224:227], v[88:103]
    v_mfma_f32_32x32x16_bf16 v[104:119], v[236:239], v[228:231], v[104:119]
    s_waitcnt lgkmcnt(0)
    v_mfma_f32_32x32x16_bf16 v[56:71], v[184:187], v[176:179], v[56:71]
    v_mfma_f32_32x32x16_bf16 v[72:87], v[184:187], v[180:183], v[72:87]
    s_waitcnt vmcnt(0)
    s_barrier
    v_mfma_f32_32x32x16_bf16 v[88:103], v[188:191], v[176:179], v[88:103]
    ds_read_b64_tr_b16 v[216:217], v5 offset:12288
    ds_read_b64_tr_b16 v[218:219], v5 offset:12544
    ds_read_b64_tr_b16 v[220:221], v5 offset:13312
    ds_read_b64_tr_b16 v[222:223], v5 offset:13568
    v_mfma_f32_32x32x16_bf16 v[104:119], v[188:191], v[180:183], v[104:119]
    ds_read_b128 v[208:211], v3 offset:8192
    ds_read_b128 v[212:215], v3 offset:10240
    ds_read_b64_tr_b16 v[232:233], v5 offset:18432
    ds_read_b64_tr_b16 v[234:235], v5 offset:18688
    v_mfma_f32_32x32x16_bf16 v[56:71], v[200:203], v[192:195], v[56:71]
    ds_read_b64_tr_b16 v[236:237], v5 offset:19456
    ds_read_b64_tr_b16 v[238:239], v5 offset:19712
    ds_read_b128 v[224:227], v4 offset:8192
    ds_read_b128 v[228:231], v4 offset:10240
    v_mfma_f32_32x32x16_bf16 v[72:87], v[200:203], v[196:199], v[72:87]
    v_mfma_f32_32x32x16_bf16 v[88:103], v[204:207], v[192:195], v[88:103]
    v_mfma_f32_32x32x16_bf16 v[104:119], v[204:207], v[196:199], v[104:119]
    s_waitcnt lgkmcnt(0)
    v_mfma_f32_32x32x16_bf16 v[56:71], v[216:219], v[208:211], v[56:71]
    v_mfma_f32_32x32x16_bf16 v[72:87], v[216:219], v[212:215], v[72:87]
    v_mfma_f32_32x32x16_bf16 v[88:103], v[220:223], v[208:211], v[88:103]
    v_mfma_f32_32x32x16_bf16 v[104:119], v[220:223], v[212:215], v[104:119]
    v_mfma_f32_32x32x16_bf16 v[56:71], v[232:235], v[224:227], v[56:71]
    v_mfma_f32_32x32x16_bf16 v[72:87], v[232:235], v[228:231], v[72:87]
    v_mfma_f32_32x32x16_bf16 v[88:103], v[236:239], v[224:227], v[88:103]
    v_mfma_f32_32x32x16_bf16 v[104:119], v[236:239], v[228:231], v[104:119]
    s_barrier
    s_nop 10
    s_and_b32 s24, s2, 7
    s_lshr_b32 s25, s2, 3
    s_and_b32 s16, s25, 1
    s_lshl_b32 s24, s24, 1
    s_add_u32 s16, s16, s24
    s_lshr_b32 s17, s25, 1
    s_mov_b32 s30, 0
    s_mov_b32 s31, -1
    s_lshl_b32 s24, s16, 6
    s_lshl_b32 s25, s17, 2
    s_add_u32 s50, s24, s25
    s_lshl_b32 s50, s50, 11
    s_lshl_b32 s26, s24, 11
    s_add_u32 s26, s26, 2097152
    s_lshl_b32 s25, s3, 15
    s_add_u32 s27, s26, s25
    s_add_u32 s18, s27, 2097152
    s_mov_b32 s4, s70
    s_and_b32 s5, s71, 0xffff
    s_mov_b32 s6, 33554432
    s_mov_b32 s7, 0x20000
    s_mov_b32 s8, s70
    s_and_b32 s9, s71, 0xffff
    s_mov_b32 s10, 0
    s_mov_b32 s11, 0x20000
    s_mov_b32 s12, s70
    s_and_b32 s13, s71, 0xffff
    s_mov_b32 s14, 0
    s_mov_b32 s15, 0x20000
    s_add_u32 s10, s27, 32768
    s_add_u32 s14, s18, 32768
    s_mov_b32 s29, 0
    v_and_b32 v5, 15, v1
    s_and_b32 s24, s16, 0xfffe
    v_bfe_u32 v6, v1, 4, 1
    v_add_u32 v6, s24, v6
    v_lshrrev_b32 v7, 3, v5
    v_lshrrev_b32 v9, 2, v6
    v_lshl_add_u32 v7, v9, 1, v7
    v_and_b32 v9, 7, v5
    v_lshl_add_u32 v7, v9, 3, v7
    v_and_b32 v9, 1, v6
    v_lshl_add_u32 v7, v9, 7, v7
    v_bfe_u32 v9, v6, 1, 1
    v_lshl_add_u32 v7, v9, 6, v7
    v_lshlrev_b32 v7, 6, v7
    v_add_u32 v7, 25296896, v7
    buffer_load_dword v220, v7, s[4:7], 0 offen sc0 sc1
    v_mov_b32 v221, v7
    s_mov_b32 s36, 0xbfb8aa3b
    v_mul_f32 v16, s36, v56
    v_mul_f32 v17, s36, v57
    v_mul_f32 v18, s36, v58
    v_mul_f32 v19, s36, v59
    v_exp_f32 v16, v16
    v_exp_f32 v17, v17
    v_exp_f32 v18, v18
    v_exp_f32 v19, v19
    v_mul_f32 v56, v56, v88
    v_mul_f32 v57, v57, v89
    v_mul_f32 v58, v58, v90
    v_mul_f32 v59, v59, v91
    v_add_f32 v16, 1.0, v16
    v_add_f32 v17, 1.0, v17
    v_add_f32 v18, 1.0, v18
    v_add_f32 v19, 1.0, v19
    v_rcp_f32 v16, v16
    v_rcp_f32 v17, v17
    v_rcp_f32 v18, v18
    v_rcp_f32 v19, v19
    s_nop 0
    v_mul_f32 v56, v56, v16
    v_mul_f32 v57, v57, v17
    v_mul_f32 v58, v58, v18
    v_mul_f32 v59, v59, v19
    v_mul_f32 v16, s36, v60
    v_mul_f32 v17, s36, v61
    v_mul_f32 v18, s36, v62
    v_mul_f32 v19, s36, v63
    v_exp_f32 v16, v16
    v_exp_f32 v17, v17
    v_exp_f32 v18, v18
    v_exp_f32 v19, v19
    v_mul_f32 v60, v60, v92
    v_mul_f32 v61, v61, v93
    v_mul_f32 v62, v62, v94
    v_mul_f32 v63, v63, v95
    v_add_f32 v16, 1.0, v16
    v_add_f32 v17, 1.0, v17
    v_add_f32 v18, 1.0, v18
    v_add_f32 v19, 1.0, v19
    v_rcp_f32 v16, v16
    v_rcp_f32 v17, v17
    v_rcp_f32 v18, v18
    v_rcp_f32 v19, v19
    s_nop 0
    v_mul_f32 v60, v60, v16
    v_mul_f32 v61, v61, v17
    v_mul_f32 v62, v62, v18
    v_mul_f32 v63, v63, v19
    v_mul_f32 v16, s36, v64
    v_mul_f32 v17, s36, v65
    v_mul_f32 v18, s36, v66
    v_mul_f32 v19, s36, v67
    v_exp_f32 v16, v16
    v_exp_f32 v17, v17
    v_exp_f32 v18, v18
    v_exp_f32 v19, v19
    v_mul_f32 v64, v64, v96
    v_mul_f32 v65, v65, v97
    v_mul_f32 v66, v66, v98
    v_mul_f32 v67, v67, v99
    v_add_f32 v16, 1.0, v16
    v_add_f32 v17, 1.0, v17
    v_add_f32 v18, 1.0, v18
    v_add_f32 v19, 1.0, v19
    v_rcp_f32 v16, v16
    v_rcp_f32 v17, v17
    v_rcp_f32 v18, v18
    v_rcp_f32 v19, v19
    s_nop 0
    v_mul_f32 v64, v64, v16
    v_mul_f32 v65, v65, v17
    v_mul_f32 v66, v66, v18
    v_mul_f32 v67, v67, v19
    v_mul_f32 v16, s36, v68
    v_mul_f32 v17, s36, v69
    v_mul_f32 v18, s36, v70
    v_mul_f32 v19, s36, v71
    v_exp_f32 v16, v16
    v_exp_f32 v17, v17
    v_exp_f32 v18, v18
    v_exp_f32 v19, v19
    v_mul_f32 v68, v68, v100
    v_mul_f32 v69, v69, v101
    v_mul_f32 v70, v70, v102
    v_mul_f32 v71, v71, v103
    v_add_f32 v16, 1.0, v16
    v_add_f32 v17, 1.0, v17
    v_add_f32 v18, 1.0, v18
    v_add_f32 v19, 1.0, v19
    v_rcp_f32 v16, v16
    v_rcp_f32 v17, v17
    v_rcp_f32 v18, v18
    v_rcp_f32 v19, v19
    s_nop 0
    v_mul_f32 v68, v68, v16
    v_mul_f32 v69, v69, v17
    v_mul_f32 v70, v70, v18
    v_mul_f32 v71, v71, v19
    v_cvt_pk_bf16_f32 v88, v56, v57
    v_cvt_pk_bf16_f32 v89, v58, v59
    v_cvt_pk_bf16_f32 v90, v60, v61
    v_cvt_pk_bf16_f32 v91, v62, v63
    v_cvt_pk_bf16_f32 v92, v64, v65
    v_cvt_pk_bf16_f32 v93, v66, v67
    v_cvt_pk_bf16_f32 v94, v68, v69
    v_cvt_pk_bf16_f32 v95, v70, v71
    s_waitcnt vmcnt(0)
    v_cmp_ne_u32 vcc, s74, v220
    s_nop 3
    s_cmp_eq_u64 vcc, 0
    s_cbranch_scc1 parallel_sum__softmax_full_mha__swiglu_ffn__prompt_kernel_qok_16
    s_add_u32 s37, s74, 0
    s_mov_b32 s36, 524288
    s_mov_b32 s68, 0xffffffff
    s_mov_b32 s69, 0xffffffff
parallel_sum__softmax_full_mha__swiglu_ffn__prompt_kernel_poll_17:
    buffer_load_dword v220, v221, s[4:7], 0 offen sc0 sc1
    s_waitcnt vmcnt(0)
    v_cmp_ne_u32 vcc, s37, v220
    s_nop 3
    s_and_b64 vcc, vcc, s[68:69]
    s_sub_u32 s36, s36, 1
    s_cmp_eq_u32 s36, 0
    s_cbranch_scc1 parallel_sum__softmax_full_mha__swiglu_ffn__prompt_kernel_pollx_18
    s_cmp_lg_u64 vcc, 0
    s_cbranch_scc0 parallel_sum__softmax_full_mha__swiglu_ffn__prompt_kernel_pollx_18
    s_sleep 1
    s_branch parallel_sum__softmax_full_mha__swiglu_ffn__prompt_kernel_poll_17
parallel_sum__softmax_full_mha__swiglu_ffn__prompt_kernel_pollx_18:
parallel_sum__softmax_full_mha__swiglu_ffn__prompt_kernel_qok_16:
    buffer_load_dwordx4 v[120:123], v2, s[4:7], s50 offen offset:0 sc1
    buffer_load_dwordx4 v[124:127], v2, s[4:7], s50 offen offset:1024 sc1
    buffer_load_dwordx4 v[128:131], v2, s[4:7], s50 offen offset:2048 sc1
    buffer_load_dwordx4 v[132:135], v2, s[4:7], s50 offen offset:3072 sc1
    s_add_u32 s24, s50, 4096
    buffer_load_dwordx4 v[136:139], v2, s[4:7], s24 offen offset:0 sc1
    buffer_load_dwordx4 v[140:143], v2, s[4:7], s24 offen offset:1024 sc1
    buffer_load_dwordx4 v[144:147], v2, s[4:7], s24 offen offset:2048 sc1
    buffer_load_dwordx4 v[148:151], v2, s[4:7], s24 offen offset:3072 sc1
    buffer_load_dwordx4 v[200:203], v2, s[4:7], s26 offen sc1
    buffer_load_dwordx4 v[204:207], v2, s[4:7], s26 offen offset:1024 sc1
    s_mov_b32 s36, 0xbfb8aa3b
    v_mul_f32 v16, s36, v72
    v_mul_f32 v17, s36, v73
    v_mul_f32 v18, s36, v74
    v_mul_f32 v19, s36, v75
    v_exp_f32 v16, v16
    v_exp_f32 v17, v17
    v_exp_f32 v18, v18
    v_exp_f32 v19, v19
    v_mul_f32 v72, v72, v104
    v_mul_f32 v73, v73, v105
    v_mul_f32 v74, v74, v106
    v_mul_f32 v75, v75, v107
    v_add_f32 v16, 1.0, v16
    v_add_f32 v17, 1.0, v17
    v_add_f32 v18, 1.0, v18
    v_add_f32 v19, 1.0, v19
    v_rcp_f32 v16, v16
    v_rcp_f32 v17, v17
    v_rcp_f32 v18, v18
    v_rcp_f32 v19, v19
    s_nop 0
    v_mul_f32 v72, v72, v16
    v_mul_f32 v73, v73, v17
    v_mul_f32 v74, v74, v18
    v_mul_f32 v75, v75, v19
    v_mul_f32 v16, s36, v76
    v_mul_f32 v17, s36, v77
    v_mul_f32 v18, s36, v78
    v_mul_f32 v19, s36, v79
    v_exp_f32 v16, v16
    v_exp_f32 v17, v17
    v_exp_f32 v18, v18
    v_exp_f32 v19, v19
    v_mul_f32 v76, v76, v108
    v_mul_f32 v77, v77, v109
    v_mul_f32 v78, v78, v110
    v_mul_f32 v79, v79, v111
    v_add_f32 v16, 1.0, v16
    v_add_f32 v17, 1.0, v17
    v_add_f32 v18, 1.0, v18
    v_add_f32 v19, 1.0, v19
    v_rcp_f32 v16, v16
    v_rcp_f32 v17, v17
    v_rcp_f32 v18, v18
    v_rcp_f32 v19, v19
    s_nop 0
    v_mul_f32 v76, v76, v16
    v_mul_f32 v77, v77, v17
    v_mul_f32 v78, v78, v18
    v_mul_f32 v79, v79, v19
    v_mul_f32 v16, s36, v80
    v_mul_f32 v17, s36, v81
    v_mul_f32 v18, s36, v82
    v_mul_f32 v19, s36, v83
    v_exp_f32 v16, v16
    v_exp_f32 v17, v17
    v_exp_f32 v18, v18
    v_exp_f32 v19, v19
    v_mul_f32 v80, v80, v112
    v_mul_f32 v81, v81, v113
    v_mul_f32 v82, v82, v114
    v_mul_f32 v83, v83, v115
    v_add_f32 v16, 1.0, v16
    v_add_f32 v17, 1.0, v17
    v_add_f32 v18, 1.0, v18
    v_add_f32 v19, 1.0, v19
    v_rcp_f32 v16, v16
    v_rcp_f32 v17, v17
    v_rcp_f32 v18, v18
    v_rcp_f32 v19, v19
    s_nop 0
    v_mul_f32 v80, v80, v16
    v_mul_f32 v81, v81, v17
    v_mul_f32 v82, v82, v18
    v_mul_f32 v83, v83, v19
    v_mul_f32 v16, s36, v84
    v_mul_f32 v17, s36, v85
    v_mul_f32 v18, s36, v86
    v_mul_f32 v19, s36, v87
    v_exp_f32 v16, v16
    v_exp_f32 v17, v17
    v_exp_f32 v18, v18
    v_exp_f32 v19, v19
    v_mul_f32 v84, v84, v116
    v_mul_f32 v85, v85, v117
    v_mul_f32 v86, v86, v118
    v_mul_f32 v87, v87, v119
    v_add_f32 v16, 1.0, v16
    v_add_f32 v17, 1.0, v17
    v_add_f32 v18, 1.0, v18
    v_add_f32 v19, 1.0, v19
    v_rcp_f32 v16, v16
    v_rcp_f32 v17, v17
    v_rcp_f32 v18, v18
    v_rcp_f32 v19, v19
    s_nop 0
    v_mul_f32 v84, v84, v16
    v_mul_f32 v85, v85, v17
    v_mul_f32 v86, v86, v18
    v_mul_f32 v87, v87, v19
    v_cvt_pk_bf16_f32 v104, v72, v73
    v_cvt_pk_bf16_f32 v105, v74, v75
    v_cvt_pk_bf16_f32 v106, v76, v77
    v_cvt_pk_bf16_f32 v107, v78, v79
    v_cvt_pk_bf16_f32 v108, v80, v81
    v_cvt_pk_bf16_f32 v109, v82, v83
    v_cvt_pk_bf16_f32 v110, v84, v85
    v_cvt_pk_bf16_f32 v111, v86, v87
    s_mul_i32 s35, s43, 144
    s_add_u32 s35, s35, s45
    s_lshl_b32 s35, s35, 10
    s_add_u32 s35, s35, 6291456
    buffer_store_dwordx4 v[88:91], v2, s[20:23], s35 offen sc0 sc1
    buffer_store_dwordx4 v[92:95], v2, s[20:23], s35 offen offset:1024 sc0 sc1
    s_mul_i32 s35, s44, 144
    s_add_u32 s35, s35, s45
    s_lshl_b32 s35, s35, 10
    s_add_u32 s35, s35, 6291456
    buffer_store_dwordx4 v[104:107], v2, s[20:23], s35 offen sc0 sc1
    buffer_store_dwordx4 v[108:111], v2, s[20:23], s35 offen offset:1024 sc0 sc1
    s_mov_b32 s48, s27
    s_mov_b32 s49, s18
    buffer_load_dwordx4 v[152:155], v2, s[8:11], s48 offen sc1
    buffer_load_dwordx4 v[156:159], v2, s[8:11], s48 offen offset:1024 sc1
    buffer_load_dwordx4 v[160:163], v2, s[12:15], s49 offen sc1
    buffer_load_dwordx4 v[164:167], v2, s[12:15], s49 offen offset:1024 sc1
    s_add_u32 s48, s48, 2048
    s_add_u32 s49, s49, 2048
    buffer_load_dwordx4 v[168:171], v2, s[8:11], s48 offen sc1
    buffer_load_dwordx4 v[172:175], v2, s[8:11], s48 offen offset:1024 sc1
    buffer_load_dwordx4 v[176:179], v2, s[12:15], s49 offen sc1
    buffer_load_dwordx4 v[180:183], v2, s[12:15], s49 offen offset:1024 sc1
    s_add_u32 s48, s48, 2048
    s_add_u32 s49, s49, 2048
    buffer_load_dwordx4 v[184:187], v2, s[8:11], s48 offen sc1
    buffer_load_dwordx4 v[188:191], v2, s[8:11], s48 offen offset:1024 sc1
    buffer_load_dwordx4 v[192:195], v2, s[12:15], s49 offen sc1
    buffer_load_dwordx4 v[196:199], v2, s[12:15], s49 offen offset:1024 sc1
    s_add_u32 s48, s48, 2048
    s_add_u32 s49, s49, 2048
    s_branch parallel_sum__softmax_full_mha__swiglu_ffn__prompt_kernel_phaseB_attn
parallel_sum__softmax_full_mha__swiglu_ffn__prompt_kernel_VH1:
    s_waitcnt vmcnt(0) lgkmcnt(0)
    s_barrier
    v_add_u32 v162, 1792, v152
    s_mov_b32 s52, s72
    s_and_b32 s53, s73, 0xffff
    s_mov_b32 s54, 256
    s_mov_b32 s55, 0x20000
    buffer_load_dword v156, v158, s[52:55], 0 offen sc0 sc1
    s_add_u32 m0, s32, 32768
    s_nop 0
    buffer_load_dwordx4 v152, s[16:19], s30 offen lds
    s_add_u32 m0, s32, 30720
    s_nop 0
    buffer_load_dwordx4 v162, s[16:19], s30 offen lds
    s_add_u32 s30, s30, s51
    s_waitcnt vmcnt(3)
    s_barrier
    s_add_u32 m0, s32, 0
    s_nop 0
    buffer_load_dwordx4 v152, s[16:19], s30 offen lds
    s_add_u32 m0, s32, 4294965248
    s_nop 0
    buffer_load_dwordx4 v162, s[16:19], s30 offen lds
    s_add_u32 s30, s30, s51
    s_waitcnt vmcnt(5)
    s_barrier
    s_add_u32 m0, s32, 8192
    s_nop 0
    buffer_load_dwordx4 v152, s[16:19], s30 offen lds
    s_add_u32 m0, s32, 6144
    s_nop 0
    buffer_load_dwordx4 v162, s[16:19], s30 offen lds
    s_add_u32 s30, s30, s51
    s_waitcnt vmcnt(7)
    s_barrier
    s_add_u32 m0, s32, 16384
    s_nop 0
    buffer_load_dwordx4 v152, s[16:19], s30 offen lds
    s_add_u32 m0, s32, 14336
    s_nop 0
    buffer_load_dwordx4 v162, s[16:19], s30 offen lds
    s_add_u32 s30, s30, s51
    s_waitcnt vmcnt(6)
    s_barrier
    s_add_u32 m0, s32, 24576
    s_nop 0
    buffer_load_dwordx4 v152, s[16:19], s30 offen lds
    s_add_u32 m0, s32, 22528
    s_nop 0
    buffer_load_dwordx4 v162, s[16:19], s30 offen lds
    s_add_u32 s30, s30, s51
    s_waitcnt vmcnt(6)
    s_barrier
    s_add_u32 m0, s32, 32768
    s_nop 0
    buffer_load_dwordx4 v152, s[16:19], s30 offen lds
    s_add_u32 m0, s32, 30720
    s_nop 0
    buffer_load_dwordx4 v162, s[16:19], s30 offen lds
    s_add_u32 s30, s30, s51
    s_waitcnt vmcnt(6)
    s_barrier
    s_add_u32 m0, s32, 0
    s_nop 0
    buffer_load_dwordx4 v152, s[16:19], s30 offen lds
    s_add_u32 m0, s32, 4294965248
    s_nop 0
    buffer_load_dwordx4 v162, s[16:19], s30 offen lds
    s_add_u32 s30, s30, s51
    s_waitcnt vmcnt(6)
    s_barrier
    s_add_u32 m0, s32, 8192
    s_nop 0
    buffer_load_dwordx4 v152, s[16:19], s30 offen lds
    s_add_u32 m0, s32, 6144
    s_nop 0
    buffer_load_dwordx4 v162, s[16:19], s30 offen lds
    s_add_u32 s30, s30, s51
    s_waitcnt vmcnt(6)
    s_barrier
    s_add_u32 m0, s32, 16384
    s_nop 0
    buffer_load_dwordx4 v152, s[16:19], s30 offen lds
    s_add_u32 m0, s32, 14336
    s_nop 0
    buffer_load_dwordx4 v162, s[16:19], s30 offen lds
    s_add_u32 s30, s30, s51
    s_waitcnt vmcnt(6)
    s_barrier
    s_add_u32 m0, s32, 24576
    s_nop 0
    buffer_load_dwordx4 v152, s[16:19], s30 offen lds
    s_add_u32 m0, s32, 22528
    s_nop 0
    buffer_load_dwordx4 v162, s[16:19], s30 offen lds
    s_add_u32 s30, s30, s51
    s_waitcnt vmcnt(6)
    s_barrier
    s_waitcnt vmcnt(4)
    s_barrier
    s_waitcnt vmcnt(2)
    s_barrier
    s_waitcnt vmcnt(0)
    s_barrier
    s_waitcnt vmcnt(0)
    s_barrier
    v_readfirstlane_b32 s74, v156
    s_nop 3
    s_cmp_lg_u32 s74, 0
    s_cbranch_scc1 parallel_sum__softmax_full_mha__swiglu_ffn__prompt_kernel_havetag_19
    s_mov_b32 s52, s72
    s_and_b32 s53, s73, 0xffff
    s_mov_b32 s54, 256
    s_mov_b32 s55, 0x20000
    s_mov_b32 s36, 524288
    v_mov_b32 v10, 0
parallel_sum__softmax_full_mha__swiglu_ffn__prompt_kernel_tag_20:
    buffer_load_dword v9, v10, s[52:55], 0 offen sc0 sc1
    s_waitcnt vmcnt(0)
    v_readfirstlane_b32 s74, v9
    s_nop 1
    s_sub_u32 s36, s36, 1
    s_cmp_eq_u32 s36, 0
    s_cbranch_scc1 parallel_sum__softmax_full_mha__swiglu_ffn__prompt_kernel_tagx_21
    s_cmp_eq_u32 s74, 0
    s_cbranch_scc1 parallel_sum__softmax_full_mha__swiglu_ffn__prompt_kernel_tag_20
parallel_sum__softmax_full_mha__swiglu_ffn__prompt_kernel_tagx_21:
parallel_sum__softmax_full_mha__swiglu_ffn__prompt_kernel_havetag_19:
    s_lshl_b32 s35, s28, 11
    v_add_u32 v155, s35, v3
    v_xor_b32 v157, 32, v155
    s_mul_i32 s35, s28, 6144
    s_add_u32 s33, s33, s35
    s_mul_i32 s31, s28, 57344
    s_add_u32 m0, s33, 0
    s_nop 0
    buffer_load_dwordx4 v153, s[8:11], s31 offen lds
    s_add_u32 s31, s31, 114688
    s_add_u32 m0, s33, 12288
    s_nop 0
    buffer_load_dwordx4 v153, s[8:11], s31 offen lds
    s_add_u32 s31, s31, 114688
    s_add_u32 m0, s33, 24576
    s_nop 0
    buffer_load_dwordx4 v153, s[8:11], s31 offen lds
    s_add_u32 s31, s31, 114688
    s_nop 7
    s_waitcnt vmcnt(2) lgkmcnt(0)
    s_barrier
    ds_read_b64_tr_b16 v[180:181], v5 offset:0
    ds_read_b64_tr_b16 v[182:183], v5 offset:256
    ds_read_b64_tr_b16 v[184:185], v5 offset:1024
    ds_read_b64_tr_b16 v[186:187], v5 offset:1280
    ds_read_b128 v[176:179], v155 offset:0
    ds_read_b64_tr_b16 v[192:193], v5 offset:6144
    ds_read_b64_tr_b16 v[194:195], v5 offset:6400
    ds_read_b64_tr_b16 v[196:197], v5 offset:7168
    ds_read_b64_tr_b16 v[198:199], v5 offset:7424
    ds_read_b128 v[188:191], v157 offset:0
    s_waitcnt lgkmcnt(0)
    v_mfma_f32_32x32x16_bf16 v[56:71], v[180:183], v[176:179], 0
    s_waitcnt vmcnt(1)
    s_barrier
    v_mfma_f32_32x32x16_bf16 v[88:103], v[184:187], v[176:179], 0
    ds_read_b64_tr_b16 v[204:205], v5 offset:12288
    ds_read_b64_tr_b16 v[206:207], v5 offset:12544
    ds_read_b64_tr_b16 v[208:209], v5 offset:13312
    ds_read_b64_tr_b16 v[210:211], v5 offset:13568
    ds_read_b128 v[200:203], v155 offset:8192
    v_mfma_f32_32x32x16_bf16 v[56:71], v[192:195], v[188:191], v[56:71]
    ds_read_b64_tr_b16 v[216:217], v5 offset:18432
    ds_read_b64_tr_b16 v[218:219], v5 offset:18688
    ds_read_b64_tr_b16 v[220:221], v5 offset:19456
    ds_read_b64_tr_b16 v[222:223], v5 offset:19712
    ds_read_b128 v[212:215], v157 offset:8192
    v_mfma_f32_32x32x16_bf16 v[88:103], v[196:199], v[188:191], v[88:103]
    s_add_u32 m0, s33, 0
    s_nop 0
    buffer_load_dwordx4 v153, s[8:11], s31 offen lds
    s_add_u32 s31, s31, 114688
    s_waitcnt lgkmcnt(0)
    v_mfma_f32_32x32x16_bf16 v[56:71], v[204:207], v[200:203], v[56:71]
    s_waitcnt vmcnt(1)
    s_barrier
    v_mfma_f32_32x32x16_bf16 v[88:103], v[208:211], v[200:203], v[88:103]
    ds_read_b64_tr_b16 v[180:181], v5 offset:24576
    ds_read_b64_tr_b16 v[182:183], v5 offset:24832
    ds_read_b64_tr_b16 v[184:185], v5 offset:25600
    ds_read_b64_tr_b16 v[186:187], v5 offset:25856
    ds_read_b128 v[176:179], v155 offset:16384
    v_mfma_f32_32x32x16_bf16 v[56:71], v[216:219], v[212:215], v[56:71]
    ds_read_b64_tr_b16 v[192:193], v5 offset:30720
    ds_read_b64_tr_b16 v[194:195], v5 offset:30976
    ds_read_b64_tr_b16 v[196:197], v5 offset:31744
    ds_read_b64_tr_b16 v[198:199], v5 offset:32000
    ds_read_b128 v[188:191], v157 offset:16384
    v_mfma_f32_32x32x16_bf16 v[88:103], v[220:223], v[212:215], v[88:103]
    s_add_u32 m0, s33, 12288
    s_nop 0
    buffer_load_dwordx4 v153, s[8:11], s31 offen lds
    s_add_u32 s31, s31, 114688
    s_waitcnt lgkmcnt(0)
    v_mfma_f32_32x32x16_bf16 v[56:71], v[180:183], v[176:179], v[56:71]
    s_waitcnt vmcnt(1)
    s_barrier
    v_mfma_f32_32x32x16_bf16 v[88:103], v[184:187], v[176:179], v[88:103]
    ds_read_b64_tr_b16 v[204:205], v5 offset:0
    ds_read_b64_tr_b16 v[206:207], v5 offset:256
    ds_read_b64_tr_b16 v[208:209], v5 offset:1024
    ds_read_b64_tr_b16 v[210:211], v5 offset:1280
    ds_read_b128 v[200:203], v155 offset:24576
    v_mfma_f32_32x32x16_bf16 v[56:71], v[192:195], v[188:191], v[56:71]
    ds_read_b64_tr_b16 v[216:217], v5 offset:6144
    ds_read_b64_tr_b16 v[218:219], v5 offset:6400
    ds_read_b64_tr_b16 v[220:221], v5 offset:7168
    ds_read_b64_tr_b16 v[222:223], v5 offset:7424
    ds_read_b128 v[212:215], v157 offset:24576
    v_mfma_f32_32x32x16_bf16 v[88:103], v[196:199], v[188:191], v[88:103]
    s_add_u32 m0, s33, 24576
    s_nop 0
    buffer_load_dwordx4 v153, s[8:11], s31 offen lds
    s_add_u32 s31, s31, 114688
    s_waitcnt lgkmcnt(0)
    v_mfma_f32_32x32x16_bf16 v[56:71], v[204:207], v[200:203], v[56:71]
    s_waitcnt vmcnt(1)
    s_barrier
    v_mfma_f32_32x32x16_bf16 v[88:103], v[208:211], v[200:203], v[88:103]
    v_add_u32 v155, 32768, v155
    v_add_u32 v157, 32768, v157
    ds_read_b64_tr_b16 v[180:181], v5 offset:12288
    ds_read_b64_tr_b16 v[182:183], v5 offset:12544
    ds_read_b64_tr_b16 v[184:185], v5 offset:13312
    ds_read_b64_tr_b16 v[186:187], v5 offset:13568
    v_mfma_f32_32x32x16_bf16 v[56:71], v[216:219], v[212:215], v[56:71]
    ds_read_b128 v[176:179], v155 offset:0
    ds_read_b64_tr_b16 v[192:193], v5 offset:18432
    ds_read_b64_tr_b16 v[194:195], v5 offset:18688
    ds_read_b64_tr_b16 v[196:197], v5 offset:19456
    ds_read_b64_tr_b16 v[198:199], v5 offset:19712
    ds_read_b128 v[188:191], v157 offset:0
    v_mfma_f32_32x32x16_bf16 v[88:103], v[220:223], v[212:215], v[88:103]
    s_add_u32 m0, s33, 0
    s_nop 0
    buffer_load_dwordx4 v153, s[8:11], s31 offen lds
    s_add_u32 s31, s31, 114688
    v_mov_b32 v9, 155648
    v_mov_b32 v10, 1
    s_mov_b64 exec, 1
    ds_add_rtn_u32 v10, v9, v10
    s_waitcnt lgkmcnt(0)
    s_mov_b64 exec, -1
    v_readfirstlane_b32 s35, v10
    s_nop 3
    s_cmp_lg_u32 s35, 7
    s_cbranch_scc1 parallel_sum__softmax_full_mha__swiglu_ffn__prompt_kernel_arr_22
    s_lshl_b32 s35, s2, 6
    s_add_u32 s35, s35, 25296896
    v_mov_b32 v9, s74
    v_mov_b32 v10, 0
    s_mov_b64 exec, 1
    buffer_store_dword v9, v10, s[20:23], s35 offen sc0 sc1
    s_mov_b64 exec, -1
parallel_sum__softmax_full_mha__swiglu_ffn__prompt_kernel_arr_22:
    s_waitcnt lgkmcnt(0)
    v_mfma_f32_32x32x16_bf16 v[56:71], v[180:183], v[176:179], v[56:71]
    s_waitcnt vmcnt(1)
    s_barrier
    v_mfma_f32_32x32x16_bf16 v[88:103], v[184:187], v[176:179], v[88:103]
    ds_read_b64_tr_b16 v[204:205], v5 offset:24576
    ds_read_b64_tr_b16 v[206:207], v5 offset:24832
    ds_read_b64_tr_b16 v[208:209], v5 offset:25600
    ds_read_b64_tr_b16 v[210:211], v5 offset:25856
    ds_read_b128 v[200:203], v155 offset:8192
    v_mfma_f32_32x32x16_bf16 v[56:71], v[192:195], v[188:191], v[56:71]
    ds_read_b64_tr_b16 v[216:217], v5 offset:30720
    ds_read_b64_tr_b16 v[218:219], v5 offset:30976
    ds_read_b64_tr_b16 v[220:221], v5 offset:31744
    ds_read_b64_tr_b16 v[222:223], v5 offset:32000
    ds_read_b128 v[212:215], v157 offset:8192
    v_mfma_f32_32x32x16_bf16 v[88:103], v[196:199], v[188:191], v[88:103]
    s_add_u32 m0, s33, 12288
    s_nop 0
    buffer_load_dwordx4 v153, s[8:11], s31 offen lds
    s_add_u32 s31, s31, 114688
    s_waitcnt lgkmcnt(0)
    v_mfma_f32_32x32x16_bf16 v[56:71], v[204:207], v[200:203], v[56:71]
    s_waitcnt vmcnt(1)
    s_barrier
    v_mfma_f32_32x32x16_bf16 v[88:103], v[208:211], v[200:203], v[88:103]
    ds_read_b64_tr_b16 v[180:181], v5 offset:0
    ds_read_b64_tr_b16 v[182:183], v5 offset:256
    ds_read_b64_tr_b16 v[184:185], v5 offset:1024
    ds_read_b64_tr_b16 v[186:187], v5 offset:1280
    ds_read_b128 v[176:179], v155 offset:16384
    v_mfma_f32_32x32x16_bf16 v[56:71], v[216:219], v[212:215], v[56:71]
    ds_read_b64_tr_b16 v[192:193], v5 offset:6144
    ds_read_b64_tr_b16 v[194:195], v5 offset:6400
    ds_read_b64_tr_b16 v[196:197], v5 offset:7168
    ds_read_b64_tr_b16 v[198:199], v5 offset:7424
    ds_read_b128 v[188:191], v157 offset:16384
    v_mfma_f32_32x32x16_bf16 v[88:103], v[220:223], v[212:215], v[88:103]
    s_add_u32 m0, s33, 24576
    s_nop 0
    buffer_load_dwordx4 v153, s[8:11], s31 offen lds
    s_add_u32 s31, s31, 114688
    s_waitcnt lgkmcnt(0)
    v_mfma_f32_32x32x16_bf16 v[56:71], v[180:183], v[176:179], v[56:71]
    s_waitcnt vmcnt(1)
    s_barrier
    v_mfma_f32_32x32x16_bf16 v[88:103], v[184:187], v[176:179], v[88:103]
    ds_read_b64_tr_b16 v[204:205], v5 offset:12288
    ds_read_b64_tr_b16 v[206:207], v5 offset:12544
    ds_read_b64_tr_b16 v[208:209], v5 offset:13312
    ds_read_b64_tr_b16 v[210:211], v5 offset:13568
    ds_read_b128 v[200:203], v155 offset:24576
    v_mfma_f32_32x32x16_bf16 v[56:71], v[192:195], v[188:191], v[56:71]
    ds_read_b64_tr_b16 v[216:217], v5 offset:18432
    ds_read_b64_tr_b16 v[218:219], v5 offset:18688
    ds_read_b64_tr_b16 v[220:221], v5 offset:19456
    ds_read_b64_tr_b16 v[222:223], v5 offset:19712
    ds_read_b128 v[212:215], v157 offset:24576
    v_mfma_f32_32x32x16_bf16 v[88:103], v[196:199], v[188:191], v[88:103]
    s_add_u32 m0, s33, 0
    s_nop 0
    buffer_load_dwordx4 v153, s[8:11], s31 offen lds
    s_add_u32 s31, s31, 114688
    s_waitcnt lgkmcnt(0)
    v_mfma_f32_32x32x16_bf16 v[56:71], v[204:207], v[200:203], v[56:71]
    s_waitcnt vmcnt(1)
    s_barrier
    v_mfma_f32_32x32x16_bf16 v[88:103], v[208:211], v[200:203], v[88:103]
    v_add_u32 v155, 32768, v155
    v_add_u32 v157, 32768, v157
    ds_read_b64_tr_b16 v[180:181], v5 offset:24576
    ds_read_b64_tr_b16 v[182:183], v5 offset:24832
    ds_read_b64_tr_b16 v[184:185], v5 offset:25600
    ds_read_b64_tr_b16 v[186:187], v5 offset:25856
    v_mfma_f32_32x32x16_bf16 v[56:71], v[216:219], v[212:215], v[56:71]
    ds_read_b128 v[176:179], v155 offset:0
    ds_read_b64_tr_b16 v[192:193], v5 offset:30720
    ds_read_b64_tr_b16 v[194:195], v5 offset:30976
    ds_read_b64_tr_b16 v[196:197], v5 offset:31744
    ds_read_b64_tr_b16 v[198:199], v5 offset:32000
    ds_read_b128 v[188:191], v157 offset:0
    v_mfma_f32_32x32x16_bf16 v[88:103], v[220:223], v[212:215], v[88:103]
    s_add_u32 m0, s33, 12288
    s_nop 0
    buffer_load_dwordx4 v153, s[8:11], s31 offen lds
    s_add_u32 s31, s31, 114688
    s_waitcnt lgkmcnt(0)
    v_mfma_f32_32x32x16_bf16 v[56:71], v[180:183], v[176:179], v[56:71]
    s_waitcnt vmcnt(1)
    s_barrier
    v_mfma_f32_32x32x16_bf16 v[88:103], v[184:187], v[176:179], v[88:103]
    ds_read_b64_tr_b16 v[204:205], v5 offset:0
    ds_read_b64_tr_b16 v[206:207], v5 offset:256
    ds_read_b64_tr_b16 v[208:209], v5 offset:1024
    ds_read_b64_tr_b16 v[210:211], v5 offset:1280
    ds_read_b128 v[200:203], v155 offset:8192
    v_mfma_f32_32x32x16_bf16 v[56:71], v[192:195], v[188:191], v[56:71]
    ds_read_b64_tr_b16 v[216:217], v5 offset:6144
    ds_read_b64_tr_b16 v[218:219], v5 offset:6400
    ds_read_b64_tr_b16 v[220:221], v5 offset:7168
    ds_read_b64_tr_b16 v[222:223], v5 offset:7424
    ds_read_b128 v[212:215], v157 offset:8192
    v_mfma_f32_32x32x16_bf16 v[88:103], v[196:199], v[188:191], v[88:103]
    s_add_u32 m0, s33, 24576
    s_nop 0
    buffer_load_dwordx4 v153, s[8:11], s31 offen lds
    s_add_u32 s31, s31, 114688
    s_waitcnt lgkmcnt(0)
    v_mfma_f32_32x32x16_bf16 v[56:71], v[204:207], v[200:203], v[56:71]
    s_waitcnt vmcnt(1)
    s_barrier
    v_mfma_f32_32x32x16_bf16 v[88:103], v[208:211], v[200:203], v[88:103]
    ds_read_b64_tr_b16 v[180:181], v5 offset:12288
    ds_read_b64_tr_b16 v[182:183], v5 offset:12544
    ds_read_b64_tr_b16 v[184:185], v5 offset:13312
    ds_read_b64_tr_b16 v[186:187], v5 offset:13568
    ds_read_b128 v[176:179], v155 offset:16384
    v_mfma_f32_32x32x16_bf16 v[56:71], v[216:219], v[212:215], v[56:71]
    ds_read_b64_tr_b16 v[192:193], v5 offset:18432
    ds_read_b64_tr_b16 v[194:195], v5 offset:18688
    ds_read_b64_tr_b16 v[196:197], v5 offset:19456
    ds_read_b64_tr_b16 v[198:199], v5 offset:19712
    ds_read_b128 v[188:191], v157 offset:16384
    v_mfma_f32_32x32x16_bf16 v[88:103], v[220:223], v[212:215], v[88:103]
    s_add_u32 m0, s33, 0
    s_nop 0
    buffer_load_dwordx4 v153, s[8:11], s31 offen lds
    s_add_u32 s31, s31, 114688
    s_waitcnt lgkmcnt(0)
    v_mfma_f32_32x32x16_bf16 v[56:71], v[180:183], v[176:179], v[56:71]
    s_waitcnt vmcnt(1)
    s_barrier
    v_mfma_f32_32x32x16_bf16 v[88:103], v[184:187], v[176:179], v[88:103]
    ds_read_b64_tr_b16 v[204:205], v5 offset:24576
    ds_read_b64_tr_b16 v[206:207], v5 offset:24832
    ds_read_b64_tr_b16 v[208:209], v5 offset:25600
    ds_read_b64_tr_b16 v[210:211], v5 offset:25856
    ds_read_b128 v[200:203], v155 offset:24576
    v_mfma_f32_32x32x16_bf16 v[56:71], v[192:195], v[188:191], v[56:71]
    ds_read_b64_tr_b16 v[216:217], v5 offset:30720
    ds_read_b64_tr_b16 v[218:219], v5 offset:30976
    ds_read_b64_tr_b16 v[220:221], v5 offset:31744
    ds_read_b64_tr_b16 v[222:223], v5 offset:32000
    ds_read_b128 v[212:215], v157 offset:24576
    v_mfma_f32_32x32x16_bf16 v[88:103], v[196:199], v[188:191], v[88:103]
    s_add_u32 m0, s33, 12288
    s_nop 0
    buffer_load_dwordx4 v153, s[8:11], s31 offen lds
    s_add_u32 s31, s31, 114688
    s_waitcnt lgkmcnt(0)
    v_mfma_f32_32x32x16_bf16 v[56:71], v[204:207], v[200:203], v[56:71]
    s_waitcnt vmcnt(1)
    s_barrier
    v_mfma_f32_32x32x16_bf16 v[88:103], v[208:211], v[200:203], v[88:103]
    v_add_u32 v155, 32768, v155
    v_add_u32 v157, 32768, v157
    ds_read_b64_tr_b16 v[180:181], v5 offset:0
    ds_read_b64_tr_b16 v[182:183], v5 offset:256
    ds_read_b64_tr_b16 v[184:185], v5 offset:1024
    ds_read_b64_tr_b16 v[186:187], v5 offset:1280
    v_mfma_f32_32x32x16_bf16 v[56:71], v[216:219], v[212:215], v[56:71]
    ds_read_b128 v[176:179], v155 offset:0
    ds_read_b64_tr_b16 v[192:193], v5 offset:6144
    ds_read_b64_tr_b16 v[194:195], v5 offset:6400
    ds_read_b64_tr_b16 v[196:197], v5 offset:7168
    ds_read_b64_tr_b16 v[198:199], v5 offset:7424
    ds_read_b128 v[188:191], v157 offset:0
    v_mfma_f32_32x32x16_bf16 v[88:103], v[220:223], v[212:215], v[88:103]
    s_waitcnt lgkmcnt(0)
    v_mfma_f32_32x32x16_bf16 v[56:71], v[180:183], v[176:179], v[56:71]
    s_waitcnt vmcnt(0)
    s_barrier
    v_mfma_f32_32x32x16_bf16 v[88:103], v[184:187], v[176:179], v[88:103]
    ds_read_b64_tr_b16 v[204:205], v5 offset:12288
    ds_read_b64_tr_b16 v[206:207], v5 offset:12544
    ds_read_b64_tr_b16 v[208:209], v5 offset:13312
    ds_read_b64_tr_b16 v[210:211], v5 offset:13568
    ds_read_b128 v[200:203], v155 offset:8192
    v_mfma_f32_32x32x16_bf16 v[56:71], v[192:195], v[188:191], v[56:71]
    ds_read_b64_tr_b16 v[216:217], v5 offset:18432
    ds_read_b64_tr_b16 v[218:219], v5 offset:18688
    ds_read_b64_tr_b16 v[220:221], v5 offset:19456
    ds_read_b64_tr_b16 v[222:223], v5 offset:19712
    ds_read_b128 v[212:215], v157 offset:8192
    v_mfma_f32_32x32x16_bf16 v[88:103], v[196:199], v[188:191], v[88:103]
    s_waitcnt lgkmcnt(0)
    v_mfma_f32_32x32x16_bf16 v[56:71], v[204:207], v[200:203], v[56:71]
    v_mfma_f32_32x32x16_bf16 v[88:103], v[208:211], v[200:203], v[88:103]
    v_mfma_f32_32x32x16_bf16 v[56:71], v[216:219], v[212:215], v[56:71]
    v_mfma_f32_32x32x16_bf16 v[88:103], v[220:223], v[212:215], v[88:103]
    s_barrier
    s_nop 10
    s_mov_b32 s36, 0xbfb8aa3b
    v_mul_f32 v16, s36, v56
    v_mul_f32 v17, s36, v57
    v_mul_f32 v18, s36, v58
    v_mul_f32 v19, s36, v59
    v_exp_f32 v16, v16
    v_exp_f32 v17, v17
    v_exp_f32 v18, v18
    v_exp_f32 v19, v19
    v_mul_f32 v56, v56, v88
    v_mul_f32 v57, v57, v89
    v_mul_f32 v58, v58, v90
    v_mul_f32 v59, v59, v91
    v_add_f32 v16, 1.0, v16
    v_add_f32 v17, 1.0, v17
    v_add_f32 v18, 1.0, v18
    v_add_f32 v19, 1.0, v19
    v_rcp_f32 v16, v16
    v_rcp_f32 v17, v17
    v_rcp_f32 v18, v18
    v_rcp_f32 v19, v19
    s_nop 0
    v_mul_f32 v56, v56, v16
    v_mul_f32 v57, v57, v17
    v_mul_f32 v58, v58, v18
    v_mul_f32 v59, v59, v19
    v_mul_f32 v16, s36, v60
    v_mul_f32 v17, s36, v61
    v_mul_f32 v18, s36, v62
    v_mul_f32 v19, s36, v63
    v_exp_f32 v16, v16
    v_exp_f32 v17, v17
    v_exp_f32 v18, v18
    v_exp_f32 v19, v19
    v_mul_f32 v60, v60, v92
    v_mul_f32 v61, v61, v93
    v_mul_f32 v62, v62, v94
    v_mul_f32 v63, v63, v95
    v_add_f32 v16, 1.0, v16
    v_add_f32 v17, 1.0, v17
    v_add_f32 v18, 1.0, v18
    v_add_f32 v19, 1.0, v19
    v_rcp_f32 v16, v16
    v_rcp_f32 v17, v17
    v_rcp_f32 v18, v18
    v_rcp_f32 v19, v19
    s_nop 0
    v_mul_f32 v60, v60, v16
    v_mul_f32 v61, v61, v17
    v_mul_f32 v62, v62, v18
    v_mul_f32 v63, v63, v19
    v_mul_f32 v16, s36, v64
    v_mul_f32 v17, s36, v65
    v_mul_f32 v18, s36, v66
    v_mul_f32 v19, s36, v67
    v_exp_f32 v16, v16
    v_exp_f32 v17, v17
    v_exp_f32 v18, v18
    v_exp_f32 v19, v19
    v_mul_f32 v64, v64, v96
    v_mul_f32 v65, v65, v97
    v_mul_f32 v66, v66, v98
    v_mul_f32 v67, v67, v99
    v_add_f32 v16, 1.0, v16
    v_add_f32 v17, 1.0, v17
    v_add_f32 v18, 1.0, v18
    v_add_f32 v19, 1.0, v19
    v_rcp_f32 v16, v16
    v_rcp_f32 v17, v17
    v_rcp_f32 v18, v18
    v_rcp_f32 v19, v19
    s_nop 0
    v_mul_f32 v64, v64, v16
    v_mul_f32 v65, v65, v17
    v_mul_f32 v66, v66, v18
    v_mul_f32 v67, v67, v19
    v_mul_f32 v16, s36, v68
    v_mul_f32 v17, s36, v69
    v_mul_f32 v18, s36, v70
    v_mul_f32 v19, s36, v71
    v_exp_f32 v16, v16
    v_exp_f32 v17, v17
    v_exp_f32 v18, v18
    v_exp_f32 v19, v19
    v_mul_f32 v68, v68, v100
    v_mul_f32 v69, v69, v101
    v_mul_f32 v70, v70, v102
    v_mul_f32 v71, v71, v103
    v_add_f32 v16, 1.0, v16
    v_add_f32 v17, 1.0, v17
    v_add_f32 v18, 1.0, v18
    v_add_f32 v19, 1.0, v19
    v_rcp_f32 v16, v16
    v_rcp_f32 v17, v17
    v_rcp_f32 v18, v18
    v_rcp_f32 v19, v19
    s_nop 0
    v_mul_f32 v68, v68, v16
    v_mul_f32 v69, v69, v17
    v_mul_f32 v70, v70, v18
    v_mul_f32 v71, v71, v19
    v_cvt_pk_bf16_f32 v88, v56, v57
    v_cvt_pk_bf16_f32 v89, v58, v59
    v_cvt_pk_bf16_f32 v90, v60, v61
    v_cvt_pk_bf16_f32 v91, v62, v63
    v_cvt_pk_bf16_f32 v92, v64, v65
    v_cvt_pk_bf16_f32 v93, v66, v67
    v_cvt_pk_bf16_f32 v94, v68, v69
    v_cvt_pk_bf16_f32 v95, v70, v71
    s_add_u32 s35, s43, s28
    s_mul_i32 s35, s35, 144
    s_add_u32 s35, s35, s45
    s_lshl_b32 s35, s35, 10
    s_add_u32 s35, s35, 6291456
    buffer_store_dwordx4 v[88:91], v2, s[20:23], s35 offen sc0 sc1
    buffer_store_dwordx4 v[92:95], v2, s[20:23], s35 offen offset:1024 sc0 sc1
    s_waitcnt vmcnt(0)
    v_mov_b32 v9, 155652
    v_mov_b32 v10, 1
    s_mov_b64 exec, 1
    ds_add_rtn_u32 v10, v9, v10
    s_waitcnt lgkmcnt(0)
    s_mov_b64 exec, -1
    v_readfirstlane_b32 s35, v10
    s_nop 3
    s_cmp_lg_u32 s35, 7
    s_cbranch_scc1 parallel_sum__softmax_full_mha__swiglu_ffn__prompt_kernel_arr_23
    s_lshl_b32 s35, s2, 6
    s_add_u32 s35, s35, 25165824
    v_mov_b32 v9, s74
    v_mov_b32 v10, 0
    s_mov_b64 exec, 1
    buffer_store_dword v9, v10, s[20:23], s35 offen sc0 sc1
    s_mov_b64 exec, -1
parallel_sum__softmax_full_mha__swiglu_ffn__prompt_kernel_arr_23:
    s_load_dwordx2 s[52:53], s[0:1], 56
    s_sub_u32 s39, s3, 4
    s_and_b32 s33, s2, 7
    s_lshr_b32 s34, s2, 3
    s_and_b32 s24, s34, 3
    s_lshl_b32 s33, s33, 2
    s_add_u32 s24, s24, s33
    s_lshr_b32 s29, s34, 2
    v_lshrrev_b32 v7, 3, v1
    v_and_b32 v8, 7, v1
    v_bfe_u32 v11, v1, 4, 1
    v_lshlrev_b32 v11, 2, v11
    v_xor_b32 v8, v8, v11
    v_lshlrev_b32 v8, 4, v8
    v_mul_u32_u24 v7, 896, v7
    s_lshl_b32 s33, s29, 7
    v_add3_u32 v3, v7, v8, s33
    v_lshrrev_b32 v7, 5, v1
    v_bfe_u32 v8, v1, 2, 2
    v_lshl_add_u32 v7, v7, 2, v8
    v_lshlrev_b32 v7, 7, v7
    v_bfe_u32 v11, v1, 4, 1
    v_bfe_u32 v12, v1, 1, 1
    v_lshl_add_u32 v11, v11, 1, v12
    v_bfe_u32 v12, v1, 3, 1
    v_lshlrev_b32 v12, 2, v12
    v_xor_b32 v11, v11, v12
    v_lshl_add_u32 v7, v11, 4, v7
    v_and_b32 v12, 1, v1
    v_lshl_add_u32 v7, v12, 3, v7
    s_mul_i32 s38, s39, 16384
    s_add_u32 s38, s38, 66560
    v_add_u32 v4, s38, v7
    v_xor_b32 v5, 64, v4
    s_and_b32 s34, s39, 1
    s_lshl_b32 s34, s34, 5
    s_lshl_b32 s33, s24, 6
    s_add_u32 s34, s34, s33
    v_and_b32 v7, 31, v1
    v_add_u32 v7, s34, v7
    v_mul_u32_u24 v7, 896, v7
    s_lshr_b32 s33, s39, 1
    s_lshl_b32 s33, s33, 6
    s_lshl_b32 s34, s29, 7
    s_add_u32 s33, s33, s34
    v_lshrrev_b32 v8, 5, v1
    v_lshlrev_b32 v8, 4, v8
    v_add3_u32 v6, v7, v8, s33
    s_waitcnt lgkmcnt(0)
    s_mov_b32 s4, s70
    s_and_b32 s5, s71, 0xffff
    s_mov_b32 s6, 33554432
    s_mov_b32 s7, 0x20000
    s_mov_b32 s8, s64
    s_and_b32 s9, s65, 0xffff
    s_mov_b32 s10, 1605632
    s_mov_b32 s11, 0x20000
    s_mov_b32 s12, s66
    s_and_b32 s13, s67, 0xffff
    s_mov_b32 s14, 401408
    s_mov_b32 s15, 0x20000
    s_mov_b32 s16, s56
    s_and_b32 s17, s57, 0xffff
    s_mov_b32 s18, 1835008
    s_mov_b32 s19, 0x20000
    s_mov_b32 s60, s52
    s_and_b32 s61, s53, 0xffff
    s_mov_b32 s62, 1835008
    s_mov_b32 s63, 0x20000
    s_lshl_b32 s48, s39, 3
    s_add_u32 s48, s48, 24
    s_mul_i32 s49, s39, 6
    s_mul_i32 s31, s24, 288
    s_lshl_b32 s33, s49, 1
    s_add_u32 s31, s31, s33
    s_lshl_b32 s31, s31, 10
    s_add_u32 s31, s31, 6291456
    s_mov_b32 s51, s31
    s_mul_i32 s50, s49, 28672
    s_mul_i32 s31, s24, 288
    s_lshl_b32 s33, s48, 1
    s_add_u32 s31, s31, s33
    s_lshl_b32 s31, s31, 10
    s_add_u32 s31, s31, 6291456
    s_mul_i32 s32, s48, 28672
    s_add_u32 m0, s38, 0
    s_nop 0
    buffer_load_dwordx4 v3, s[8:11], s32 offen lds
    s_add_u32 m0, s38, 1024
    s_add_u32 s32, s32, 7168
    buffer_load_dwordx4 v3, s[8:11], s32 offen lds
    s_add_u32 m0, s38, 2048
    s_add_u32 s32, s32, 7168
    buffer_load_dwordx4 v3, s[8:11], s32 offen lds
    s_add_u32 m0, s38, 3072
    s_add_u32 s32, s32, 7168
    buffer_load_dwordx4 v3, s[8:11], s32 offen lds
    s_add_u32 s32, s32, 7168
    s_add_u32 m0, s38, 4096
    s_nop 0
    buffer_load_dwordx4 v3, s[8:11], s32 offen lds
    s_add_u32 m0, s38, 5120
    s_add_u32 s32, s32, 7168
    buffer_load_dwordx4 v3, s[8:11], s32 offen lds
    s_add_u32 m0, s38, 6144
    s_add_u32 s32, s32, 7168
    buffer_load_dwordx4 v3, s[8:11], s32 offen lds
    s_add_u32 m0, s38, 7168
    s_add_u32 s32, s32, 7168
    buffer_load_dwordx4 v3, s[8:11], s32 offen lds
    s_add_u32 s32, s32, 7168
    s_add_u32 m0, s38, 8192
    s_nop 0
    buffer_load_dwordx4 v3, s[8:11], s32 offen lds
    s_add_u32 m0, s38, 9216
    s_add_u32 s32, s32, 7168
    buffer_load_dwordx4 v3, s[8:11], s32 offen lds
    s_add_u32 m0, s38, 10240
    s_add_u32 s32, s32, 7168
    buffer_load_dwordx4 v3, s[8:11], s32 offen lds
    s_add_u32 m0, s38, 11264
    s_add_u32 s32, s32, 7168
    buffer_load_dwordx4 v3, s[8:11], s32 offen lds
    s_add_u32 s32, s32, 7168
    buffer_load_dwordx4 v[188:191], v6, s[16:19], 0 offen
    buffer_load_dwordx4 v[192:195], v6, s[16:19], 0 offen offset:32
    s_branch parallel_sum__softmax_full_mha__swiglu_ffn__prompt_kernel_phaseB_gemm
parallel_sum__softmax_full_mha__swiglu_ffn__prompt_kernel_VK0:
    s_waitcnt vmcnt(21) lgkmcnt(0)
    s_barrier
    ds_read_b64_tr_b16 v[92:93], v154 offset:0
    ds_read_b64_tr_b16 v[94:95], v154 offset:512
    ds_read_b128 v[88:91], v155 offset:0
    ds_read_b64_tr_b16 v[100:101], v154 offset:2048
    ds_read_b64_tr_b16 v[102:103], v154 offset:2560
    ds_read_b128 v[96:99], v157 offset:0
    ds_read_b64_tr_b16 v[108:109], v154 offset:4096
    ds_read_b64_tr_b16 v[110:111], v154 offset:4608
    ds_read_b128 v[104:107], v155 offset:8192
    ds_read_b64_tr_b16 v[116:117], v154 offset:6144
    ds_read_b64_tr_b16 v[118:119], v154 offset:6656
    ds_read_b128 v[112:115], v157 offset:8192
    s_mov_b32 s52, s72
    s_and_b32 s53, s73, 0xffff
    s_mov_b32 s54, 256
    s_mov_b32 s55, 0x20000
    buffer_load_dword v156, v158, s[52:55], 0 offen sc0 sc1
    s_waitcnt lgkmcnt(0)
    v_mfma_f32_32x32x16_bf16 v[56:71], v[92:95], v[88:91], 0
    s_waitcnt vmcnt(20)
    s_barrier
    ds_read_b64_tr_b16 v[124:125], v154 offset:8192
    ds_read_b64_tr_b16 v[126:127], v154 offset:8704
    ds_read_b128 v[120:123], v155 offset:16384
    ds_read_b64_tr_b16 v[132:133], v154 offset:10240
    ds_read_b64_tr_b16 v[134:135], v154 offset:10752
    ds_read_b128 v[128:131], v157 offset:16384
    v_mfma_f32_32x32x16_bf16 v[56:71], v[100:103], v[96:99], v[56:71]
    ds_read_b64_tr_b16 v[140:141], v154 offset:12288
    ds_read_b64_tr_b16 v[142:143], v154 offset:12800
    ds_read_b128 v[136:139], v155 offset:24576
    ds_read_b64_tr_b16 v[148:149], v154 offset:14336
    ds_read_b64_tr_b16 v[150:151], v154 offset:14848
    ds_read_b128 v[144:147], v157 offset:24576
    v_mfma_f32_32x32x16_bf16 v[56:71], v[108:111], v[104:107], v[56:71]
    s_add_u32 m0, s32, 0
    v_mfma_f32_32x32x16_bf16 v[56:71], v[116:119], v[112:115], v[56:71]
    buffer_load_dwordx4 v152, s[16:19], s30 offen lds
    s_add_u32 s30, s30, s51
    s_waitcnt lgkmcnt(0)
    v_mfma_f32_32x32x16_bf16 v[56:71], v[124:127], v[120:123], v[56:71]
    s_waitcnt vmcnt(19)
    s_barrier
    v_add_u32 v155, 32768, v155
    v_add_u32 v157, 32768, v157
    ds_read_b64_tr_b16 v[92:93], v154 offset:16384
    ds_read_b64_tr_b16 v[94:95], v154 offset:16896
    ds_read_b128 v[88:91], v155 offset:0
    ds_read_b64_tr_b16 v[100:101], v154 offset:18432
    ds_read_b64_tr_b16 v[102:103], v154 offset:18944
    ds_read_b128 v[96:99], v157 offset:0
    v_mfma_f32_32x32x16_bf16 v[56:71], v[132:135], v[128:131], v[56:71]
    ds_read_b64_tr_b16 v[108:109], v154 offset:20480
    ds_read_b64_tr_b16 v[110:111], v154 offset:20992
    ds_read_b128 v[104:107], v155 offset:8192
    ds_read_b64_tr_b16 v[116:117], v154 offset:22528
    ds_read_b64_tr_b16 v[118:119], v154 offset:23040
    ds_read_b128 v[112:115], v157 offset:8192
    v_mfma_f32_32x32x16_bf16 v[56:71], v[140:143], v[136:139], v[56:71]
    s_add_u32 m0, s32, 8192
    v_mfma_f32_32x32x16_bf16 v[56:71], v[148:151], v[144:147], v[56:71]
    buffer_load_dwordx4 v152, s[16:19], s30 offen lds
    s_add_u32 s30, s30, s51
    s_waitcnt lgkmcnt(0)
    v_mfma_f32_32x32x16_bf16 v[56:71], v[92:95], v[88:91], v[56:71]
    s_waitcnt vmcnt(18)
    s_barrier
    ds_read_b64_tr_b16 v[124:125], v154 offset:24576
    ds_read_b64_tr_b16 v[126:127], v154 offset:25088
    ds_read_b128 v[120:123], v155 offset:16384
    ds_read_b64_tr_b16 v[132:133], v154 offset:26624
    ds_read_b64_tr_b16 v[134:135], v154 offset:27136
    ds_read_b128 v[128:131], v157 offset:16384
    v_mfma_f32_32x32x16_bf16 v[56:71], v[100:103], v[96:99], v[56:71]
    ds_read_b64_tr_b16 v[140:141], v154 offset:28672
    ds_read_b64_tr_b16 v[142:143], v154 offset:29184
    ds_read_b128 v[136:139], v155 offset:24576
    ds_read_b64_tr_b16 v[148:149], v154 offset:30720
    ds_read_b64_tr_b16 v[150:151], v154 offset:31232
    ds_read_b128 v[144:147], v157 offset:24576
    v_mfma_f32_32x32x16_bf16 v[56:71], v[108:111], v[104:107], v[56:71]
    s_add_u32 m0, s32, 16384
    v_mfma_f32_32x32x16_bf16 v[56:71], v[116:119], v[112:115], v[56:71]
    buffer_load_dwordx4 v152, s[16:19], s30 offen lds
    s_add_u32 s30, s30, s51
    s_waitcnt lgkmcnt(0)
    v_mfma_f32_32x32x16_bf16 v[56:71], v[124:127], v[120:123], v[56:71]
    s_waitcnt vmcnt(2)
    s_barrier
    v_add_u32 v155, 32768, v155
    v_add_u32 v157, 32768, v157
    ds_read_b64_tr_b16 v[92:93], v154 offset:0
    ds_read_b64_tr_b16 v[94:95], v154 offset:512
    ds_read_b128 v[88:91], v155 offset:0
    ds_read_b64_tr_b16 v[100:101], v154 offset:2048
    ds_read_b64_tr_b16 v[102:103], v154 offset:2560
    ds_read_b128 v[96:99], v157 offset:0
    v_mfma_f32_32x32x16_bf16 v[56:71], v[132:135], v[128:131], v[56:71]
    ds_read_b64_tr_b16 v[108:109], v154 offset:4096
    ds_read_b64_tr_b16 v[110:111], v154 offset:4608
    ds_read_b128 v[104:107], v155 offset:8192
    ds_read_b64_tr_b16 v[116:117], v154 offset:6144
    ds_read_b64_tr_b16 v[118:119], v154 offset:6656
    ds_read_b128 v[112:115], v157 offset:8192
    v_mfma_f32_32x32x16_bf16 v[56:71], v[140:143], v[136:139], v[56:71]
    v_mfma_f32_32x32x16_bf16 v[56:71], v[148:151], v[144:147], v[56:71]
    s_waitcnt lgkmcnt(0)
    v_mfma_f32_32x32x16_bf16 v[56:71], v[92:95], v[88:91], v[56:71]
    s_waitcnt vmcnt(1)
    s_barrier
    ds_read_b64_tr_b16 v[124:125], v154 offset:8192
    ds_read_b64_tr_b16 v[126:127], v154 offset:8704
    ds_read_b128 v[120:123], v155 offset:16384
    ds_read_b64_tr_b16 v[132:133], v154 offset:10240
    ds_read_b64_tr_b16 v[134:135], v154 offset:10752
    ds_read_b128 v[128:131], v157 offset:16384
    v_mfma_f32_32x32x16_bf16 v[56:71], v[100:103], v[96:99], v[56:71]
    ds_read_b64_tr_b16 v[140:141], v154 offset:12288
    ds_read_b64_tr_b16 v[142:143], v154 offset:12800
    ds_read_b128 v[136:139], v155 offset:24576
    ds_read_b64_tr_b16 v[148:149], v154 offset:14336
    ds_read_b64_tr_b16 v[150:151], v154 offset:14848
    ds_read_b128 v[144:147], v157 offset:24576
    v_mfma_f32_32x32x16_bf16 v[56:71], v[108:111], v[104:107], v[56:71]
    v_mfma_f32_32x32x16_bf16 v[56:71], v[116:119], v[112:115], v[56:71]
    s_waitcnt lgkmcnt(0)
    v_mfma_f32_32x32x16_bf16 v[56:71], v[124:127], v[120:123], v[56:71]
    s_waitcnt vmcnt(0)
    s_barrier
    v_add_u32 v155, 32768, v155
    v_add_u32 v157, 32768, v157
    ds_read_b64_tr_b16 v[92:93], v154 offset:16384
    ds_read_b64_tr_b16 v[94:95], v154 offset:16896
    ds_read_b128 v[88:91], v155 offset:0
    ds_read_b64_tr_b16 v[100:101], v154 offset:18432
    ds_read_b64_tr_b16 v[102:103], v154 offset:18944
    ds_read_b128 v[96:99], v157 offset:0
    v_mfma_f32_32x32x16_bf16 v[56:71], v[132:135], v[128:131], v[56:71]
    ds_read_b64_tr_b16 v[108:109], v154 offset:20480
    ds_read_b64_tr_b16 v[110:111], v154 offset:20992
    ds_read_b128 v[104:107], v155 offset:8192
    ds_read_b64_tr_b16 v[116:117], v154 offset:22528
    ds_read_b64_tr_b16 v[118:119], v154 offset:23040
    ds_read_b128 v[112:115], v157 offset:8192
    v_mfma_f32_32x32x16_bf16 v[56:71], v[140:143], v[136:139], v[56:71]
    v_mfma_f32_32x32x16_bf16 v[56:71], v[148:151], v[144:147], v[56:71]
    s_waitcnt lgkmcnt(0)
    v_mfma_f32_32x32x16_bf16 v[56:71], v[92:95], v[88:91], v[56:71]
    v_mfma_f32_32x32x16_bf16 v[56:71], v[100:103], v[96:99], v[56:71]
    v_mfma_f32_32x32x16_bf16 v[56:71], v[108:111], v[104:107], v[56:71]
    v_mfma_f32_32x32x16_bf16 v[56:71], v[116:119], v[112:115], v[56:71]
    s_barrier
    v_readfirstlane_b32 s74, v156
    s_nop 3
    s_cmp_lg_u32 s74, 0
    s_cbranch_scc1 parallel_sum__softmax_full_mha__swiglu_ffn__prompt_kernel_havetag_24
    s_mov_b32 s52, s72
    s_and_b32 s53, s73, 0xffff
    s_mov_b32 s54, 256
    s_mov_b32 s55, 0x20000
    s_mov_b32 s36, 524288
    v_mov_b32 v10, 0
parallel_sum__softmax_full_mha__swiglu_ffn__prompt_kernel_tag_25:
    buffer_load_dword v9, v10, s[52:55], 0 offen sc0 sc1
    s_waitcnt vmcnt(0)
    v_readfirstlane_b32 s74, v9
    s_nop 1
    s_sub_u32 s36, s36, 1
    s_cmp_eq_u32 s36, 0
    s_cbranch_scc1 parallel_sum__softmax_full_mha__swiglu_ffn__prompt_kernel_tagx_26
    s_cmp_eq_u32 s74, 0
    s_cbranch_scc1 parallel_sum__softmax_full_mha__swiglu_ffn__prompt_kernel_tag_25
parallel_sum__softmax_full_mha__swiglu_ffn__prompt_kernel_tagx_26:
parallel_sum__softmax_full_mha__swiglu_ffn__prompt_kernel_havetag_24:
    s_add_u32 m0, s33, 0
    s_nop 0
    buffer_load_dwordx4 v153, s[8:11], s31 offen lds
    s_add_u32 s31, s31, 57344
    s_add_u32 m0, s33, 8192
    s_nop 0
    buffer_load_dwordx4 v153, s[8:11], s31 offen lds
    s_add_u32 s31, s31, 57344
    s_add_u32 m0, s33, 16384
    s_nop 0
    buffer_load_dwordx4 v153, s[8:11], s31 offen lds
    s_add_u32 s31, s31, 57344
    s_add_u32 m0, s33, 24576
    s_nop 0
    buffer_load_dwordx4 v153, s[8:11], s31 offen lds
    s_add_u32 s31, s31, 57344
    s_nop 7
    v_cvt_pk_bf16_f32 v56, v56, v57
    v_cvt_pk_bf16_f32 v57, v58, v59
    v_cvt_pk_bf16_f32 v58, v60, v61
    v_cvt_pk_bf16_f32 v59, v62, v63
    v_cvt_pk_bf16_f32 v60, v64, v65
    v_cvt_pk_bf16_f32 v61, v66, v67
    v_cvt_pk_bf16_f32 v62, v68, v69
    v_cvt_pk_bf16_f32 v63, v70, v71
    s_mov_b64 exec, s[46:47]
    v_mov_b32 v62, 0x3f803f80
    v_mov_b32 v63, 0x3f80
    s_mov_b64 exec, -1
    s_lshl_b32 s35, s39, 6
    s_add_u32 s35, s35, s43
    s_add_u32 s35, s35, s48
    s_lshl_b32 s35, s35, 11
    buffer_store_dwordx4 v[56:59], v2, s[20:23], s35 offen sc0 sc1
    buffer_store_dwordx4 v[60:63], v2, s[20:23], s35 offen offset:1024 sc0 sc1
    s_waitcnt vmcnt(5) lgkmcnt(0)
    s_barrier
    ds_read_b64_tr_b16 v[24:25], v5 offset:0
    ds_read_b64_tr_b16 v[26:27], v5 offset:256
    ds_read_b64_tr_b16 v[28:29], v5 offset:1024
    ds_read_b64_tr_b16 v[30:31], v5 offset:1280
    ds_read_b128 v[16:19], v3 offset:0
    ds_read_b128 v[20:23], v3 offset:2048
    s_waitcnt lgkmcnt(0)
    v_mfma_f32_32x32x16_bf16 v[56:71], v[24:27], v[16:19], 0
    v_mfma_f32_32x32x16_bf16 v[72:87], v[24:27], v[20:23], 0
    s_waitcnt vmcnt(4)
    s_barrier
    v_mfma_f32_32x32x16_bf16 v[88:103], v[28:31], v[16:19], 0
    ds_read_b64_tr_b16 v[40:41], v5 offset:8192
    ds_read_b64_tr_b16 v[42:43], v5 offset:8448
    ds_read_b64_tr_b16 v[44:45], v5 offset:9216
    v_mfma_f32_32x32x16_bf16 v[104:119], v[28:31], v[20:23], 0
    ds_read_b64_tr_b16 v[46:47], v5 offset:9472
    ds_read_b128 v[32:35], v4 offset:0
    ds_read_b128 v[36:39], v4 offset:2048
    s_add_u32 m0, s33, 0
    s_nop 0
    buffer_load_dwordx4 v153, s[8:11], s31 offen lds
    s_add_u32 s31, s31, 57344
    s_waitcnt lgkmcnt(0)
    v_mfma_f32_32x32x16_bf16 v[56:71], v[40:43], v[32:35], v[56:71]
    v_mfma_f32_32x32x16_bf16 v[72:87], v[40:43], v[36:39], v[72:87]
    s_waitcnt vmcnt(4)
    s_barrier
    v_mfma_f32_32x32x16_bf16 v[88:103], v[44:47], v[32:35], v[88:103]
    ds_read_b64_tr_b16 v[24:25], v5 offset:16384
    ds_read_b64_tr_b16 v[26:27], v5 offset:16640
    ds_read_b64_tr_b16 v[28:29], v5 offset:17408
    v_mfma_f32_32x32x16_bf16 v[104:119], v[44:47], v[36:39], v[104:119]
    ds_read_b64_tr_b16 v[30:31], v5 offset:17664
    ds_read_b128 v[16:19], v3 offset:8192
    ds_read_b128 v[20:23], v3 offset:10240
    s_add_u32 m0, s33, 8192
    s_nop 0
    buffer_load_dwordx4 v153, s[8:11], s31 offen lds
    s_add_u32 s31, s31, 57344
    s_waitcnt lgkmcnt(0)
    v_mfma_f32_32x32x16_bf16 v[56:71], v[24:27], v[16:19], v[56:71]
    v_mfma_f32_32x32x16_bf16 v[72:87], v[24:27], v[20:23], v[72:87]
    s_waitcnt vmcnt(4)
    s_barrier
    v_mfma_f32_32x32x16_bf16 v[88:103], v[28:31], v[16:19], v[88:103]
    ds_read_b64_tr_b16 v[40:41], v5 offset:24576
    ds_read_b64_tr_b16 v[42:43], v5 offset:24832
    ds_read_b64_tr_b16 v[44:45], v5 offset:25600
    v_mfma_f32_32x32x16_bf16 v[104:119], v[28:31], v[20:23], v[104:119]
    ds_read_b64_tr_b16 v[46:47], v5 offset:25856
    ds_read_b128 v[32:35], v4 offset:8192
    ds_read_b128 v[36:39], v4 offset:10240
    s_add_u32 m0, s33, 16384
    s_nop 0
    buffer_load_dwordx4 v153, s[8:11], s31 offen lds
    s_add_u32 s31, s31, 57344
    s_waitcnt lgkmcnt(0)
    v_mfma_f32_32x32x16_bf16 v[56:71], v[40:43], v[32:35], v[56:71]
    v_mfma_f32_32x32x16_bf16 v[72:87], v[40:43], v[36:39], v[72:87]
    s_waitcnt vmcnt(2)
    s_barrier
    v_mfma_f32_32x32x16_bf16 v[88:103], v[44:47], v[32:35], v[88:103]
    v_add_u32 v3, 16384, v3
    v_add_u32 v4, 16384, v4
    ds_read_b64_tr_b16 v[24:25], v5 offset:0
    ds_read_b64_tr_b16 v[26:27], v5 offset:256
    v_mfma_f32_32x32x16_bf16 v[104:119], v[44:47], v[36:39], v[104:119]
    ds_read_b64_tr_b16 v[28:29], v5 offset:1024
    ds_read_b64_tr_b16 v[30:31], v5 offset:1280
    ds_read_b128 v[16:19], v3 offset:0
    ds_read_b128 v[20:23], v3 offset:2048
    s_add_u32 m0, s33, 24576
    s_nop 0
    buffer_load_dwordx4 v153, s[8:11], s31 offen lds
    s_add_u32 s31, s31, 57344
    v_mov_b32 v9, 155648
    v_mov_b32 v10, 1
    s_mov_b64 exec, 1
    ds_add_rtn_u32 v10, v9, v10
    s_waitcnt lgkmcnt(0)
    s_mov_b64 exec, -1
    v_readfirstlane_b32 s35, v10
    s_nop 3
    s_cmp_lg_u32 s35, 7
    s_cbranch_scc1 parallel_sum__softmax_full_mha__swiglu_ffn__prompt_kernel_arr_27
    s_lshl_b32 s35, s2, 6
    s_add_u32 s35, s35, 25296896
    v_mov_b32 v9, s74
    v_mov_b32 v10, 0
    s_mov_b64 exec, 1
    buffer_store_dword v9, v10, s[20:23], s35 offen sc0 sc1
    s_mov_b64 exec, -1
parallel_sum__softmax_full_mha__swiglu_ffn__prompt_kernel_arr_27:
    s_mov_b32 s34, 5
parallel_sum__softmax_full_mha__swiglu_ffn__prompt_kernel_K0_p2_loop:
    s_waitcnt lgkmcnt(0)
    v_mfma_f32_32x32x16_bf16 v[56:71], v[24:27], v[16:19], v[56:71]
    v_mfma_f32_32x32x16_bf16 v[72:87], v[24:27], v[20:23], v[72:87]
    s_waitcnt vmcnt(2)
    s_barrier
    v_mfma_f32_32x32x16_bf16 v[88:103], v[28:31], v[16:19], v[88:103]
    ds_read_b64_tr_b16 v[40:41], v5 offset:8192
    ds_read_b64_tr_b16 v[42:43], v5 offset:8448
    ds_read_b64_tr_b16 v[44:45], v5 offset:9216
    v_mfma_f32_32x32x16_bf16 v[104:119], v[28:31], v[20:23], v[104:119]
    ds_read_b64_tr_b16 v[46:47], v5 offset:9472
    ds_read_b128 v[32:35], v4 offset:0
    ds_read_b128 v[36:39], v4 offset:2048
    s_add_u32 m0, s33, 0
    s_nop 0
    buffer_load_dwordx4 v153, s[8:11], s31 offen lds
    s_add_u32 s31, s31, 57344
    s_waitcnt lgkmcnt(0)
    v_mfma_f32_32x32x16_bf16 v[56:71], v[40:43], v[32:35], v[56:71]
    v_mfma_f32_32x32x16_bf16 v[72:87], v[40:43], v[36:39], v[72:87]
    s_waitcnt vmcnt(2)
    s_barrier
    v_mfma_f32_32x32x16_bf16 v[88:103], v[44:47], v[32:35], v[88:103]
    ds_read_b64_tr_b16 v[24:25], v5 offset:16384
    ds_read_b64_tr_b16 v[26:27], v5 offset:16640
    ds_read_b64_tr_b16 v[28:29], v5 offset:17408
    v_mfma_f32_32x32x16_bf16 v[104:119], v[44:47], v[36:39], v[104:119]
    ds_read_b64_tr_b16 v[30:31], v5 offset:17664
    ds_read_b128 v[16:19], v3 offset:8192
    ds_read_b128 v[20:23], v3 offset:10240
    s_add_u32 m0, s33, 8192
    s_nop 0
    buffer_load_dwordx4 v153, s[8:11], s31 offen lds
    s_add_u32 s31, s31, 57344
    s_waitcnt lgkmcnt(0)
    v_mfma_f32_32x32x16_bf16 v[56:71], v[24:27], v[16:19], v[56:71]
    v_mfma_f32_32x32x16_bf16 v[72:87], v[24:27], v[20:23], v[72:87]
    s_waitcnt vmcnt(2)
    s_barrier
    v_mfma_f32_32x32x16_bf16 v[88:103], v[28:31], v[16:19], v[88:103]
    ds_read_b64_tr_b16 v[40:41], v5 offset:24576
    ds_read_b64_tr_b16 v[42:43], v5 offset:24832
    ds_read_b64_tr_b16 v[44:45], v5 offset:25600
    v_mfma_f32_32x32x16_bf16 v[104:119], v[28:31], v[20:23], v[104:119]
    ds_read_b64_tr_b16 v[46:47], v5 offset:25856
    ds_read_b128 v[32:35], v4 offset:8192
    ds_read_b128 v[36:39], v4 offset:10240
    s_add_u32 m0, s33, 16384
    s_nop 0
    buffer_load_dwordx4 v153, s[8:11], s31 offen lds
    s_add_u32 s31, s31, 57344
    s_waitcnt lgkmcnt(0)
    v_mfma_f32_32x32x16_bf16 v[56:71], v[40:43], v[32:35], v[56:71]
    v_mfma_f32_32x32x16_bf16 v[72:87], v[40:43], v[36:39], v[72:87]
    s_waitcnt vmcnt(2)
    s_barrier
    v_mfma_f32_32x32x16_bf16 v[88:103], v[44:47], v[32:35], v[88:103]
    v_add_u32 v3, 16384, v3
    v_add_u32 v4, 16384, v4
    ds_read_b64_tr_b16 v[24:25], v5 offset:0
    ds_read_b64_tr_b16 v[26:27], v5 offset:256
    v_mfma_f32_32x32x16_bf16 v[104:119], v[44:47], v[36:39], v[104:119]
    ds_read_b64_tr_b16 v[28:29], v5 offset:1024
    ds_read_b64_tr_b16 v[30:31], v5 offset:1280
    ds_read_b128 v[16:19], v3 offset:0
    ds_read_b128 v[20:23], v3 offset:2048
    s_add_u32 m0, s33, 24576
    s_nop 0
    buffer_load_dwordx4 v153, s[8:11], s31 offen lds
    s_add_u32 s31, s31, 57344
    s_sub_u32 s34, s34, 1
    s_cmp_lg_u32 s34, 0
    s_cbranch_scc1 parallel_sum__softmax_full_mha__swiglu_ffn__prompt_kernel_K0_p2_loop
    s_waitcnt lgkmcnt(0)
    v_mfma_f32_32x32x16_bf16 v[56:71], v[24:27], v[16:19], v[56:71]
    v_mfma_f32_32x32x16_bf16 v[72:87], v[24:27], v[20:23], v[72:87]
    s_waitcnt vmcnt(2)
    s_barrier
    v_mfma_f32_32x32x16_bf16 v[88:103], v[28:31], v[16:19], v[88:103]
    ds_read_b64_tr_b16 v[40:41], v5 offset:8192
    ds_read_b64_tr_b16 v[42:43], v5 offset:8448
    ds_read_b64_tr_b16 v[44:45], v5 offset:9216
    v_mfma_f32_32x32x16_bf16 v[104:119], v[28:31], v[20:23], v[104:119]
    ds_read_b64_tr_b16 v[46:47], v5 offset:9472
    ds_read_b128 v[32:35], v4 offset:0
    ds_read_b128 v[36:39], v4 offset:2048
    s_waitcnt lgkmcnt(0)
    v_mfma_f32_32x32x16_bf16 v[56:71], v[40:43], v[32:35], v[56:71]
    v_mfma_f32_32x32x16_bf16 v[72:87], v[40:43], v[36:39], v[72:87]
    s_waitcnt vmcnt(1)
    s_barrier
    v_mfma_f32_32x32x16_bf16 v[88:103], v[44:47], v[32:35], v[88:103]
    ds_read_b64_tr_b16 v[24:25], v5 offset:16384
    ds_read_b64_tr_b16 v[26:27], v5 offset:16640
    ds_read_b64_tr_b16 v[28:29], v5 offset:17408
    v_mfma_f32_32x32x16_bf16 v[104:119], v[44:47], v[36:39], v[104:119]
    ds_read_b64_tr_b16 v[30:31], v5 offset:17664
    ds_read_b128 v[16:19], v3 offset:8192
    ds_read_b128 v[20:23], v3 offset:10240
    s_waitcnt lgkmcnt(0)
    v_mfma_f32_32x32x16_bf16 v[56:71], v[24:27], v[16:19], v[56:71]
    v_mfma_f32_32x32x16_bf16 v[72:87], v[24:27], v[20:23], v[72:87]
    s_waitcnt vmcnt(0)
    s_barrier
    v_mfma_f32_32x32x16_bf16 v[88:103], v[28:31], v[16:19], v[88:103]
    ds_read_b64_tr_b16 v[40:41], v5 offset:24576
    ds_read_b64_tr_b16 v[42:43], v5 offset:24832
    ds_read_b64_tr_b16 v[44:45], v5 offset:25600
    v_mfma_f32_32x32x16_bf16 v[104:119], v[28:31], v[20:23], v[104:119]
    ds_read_b64_tr_b16 v[46:47], v5 offset:25856
    ds_read_b128 v[32:35], v4 offset:8192
    ds_read_b128 v[36:39], v4 offset:10240
    s_waitcnt lgkmcnt(0)
    v_mfma_f32_32x32x16_bf16 v[56:71], v[40:43], v[32:35], v[56:71]
    v_mfma_f32_32x32x16_bf16 v[72:87], v[40:43], v[36:39], v[72:87]
    v_mfma_f32_32x32x16_bf16 v[88:103], v[44:47], v[32:35], v[88:103]
    v_mfma_f32_32x32x16_bf16 v[104:119], v[44:47], v[36:39], v[104:119]
    s_barrier
    s_nop 10
    s_and_b32 s24, s2, 7
    s_lshr_b32 s25, s2, 3
    s_and_b32 s16, s25, 1
    s_lshl_b32 s24, s24, 1
    s_add_u32 s16, s16, s24
    s_lshr_b32 s17, s25, 1
    s_mov_b32 s30, 0
    s_mov_b32 s31, -1
    s_lshl_b32 s24, s16, 6
    s_lshl_b32 s25, s17, 2
    s_add_u32 s50, s24, s25
    s_lshl_b32 s50, s50, 11
    s_lshl_b32 s26, s24, 11
    s_add_u32 s26, s26, 2097152
    s_lshl_b32 s25, s3, 15
    s_add_u32 s27, s26, s25
    s_add_u32 s18, s27, 2097152
    s_mov_b32 s4, s70
    s_and_b32 s5, s71, 0xffff
    s_mov_b32 s6, 33554432
    s_mov_b32 s7, 0x20000
    s_mov_b32 s8, s70
    s_and_b32 s9, s71, 0xffff
    s_mov_b32 s10, 0
    s_mov_b32 s11, 0x20000
    s_mov_b32 s12, s70
    s_and_b32 s13, s71, 0xffff
    s_mov_b32 s14, 0
    s_mov_b32 s15, 0x20000
    s_add_u32 s10, s27, 32768
    s_add_u32 s14, s18, 32768
    s_mov_b32 s29, 0
    v_and_b32 v5, 15, v1
    s_and_b32 s24, s16, 0xfffe
    v_bfe_u32 v6, v1, 4, 1
    v_add_u32 v6, s24, v6
    v_lshrrev_b32 v7, 3, v5
    v_lshrrev_b32 v9, 2, v6
    v_lshl_add_u32 v7, v9, 1, v7
    v_and_b32 v9, 7, v5
    v_lshl_add_u32 v7, v9, 3, v7
    v_and_b32 v9, 1, v6
    v_lshl_add_u32 v7, v9, 7, v7
    v_bfe_u32 v9, v6, 1, 1
    v_lshl_add_u32 v7, v9, 6, v7
    v_lshlrev_b32 v7, 6, v7
    v_add_u32 v7, 25296896, v7
    buffer_load_dword v220, v7, s[4:7], 0 offen sc0 sc1
    v_mov_b32 v221, v7
    s_mov_b32 s36, 0xbfb8aa3b
    v_mul_f32 v16, s36, v56
    v_mul_f32 v17, s36, v57
    v_mul_f32 v18, s36, v58
    v_mul_f32 v19, s36, v59
    v_exp_f32 v16, v16
    v_exp_f32 v17, v17
    v_exp_f32 v18, v18
    v_exp_f32 v19, v19
    v_mul_f32 v56, v56, v88
    v_mul_f32 v57, v57, v89
    v_mul_f32 v58, v58, v90
    v_mul_f32 v59, v59, v91
    v_add_f32 v16, 1.0, v16
    v_add_f32 v17, 1.0, v17
    v_add_f32 v18, 1.0, v18
    v_add_f32 v19, 1.0, v19
    v_rcp_f32 v16, v16
    v_rcp_f32 v17, v17
    v_rcp_f32 v18, v18
    v_rcp_f32 v19, v19
    s_nop 0
    v_mul_f32 v56, v56, v16
    v_mul_f32 v57, v57, v17
    v_mul_f32 v58, v58, v18
    v_mul_f32 v59, v59, v19
    v_mul_f32 v16, s36, v60
    v_mul_f32 v17, s36, v61
    v_mul_f32 v18, s36, v62
    v_mul_f32 v19, s36, v63
    v_exp_f32 v16, v16
    v_exp_f32 v17, v17
    v_exp_f32 v18, v18
    v_exp_f32 v19, v19
    v_mul_f32 v60, v60, v92
    v_mul_f32 v61, v61, v93
    v_mul_f32 v62, v62, v94
    v_mul_f32 v63, v63, v95
    v_add_f32 v16, 1.0, v16
    v_add_f32 v17, 1.0, v17
    v_add_f32 v18, 1.0, v18
    v_add_f32 v19, 1.0, v19
    v_rcp_f32 v16, v16
    v_rcp_f32 v17, v17
    v_rcp_f32 v18, v18
    v_rcp_f32 v19, v19
    s_nop 0
    v_mul_f32 v60, v60, v16
    v_mul_f32 v61, v61, v17
    v_mul_f32 v62, v62, v18
    v_mul_f32 v63, v63, v19
    v_mul_f32 v16, s36, v64
    v_mul_f32 v17, s36, v65
    v_mul_f32 v18, s36, v66
    v_mul_f32 v19, s36, v67
    v_exp_f32 v16, v16
    v_exp_f32 v17, v17
    v_exp_f32 v18, v18
    v_exp_f32 v19, v19
    v_mul_f32 v64, v64, v96
    v_mul_f32 v65, v65, v97
    v_mul_f32 v66, v66, v98
    v_mul_f32 v67, v67, v99
    v_add_f32 v16, 1.0, v16
    v_add_f32 v17, 1.0, v17
    v_add_f32 v18, 1.0, v18
    v_add_f32 v19, 1.0, v19
    v_rcp_f32 v16, v16
    v_rcp_f32 v17, v17
    v_rcp_f32 v18, v18
    v_rcp_f32 v19, v19
    s_nop 0
    v_mul_f32 v64, v64, v16
    v_mul_f32 v65, v65, v17
    v_mul_f32 v66, v66, v18
    v_mul_f32 v67, v67, v19
    v_mul_f32 v16, s36, v68
    v_mul_f32 v17, s36, v69
    v_mul_f32 v18, s36, v70
    v_mul_f32 v19, s36, v71
    v_exp_f32 v16, v16
    v_exp_f32 v17, v17
    v_exp_f32 v18, v18
    v_exp_f32 v19, v19
    v_mul_f32 v68, v68, v100
    v_mul_f32 v69, v69, v101
    v_mul_f32 v70, v70, v102
    v_mul_f32 v71, v71, v103
    v_add_f32 v16, 1.0, v16
    v_add_f32 v17, 1.0, v17
    v_add_f32 v18, 1.0, v18
    v_add_f32 v19, 1.0, v19
    v_rcp_f32 v16, v16
    v_rcp_f32 v17, v17
    v_rcp_f32 v18, v18
    v_rcp_f32 v19, v19
    s_nop 0
    v_mul_f32 v68, v68, v16
    v_mul_f32 v69, v69, v17
    v_mul_f32 v70, v70, v18
    v_mul_f32 v71, v71, v19
    v_cvt_pk_bf16_f32 v88, v56, v57
    v_cvt_pk_bf16_f32 v89, v58, v59
    v_cvt_pk_bf16_f32 v90, v60, v61
    v_cvt_pk_bf16_f32 v91, v62, v63
    v_cvt_pk_bf16_f32 v92, v64, v65
    v_cvt_pk_bf16_f32 v93, v66, v67
    v_cvt_pk_bf16_f32 v94, v68, v69
    v_cvt_pk_bf16_f32 v95, v70, v71
    s_waitcnt vmcnt(0)
    v_cmp_ne_u32 vcc, s74, v220
    s_nop 3
    s_cmp_eq_u64 vcc, 0
    s_cbranch_scc1 parallel_sum__softmax_full_mha__swiglu_ffn__prompt_kernel_qok_28
    s_add_u32 s37, s74, 0
    s_mov_b32 s36, 524288
    s_mov_b32 s68, 0xffffffff
    s_mov_b32 s69, 0xffffffff
parallel_sum__softmax_full_mha__swiglu_ffn__prompt_kernel_poll_29:
    buffer_load_dword v220, v221, s[4:7], 0 offen sc0 sc1
    s_waitcnt vmcnt(0)
    v_cmp_ne_u32 vcc, s37, v220
    s_nop 3
    s_and_b64 vcc, vcc, s[68:69]
    s_sub_u32 s36, s36, 1
    s_cmp_eq_u32 s36, 0
    s_cbranch_scc1 parallel_sum__softmax_full_mha__swiglu_ffn__prompt_kernel_pollx_30
    s_cmp_lg_u64 vcc, 0
    s_cbranch_scc0 parallel_sum__softmax_full_mha__swiglu_ffn__prompt_kernel_pollx_30
    s_sleep 1
    s_branch parallel_sum__softmax_full_mha__swiglu_ffn__prompt_kernel_poll_29
parallel_sum__softmax_full_mha__swiglu_ffn__prompt_kernel_pollx_30:
parallel_sum__softmax_full_mha__swiglu_ffn__prompt_kernel_qok_28:
    buffer_load_dwordx4 v[120:123], v2, s[4:7], s50 offen offset:0 sc1
    buffer_load_dwordx4 v[124:127], v2, s[4:7], s50 offen offset:1024 sc1
    buffer_load_dwordx4 v[128:131], v2, s[4:7], s50 offen offset:2048 sc1
    buffer_load_dwordx4 v[132:135], v2, s[4:7], s50 offen offset:3072 sc1
    s_add_u32 s24, s50, 4096
    buffer_load_dwordx4 v[136:139], v2, s[4:7], s24 offen offset:0 sc1
    buffer_load_dwordx4 v[140:143], v2, s[4:7], s24 offen offset:1024 sc1
    buffer_load_dwordx4 v[144:147], v2, s[4:7], s24 offen offset:2048 sc1
    buffer_load_dwordx4 v[148:151], v2, s[4:7], s24 offen offset:3072 sc1
    buffer_load_dwordx4 v[200:203], v2, s[4:7], s26 offen sc1
    buffer_load_dwordx4 v[204:207], v2, s[4:7], s26 offen offset:1024 sc1
    s_mov_b32 s36, 0xbfb8aa3b
    v_mul_f32 v16, s36, v72
    v_mul_f32 v17, s36, v73
    v_mul_f32 v18, s36, v74
    v_mul_f32 v19, s36, v75
    v_exp_f32 v16, v16
    v_exp_f32 v17, v17
    v_exp_f32 v18, v18
    v_exp_f32 v19, v19
    v_mul_f32 v72, v72, v104
    v_mul_f32 v73, v73, v105
    v_mul_f32 v74, v74, v106
    v_mul_f32 v75, v75, v107
    v_add_f32 v16, 1.0, v16
    v_add_f32 v17, 1.0, v17
    v_add_f32 v18, 1.0, v18
    v_add_f32 v19, 1.0, v19
    v_rcp_f32 v16, v16
    v_rcp_f32 v17, v17
    v_rcp_f32 v18, v18
    v_rcp_f32 v19, v19
    s_nop 0
    v_mul_f32 v72, v72, v16
    v_mul_f32 v73, v73, v17
    v_mul_f32 v74, v74, v18
    v_mul_f32 v75, v75, v19
    v_mul_f32 v16, s36, v76
    v_mul_f32 v17, s36, v77
    v_mul_f32 v18, s36, v78
    v_mul_f32 v19, s36, v79
    v_exp_f32 v16, v16
    v_exp_f32 v17, v17
    v_exp_f32 v18, v18
    v_exp_f32 v19, v19
    v_mul_f32 v76, v76, v108
    v_mul_f32 v77, v77, v109
    v_mul_f32 v78, v78, v110
    v_mul_f32 v79, v79, v111
    v_add_f32 v16, 1.0, v16
    v_add_f32 v17, 1.0, v17
    v_add_f32 v18, 1.0, v18
    v_add_f32 v19, 1.0, v19
    v_rcp_f32 v16, v16
    v_rcp_f32 v17, v17
    v_rcp_f32 v18, v18
    v_rcp_f32 v19, v19
    s_nop 0
    v_mul_f32 v76, v76, v16
    v_mul_f32 v77, v77, v17
    v_mul_f32 v78, v78, v18
    v_mul_f32 v79, v79, v19
    v_mul_f32 v16, s36, v80
    v_mul_f32 v17, s36, v81
    v_mul_f32 v18, s36, v82
    v_mul_f32 v19, s36, v83
    v_exp_f32 v16, v16
    v_exp_f32 v17, v17
    v_exp_f32 v18, v18
    v_exp_f32 v19, v19
    v_mul_f32 v80, v80, v112
    v_mul_f32 v81, v81, v113
    v_mul_f32 v82, v82, v114
    v_mul_f32 v83, v83, v115
    v_add_f32 v16, 1.0, v16
    v_add_f32 v17, 1.0, v17
    v_add_f32 v18, 1.0, v18
    v_add_f32 v19, 1.0, v19
    v_rcp_f32 v16, v16
    v_rcp_f32 v17, v17
    v_rcp_f32 v18, v18
    v_rcp_f32 v19, v19
    s_nop 0
    v_mul_f32 v80, v80, v16
    v_mul_f32 v81, v81, v17
    v_mul_f32 v82, v82, v18
    v_mul_f32 v83, v83, v19
    v_mul_f32 v16, s36, v84
    v_mul_f32 v17, s36, v85
    v_mul_f32 v18, s36, v86
    v_mul_f32 v19, s36, v87
    v_exp_f32 v16, v16
    v_exp_f32 v17, v17
    v_exp_f32 v18, v18
    v_exp_f32 v19, v19
    v_mul_f32 v84, v84, v116
    v_mul_f32 v85, v85, v117
    v_mul_f32 v86, v86, v118
    v_mul_f32 v87, v87, v119
    v_add_f32 v16, 1.0, v16
    v_add_f32 v17, 1.0, v17
    v_add_f32 v18, 1.0, v18
    v_add_f32 v19, 1.0, v19
    v_rcp_f32 v16, v16
    v_rcp_f32 v17, v17
    v_rcp_f32 v18, v18
    v_rcp_f32 v19, v19
    s_nop 0
    v_mul_f32 v84, v84, v16
    v_mul_f32 v85, v85, v17
    v_mul_f32 v86, v86, v18
    v_mul_f32 v87, v87, v19
    v_cvt_pk_bf16_f32 v104, v72, v73
    v_cvt_pk_bf16_f32 v105, v74, v75
    v_cvt_pk_bf16_f32 v106, v76, v77
    v_cvt_pk_bf16_f32 v107, v78, v79
    v_cvt_pk_bf16_f32 v108, v80, v81
    v_cvt_pk_bf16_f32 v109, v82, v83
    v_cvt_pk_bf16_f32 v110, v84, v85
    v_cvt_pk_bf16_f32 v111, v86, v87
    s_mul_i32 s35, s43, 144
    s_add_u32 s35, s35, s45
    s_lshl_b32 s35, s35, 10
    s_add_u32 s35, s35, 6291456
    buffer_store_dwordx4 v[88:91], v2, s[20:23], s35 offen sc0 sc1
    buffer_store_dwordx4 v[92:95], v2, s[20:23], s35 offen offset:1024 sc0 sc1
    s_mul_i32 s35, s44, 144
    s_add_u32 s35, s35, s45
    s_lshl_b32 s35, s35, 10
    s_add_u32 s35, s35, 6291456
    buffer_store_dwordx4 v[104:107], v2, s[20:23], s35 offen sc0 sc1
    buffer_store_dwordx4 v[108:111], v2, s[20:23], s35 offen offset:1024 sc0 sc1
    s_mov_b32 s48, s27
    s_mov_b32 s49, s18
    buffer_load_dwordx4 v[152:155], v2, s[8:11], s48 offen sc1
    buffer_load_dwordx4 v[156:159], v2, s[8:11], s48 offen offset:1024 sc1
    buffer_load_dwordx4 v[160:163], v2, s[12:15], s49 offen sc1
    buffer_load_dwordx4 v[164:167], v2, s[12:15], s49 offen offset:1024 sc1
    s_add_u32 s48, s48, 2048
    s_add_u32 s49, s49, 2048
    buffer_load_dwordx4 v[168:171], v2, s[8:11], s48 offen sc1
    buffer_load_dwordx4 v[172:175], v2, s[8:11], s48 offen offset:1024 sc1
    buffer_load_dwordx4 v[176:179], v2, s[12:15], s49 offen sc1
    buffer_load_dwordx4 v[180:183], v2, s[12:15], s49 offen offset:1024 sc1
    s_add_u32 s48, s48, 2048
    s_add_u32 s49, s49, 2048
    buffer_load_dwordx4 v[184:187], v2, s[8:11], s48 offen sc1
    buffer_load_dwordx4 v[188:191], v2, s[8:11], s48 offen offset:1024 sc1
    buffer_load_dwordx4 v[192:195], v2, s[12:15], s49 offen sc1
    buffer_load_dwordx4 v[196:199], v2, s[12:15], s49 offen offset:1024 sc1
    s_add_u32 s48, s48, 2048
    s_add_u32 s49, s49, 2048
    s_branch parallel_sum__softmax_full_mha__swiglu_ffn__prompt_kernel_phaseB_attn
parallel_sum__softmax_full_mha__swiglu_ffn__prompt_kernel_VK1:
    s_waitcnt vmcnt(0) lgkmcnt(0)
    s_barrier
    ds_read_b64_tr_b16 v[92:93], v154 offset:0
    ds_read_b64_tr_b16 v[94:95], v154 offset:512
    ds_read_b128 v[88:91], v155 offset:0
    ds_read_b64_tr_b16 v[100:101], v154 offset:2048
    ds_read_b64_tr_b16 v[102:103], v154 offset:2560
    ds_read_b128 v[96:99], v157 offset:0
    ds_read_b64_tr_b16 v[108:109], v154 offset:4096
    ds_read_b64_tr_b16 v[110:111], v154 offset:4608
    ds_read_b128 v[104:107], v155 offset:8192
    ds_read_b64_tr_b16 v[116:117], v154 offset:6144
    ds_read_b64_tr_b16 v[118:119], v154 offset:6656
    ds_read_b128 v[112:115], v157 offset:8192
    s_mov_b32 s52, s72
    s_and_b32 s53, s73, 0xffff
    s_mov_b32 s54, 256
    s_mov_b32 s55, 0x20000
    buffer_load_dword v156, v158, s[52:55], 0 offen sc0 sc1
    s_waitcnt lgkmcnt(0)
    v_mfma_f32_32x32x16_bf16 v[56:71], v[92:95], v[88:91], 0
    s_waitcnt vmcnt(1)
    s_barrier
    ds_read_b64_tr_b16 v[124:125], v154 offset:8192
    ds_read_b64_tr_b16 v[126:127], v154 offset:8704
    ds_read_b128 v[120:123], v155 offset:16384
    ds_read_b64_tr_b16 v[132:133], v154 offset:10240
    ds_read_b64_tr_b16 v[134:135], v154 offset:10752
    ds_read_b128 v[128:131], v157 offset:16384
    v_mfma_f32_32x32x16_bf16 v[56:71], v[100:103], v[96:99], v[56:71]
    ds_read_b64_tr_b16 v[140:141], v154 offset:12288
    ds_read_b64_tr_b16 v[142:143], v154 offset:12800
    ds_read_b128 v[136:139], v155 offset:24576
    ds_read_b64_tr_b16 v[148:149], v154 offset:14336
    ds_read_b64_tr_b16 v[150:151], v154 offset:14848
    ds_read_b128 v[144:147], v157 offset:24576
    v_mfma_f32_32x32x16_bf16 v[56:71], v[108:111], v[104:107], v[56:71]
    s_add_u32 m0, s32, 0
    v_mfma_f32_32x32x16_bf16 v[56:71], v[116:119], v[112:115], v[56:71]
    buffer_load_dwordx4 v152, s[16:19], s30 offen lds
    s_add_u32 s30, s30, s51
    s_waitcnt lgkmcnt(0)
    v_mfma_f32_32x32x16_bf16 v[56:71], v[124:127], v[120:123], v[56:71]
    s_waitcnt vmcnt(2)
    s_barrier
    v_add_u32 v155, 32768, v155
    v_add_u32 v157, 32768, v157
    ds_read_b64_tr_b16 v[92:93], v154 offset:16384
    ds_read_b64_tr_b16 v[94:95], v154 offset:16896
    ds_read_b128 v[88:91], v155 offset:0
    ds_read_b64_tr_b16 v[100:101], v154 offset:18432
    ds_read_b64_tr_b16 v[102:103], v154 offset:18944
    ds_read_b128 v[96:99], v157 offset:0
    v_mfma_f32_32x32x16_bf16 v[56:71], v[132:135], v[128:131], v[56:71]
    ds_read_b64_tr_b16 v[108:109], v154 offset:20480
    ds_read_b64_tr_b16 v[110:111], v154 offset:20992
    ds_read_b128 v[104:107], v155 offset:8192
    ds_read_b64_tr_b16 v[116:117], v154 offset:22528
    ds_read_b64_tr_b16 v[118:119], v154 offset:23040
    ds_read_b128 v[112:115], v157 offset:8192
    v_mfma_f32_32x32x16_bf16 v[56:71], v[140:143], v[136:139], v[56:71]
    s_add_u32 m0, s32, 8192
    v_mfma_f32_32x32x16_bf16 v[56:71], v[148:151], v[144:147], v[56:71]
    buffer_load_dwordx4 v152, s[16:19], s30 offen lds
    s_add_u32 s30, s30, s51
    s_waitcnt lgkmcnt(0)
    v_mfma_f32_32x32x16_bf16 v[56:71], v[92:95], v[88:91], v[56:71]
    s_waitcnt vmcnt(3)
    s_barrier
    ds_read_b64_tr_b16 v[124:125], v154 offset:24576
    ds_read_b64_tr_b16 v[126:127], v154 offset:25088
    ds_read_b128 v[120:123], v155 offset:16384
    ds_read_b64_tr_b16 v[132:133], v154 offset:26624
    ds_read_b64_tr_b16 v[134:135], v154 offset:27136
    ds_read_b128 v[128:131], v157 offset:16384
    v_mfma_f32_32x32x16_bf16 v[56:71], v[100:103], v[96:99], v[56:71]
    ds_read_b64_tr_b16 v[140:141], v154 offset:28672
    ds_read_b64_tr_b16 v[142:143], v154 offset:29184
    ds_read_b128 v[136:139], v155 offset:24576
    ds_read_b64_tr_b16 v[148:149], v154 offset:30720
    ds_read_b64_tr_b16 v[150:151], v154 offset:31232
    ds_read_b128 v[144:147], v157 offset:24576
    v_mfma_f32_32x32x16_bf16 v[56:71], v[108:111], v[104:107], v[56:71]
    s_add_u32 m0, s32, 16384
    v_mfma_f32_32x32x16_bf16 v[56:71], v[116:119], v[112:115], v[56:71]
    buffer_load_dwordx4 v152, s[16:19], s30 offen lds
    s_add_u32 s30, s30, s51
    s_waitcnt lgkmcnt(0)
    v_mfma_f32_32x32x16_bf16 v[56:71], v[124:127], v[120:123], v[56:71]
    s_waitcnt vmcnt(2)
    s_barrier
    v_add_u32 v155, 32768, v155
    v_add_u32 v157, 32768, v157
    ds_read_b64_tr_b16 v[92:93], v154 offset:0
    ds_read_b64_tr_b16 v[94:95], v154 offset:512
    ds_read_b128 v[88:91], v155 offset:0
    ds_read_b64_tr_b16 v[100:101], v154 offset:2048
    ds_read_b64_tr_b16 v[102:103], v154 offset:2560
    ds_read_b128 v[96:99], v157 offset:0
    v_mfma_f32_32x32x16_bf16 v[56:71], v[132:135], v[128:131], v[56:71]
    ds_read_b64_tr_b16 v[108:109], v154 offset:4096
    ds_read_b64_tr_b16 v[110:111], v154 offset:4608
    ds_read_b128 v[104:107], v155 offset:8192
    ds_read_b64_tr_b16 v[116:117], v154 offset:6144
    ds_read_b64_tr_b16 v[118:119], v154 offset:6656
    ds_read_b128 v[112:115], v157 offset:8192
    v_mfma_f32_32x32x16_bf16 v[56:71], v[140:143], v[136:139], v[56:71]
    v_mfma_f32_32x32x16_bf16 v[56:71], v[148:151], v[144:147], v[56:71]
    s_waitcnt lgkmcnt(0)
    v_mfma_f32_32x32x16_bf16 v[56:71], v[92:95], v[88:91], v[56:71]
    s_waitcnt vmcnt(1)
    s_barrier
    ds_read_b64_tr_b16 v[124:125], v154 offset:8192
    ds_read_b64_tr_b16 v[126:127], v154 offset:8704
    ds_read_b128 v[120:123], v155 offset:16384
    ds_read_b64_tr_b16 v[132:133], v154 offset:10240
    ds_read_b64_tr_b16 v[134:135], v154 offset:10752
    ds_read_b128 v[128:131], v157 offset:16384
    v_mfma_f32_32x32x16_bf16 v[56:71], v[100:103], v[96:99], v[56:71]
    ds_read_b64_tr_b16 v[140:141], v154 offset:12288
    ds_read_b64_tr_b16 v[142:143], v154 offset:12800
    ds_read_b128 v[136:139], v155 offset:24576
    ds_read_b64_tr_b16 v[148:149], v154 offset:14336
    ds_read_b64_tr_b16 v[150:151], v154 offset:14848
    ds_read_b128 v[144:147], v157 offset:24576
    v_mfma_f32_32x32x16_bf16 v[56:71], v[108:111], v[104:107], v[56:71]
    v_mfma_f32_32x32x16_bf16 v[56:71], v[116:119], v[112:115], v[56:71]
    s_waitcnt lgkmcnt(0)
    v_mfma_f32_32x32x16_bf16 v[56:71], v[124:127], v[120:123], v[56:71]
    s_waitcnt vmcnt(0)
    s_barrier
    v_add_u32 v155, 32768, v155
    v_add_u32 v157, 32768, v157
    ds_read_b64_tr_b16 v[92:93], v154 offset:16384
    ds_read_b64_tr_b16 v[94:95], v154 offset:16896
    ds_read_b128 v[88:91], v155 offset:0
    ds_read_b64_tr_b16 v[100:101], v154 offset:18432
    ds_read_b64_tr_b16 v[102:103], v154 offset:18944
    ds_read_b128 v[96:99], v157 offset:0
    v_mfma_f32_32x32x16_bf16 v[56:71], v[132:135], v[128:131], v[56:71]
    ds_read_b64_tr_b16 v[108:109], v154 offset:20480
    ds_read_b64_tr_b16 v[110:111], v154 offset:20992
    ds_read_b128 v[104:107], v155 offset:8192
    ds_read_b64_tr_b16 v[116:117], v154 offset:22528
    ds_read_b64_tr_b16 v[118:119], v154 offset:23040
    ds_read_b128 v[112:115], v157 offset:8192
    v_mfma_f32_32x32x16_bf16 v[56:71], v[140:143], v[136:139], v[56:71]
    v_mfma_f32_32x32x16_bf16 v[56:71], v[148:151], v[144:147], v[56:71]
    s_waitcnt lgkmcnt(0)
    v_mfma_f32_32x32x16_bf16 v[56:71], v[92:95], v[88:91], v[56:71]
    v_mfma_f32_32x32x16_bf16 v[56:71], v[100:103], v[96:99], v[56:71]
    v_mfma_f32_32x32x16_bf16 v[56:71], v[108:111], v[104:107], v[56:71]
    v_mfma_f32_32x32x16_bf16 v[56:71], v[116:119], v[112:115], v[56:71]
    s_barrier
    v_readfirstlane_b32 s74, v156
    s_nop 3
    s_cmp_lg_u32 s74, 0
    s_cbranch_scc1 parallel_sum__softmax_full_mha__swiglu_ffn__prompt_kernel_havetag_31
    s_mov_b32 s52, s72
    s_and_b32 s53, s73, 0xffff
    s_mov_b32 s54, 256
    s_mov_b32 s55, 0x20000
    s_mov_b32 s36, 524288
    v_mov_b32 v10, 0
parallel_sum__softmax_full_mha__swiglu_ffn__prompt_kernel_tag_32:
    buffer_load_dword v9, v10, s[52:55], 0 offen sc0 sc1
    s_waitcnt vmcnt(0)
    v_readfirstlane_b32 s74, v9
    s_nop 1
    s_sub_u32 s36, s36, 1
    s_cmp_eq_u32 s36, 0
    s_cbranch_scc1 parallel_sum__softmax_full_mha__swiglu_ffn__prompt_kernel_tagx_33
    s_cmp_eq_u32 s74, 0
    s_cbranch_scc1 parallel_sum__softmax_full_mha__swiglu_ffn__prompt_kernel_tag_32
parallel_sum__softmax_full_mha__swiglu_ffn__prompt_kernel_tagx_33:
parallel_sum__softmax_full_mha__swiglu_ffn__prompt_kernel_havetag_31:
    s_add_u32 m0, s33, 0
    s_nop 0
    buffer_load_dwordx4 v153, s[8:11], s31 offen lds
    s_add_u32 s31, s31, 57344
    s_add_u32 m0, s33, 8192
    s_nop 0
    buffer_load_dwordx4 v153, s[8:11], s31 offen lds
    s_add_u32 s31, s31, 57344
    s_add_u32 m0, s33, 16384
    s_nop 0
    buffer_load_dwordx4 v153, s[8:11], s31 offen lds
    s_add_u32 s31, s31, 57344
    s_add_u32 m0, s33, 24576
    s_nop 0
    buffer_load_dwordx4 v153, s[8:11], s31 offen lds
    s_add_u32 s31, s31, 57344
    s_nop 7
    v_cvt_pk_bf16_f32 v56, v56, v57
    v_cvt_pk_bf16_f32 v57, v58, v59
    v_cvt_pk_bf16_f32 v58, v60, v61
    v_cvt_pk_bf16_f32 v59, v62, v63
    v_cvt_pk_bf16_f32 v60, v64, v65
    v_cvt_pk_bf16_f32 v61, v66, v67
    v_cvt_pk_bf16_f32 v62, v68, v69
    v_cvt_pk_bf16_f32 v63, v70, v71
    s_mov_b64 exec, s[46:47]
    v_mov_b32 v62, 0x3f803f80
    v_mov_b32 v63, 0x3f80
    s_mov_b64 exec, -1
    s_lshl_b32 s35, s39, 6
    s_add_u32 s35, s35, s43
    s_add_u32 s35, s35, s48
    s_lshl_b32 s35, s35, 11
    buffer_store_dwordx4 v[56:59], v2, s[20:23], s35 offen sc0 sc1
    buffer_store_dwordx4 v[60:63], v2, s[20:23], s35 offen offset:1024 sc0 sc1
    s_waitcnt vmcnt(5) lgkmcnt(0)
    s_barrier
    ds_read_b64_tr_b16 v[24:25], v5 offset:0
    ds_read_b64_tr_b16 v[26:27], v5 offset:256
    ds_read_b64_tr_b16 v[28:29], v5 offset:1024
    ds_read_b64_tr_b16 v[30:31], v5 offset:1280
    ds_read_b128 v[16:19], v3 offset:0
    ds_read_b128 v[20:23], v3 offset:2048
    s_waitcnt lgkmcnt(0)
    v_mfma_f32_32x32x16_bf16 v[56:71], v[24:27], v[16:19], 0
    v_mfma_f32_32x32x16_bf16 v[72:87], v[24:27], v[20:23], 0
    s_waitcnt vmcnt(4)
    s_barrier
    v_mfma_f32_32x32x16_bf16 v[88:103], v[28:31], v[16:19], 0
    ds_read_b64_tr_b16 v[40:41], v5 offset:8192
    ds_read_b64_tr_b16 v[42:43], v5 offset:8448
    ds_read_b64_tr_b16 v[44:45], v5 offset:9216
    v_mfma_f32_32x32x16_bf16 v[104:119], v[28:31], v[20:23], 0
    ds_read_b64_tr_b16 v[46:47], v5 offset:9472
    ds_read_b128 v[32:35], v4 offset:0
    ds_read_b128 v[36:39], v4 offset:2048
    s_add_u32 m0, s33, 0
    s_nop 0
    buffer_load_dwordx4 v153, s[8:11], s31 offen lds
    s_add_u32 s31, s31, 57344
    s_waitcnt lgkmcnt(0)
    v_mfma_f32_32x32x16_bf16 v[56:71], v[40:43], v[32:35], v[56:71]
    v_mfma_f32_32x32x16_bf16 v[72:87], v[40:43], v[36:39], v[72:87]
    s_waitcnt vmcnt(4)
    s_barrier
    v_mfma_f32_32x32x16_bf16 v[88:103], v[44:47], v[32:35], v[88:103]
    ds_read_b64_tr_b16 v[24:25], v5 offset:16384
    ds_read_b64_tr_b16 v[26:27], v5 offset:16640
    ds_read_b64_tr_b16 v[28:29], v5 offset:17408
    v_mfma_f32_32x32x16_bf16 v[104:119], v[44:47], v[36:39], v[104:119]
    ds_read_b64_tr_b16 v[30:31], v5 offset:17664
    ds_read_b128 v[16:19], v3 offset:8192
    ds_read_b128 v[20:23], v3 offset:10240
    s_add_u32 m0, s33, 8192
    s_nop 0
    buffer_load_dwordx4 v153, s[8:11], s31 offen lds
    s_add_u32 s31, s31, 57344
    s_waitcnt lgkmcnt(0)
    v_mfma_f32_32x32x16_bf16 v[56:71], v[24:27], v[16:19], v[56:71]
    v_mfma_f32_32x32x16_bf16 v[72:87], v[24:27], v[20:23], v[72:87]
    s_waitcnt vmcnt(4)
    s_barrier
    v_mfma_f32_32x32x16_bf16 v[88:103], v[28:31], v[16:19], v[88:103]
    ds_read_b64_tr_b16 v[40:41], v5 offset:24576
    ds_read_b64_tr_b16 v[42:43], v5 offset:24832
    ds_read_b64_tr_b16 v[44:45], v5 offset:25600
    v_mfma_f32_32x32x16_bf16 v[104:119], v[28:31], v[20:23], v[104:119]
    ds_read_b64_tr_b16 v[46:47], v5 offset:25856
    ds_read_b128 v[32:35], v4 offset:8192
    ds_read_b128 v[36:39], v4 offset:10240
    s_add_u32 m0, s33, 16384
    s_nop 0
    buffer_load_dwordx4 v153, s[8:11], s31 offen lds
    s_add_u32 s31, s31, 57344
    s_waitcnt lgkmcnt(0)
    v_mfma_f32_32x32x16_bf16 v[56:71], v[40:43], v[32:35], v[56:71]
    v_mfma_f32_32x32x16_bf16 v[72:87], v[40:43], v[36:39], v[72:87]
    s_waitcnt vmcnt(2)
    s_barrier
    v_mfma_f32_32x32x16_bf16 v[88:103], v[44:47], v[32:35], v[88:103]
    v_add_u32 v3, 16384, v3
    v_add_u32 v4, 16384, v4
    ds_read_b64_tr_b16 v[24:25], v5 offset:0
    ds_read_b64_tr_b16 v[26:27], v5 offset:256
    v_mfma_f32_32x32x16_bf16 v[104:119], v[44:47], v[36:39], v[104:119]
    ds_read_b64_tr_b16 v[28:29], v5 offset:1024
    ds_read_b64_tr_b16 v[30:31], v5 offset:1280
    ds_read_b128 v[16:19], v3 offset:0
    ds_read_b128 v[20:23], v3 offset:2048
    s_add_u32 m0, s33, 24576
    s_nop 0
    buffer_load_dwordx4 v153, s[8:11], s31 offen lds
    s_add_u32 s31, s31, 57344
    v_mov_b32 v9, 155648
    v_mov_b32 v10, 1
    s_mov_b64 exec, 1
    ds_add_rtn_u32 v10, v9, v10
    s_waitcnt lgkmcnt(0)
    s_mov_b64 exec, -1
    v_readfirstlane_b32 s35, v10
    s_nop 3
    s_cmp_lg_u32 s35, 7
    s_cbranch_scc1 parallel_sum__softmax_full_mha__swiglu_ffn__prompt_kernel_arr_34
    s_lshl_b32 s35, s2, 6
    s_add_u32 s35, s35, 25296896
    v_mov_b32 v9, s74
    v_mov_b32 v10, 0
    s_mov_b64 exec, 1
    buffer_store_dword v9, v10, s[20:23], s35 offen sc0 sc1
    s_mov_b64 exec, -1
parallel_sum__softmax_full_mha__swiglu_ffn__prompt_kernel_arr_34:
    s_mov_b32 s34, 5
parallel_sum__softmax_full_mha__swiglu_ffn__prompt_kernel_K1_p2_loop:
    s_waitcnt lgkmcnt(0)
    v_mfma_f32_32x32x16_bf16 v[56:71], v[24:27], v[16:19], v[56:71]
    v_mfma_f32_32x32x16_bf16 v[72:87], v[24:27], v[20:23], v[72:87]
    s_waitcnt vmcnt(2)
    s_barrier
    v_mfma_f32_32x32x16_bf16 v[88:103], v[28:31], v[16:19], v[88:103]
    ds_read_b64_tr_b16 v[40:41], v5 offset:8192
    ds_read_b64_tr_b16 v[42:43], v5 offset:8448
    ds_read_b64_tr_b16 v[44:45], v5 offset:9216
    v_mfma_f32_32x32x16_bf16 v[104:119], v[28:31], v[20:23], v[104:119]
    ds_read_b64_tr_b16 v[46:47], v5 offset:9472
    ds_read_b128 v[32:35], v4 offset:0
    ds_read_b128 v[36:39], v4 offset:2048
    s_add_u32 m0, s33, 0
    s_nop 0
    buffer_load_dwordx4 v153, s[8:11], s31 offen lds
    s_add_u32 s31, s31, 57344
    s_waitcnt lgkmcnt(0)
    v_mfma_f32_32x32x16_bf16 v[56:71], v[40:43], v[32:35], v[56:71]
    v_mfma_f32_32x32x16_bf16 v[72:87], v[40:43], v[36:39], v[72:87]
    s_waitcnt vmcnt(2)
    s_barrier
    v_mfma_f32_32x32x16_bf16 v[88:103], v[44:47], v[32:35], v[88:103]
    ds_read_b64_tr_b16 v[24:25], v5 offset:16384
    ds_read_b64_tr_b16 v[26:27], v5 offset:16640
    ds_read_b64_tr_b16 v[28:29], v5 offset:17408
    v_mfma_f32_32x32x16_bf16 v[104:119], v[44:47], v[36:39], v[104:119]
    ds_read_b64_tr_b16 v[30:31], v5 offset:17664
    ds_read_b128 v[16:19], v3 offset:8192
    ds_read_b128 v[20:23], v3 offset:10240
    s_add_u32 m0, s33, 8192
    s_nop 0
    buffer_load_dwordx4 v153, s[8:11], s31 offen lds
    s_add_u32 s31, s31, 57344
    s_waitcnt lgkmcnt(0)
    v_mfma_f32_32x32x16_bf16 v[56:71], v[24:27], v[16:19], v[56:71]
    v_mfma_f32_32x32x16_bf16 v[72:87], v[24:27], v[20:23], v[72:87]
    s_waitcnt vmcnt(2)
    s_barrier
    v_mfma_f32_32x32x16_bf16 v[88:103], v[28:31], v[16:19], v[88:103]
    ds_read_b64_tr_b16 v[40:41], v5 offset:24576
    ds_read_b64_tr_b16 v[42:43], v5 offset:24832
    ds_read_b64_tr_b16 v[44:45], v5 offset:25600
    v_mfma_f32_32x32x16_bf16 v[104:119], v[28:31], v[20:23], v[104:119]
    ds_read_b64_tr_b16 v[46:47], v5 offset:25856
    ds_read_b128 v[32:35], v4 offset:8192
    ds_read_b128 v[36:39], v4 offset:10240
    s_add_u32 m0, s33, 16384
    s_nop 0
    buffer_load_dwordx4 v153, s[8:11], s31 offen lds
    s_add_u32 s31, s31, 57344
    s_waitcnt lgkmcnt(0)
    v_mfma_f32_32x32x16_bf16 v[56:71], v[40:43], v[32:35], v[56:71]
    v_mfma_f32_32x32x16_bf16 v[72:87], v[40:43], v[36:39], v[72:87]
    s_waitcnt vmcnt(2)
    s_barrier
    v_mfma_f32_32x32x16_bf16 v[88:103], v[44:47], v[32:35], v[88:103]
    v_add_u32 v3, 16384, v3
    v_add_u32 v4, 16384, v4
    ds_read_b64_tr_b16 v[24:25], v5 offset:0
    ds_read_b64_tr_b16 v[26:27], v5 offset:256
    v_mfma_f32_32x32x16_bf16 v[104:119], v[44:47], v[36:39], v[104:119]
    ds_read_b64_tr_b16 v[28:29], v5 offset:1024
    ds_read_b64_tr_b16 v[30:31], v5 offset:1280
    ds_read_b128 v[16:19], v3 offset:0
    ds_read_b128 v[20:23], v3 offset:2048
    s_add_u32 m0, s33, 24576
    s_nop 0
    buffer_load_dwordx4 v153, s[8:11], s31 offen lds
    s_add_u32 s31, s31, 57344
    s_sub_u32 s34, s34, 1
    s_cmp_lg_u32 s34, 0
    s_cbranch_scc1 parallel_sum__softmax_full_mha__swiglu_ffn__prompt_kernel_K1_p2_loop
    s_waitcnt lgkmcnt(0)
    v_mfma_f32_32x32x16_bf16 v[56:71], v[24:27], v[16:19], v[56:71]
    v_mfma_f32_32x32x16_bf16 v[72:87], v[24:27], v[20:23], v[72:87]
    s_waitcnt vmcnt(2)
    s_barrier
    v_mfma_f32_32x32x16_bf16 v[88:103], v[28:31], v[16:19], v[88:103]
    ds_read_b64_tr_b16 v[40:41], v5 offset:8192
    ds_read_b64_tr_b16 v[42:43], v5 offset:8448
    ds_read_b64_tr_b16 v[44:45], v5 offset:9216
    v_mfma_f32_32x32x16_bf16 v[104:119], v[28:31], v[20:23], v[104:119]
    ds_read_b64_tr_b16 v[46:47], v5 offset:9472
    ds_read_b128 v[32:35], v4 offset:0
    ds_read_b128 v[36:39], v4 offset:2048
    s_waitcnt lgkmcnt(0)
    v_mfma_f32_32x32x16_bf16 v[56:71], v[40:43], v[32:35], v[56:71]
    v_mfma_f32_32x32x16_bf16 v[72:87], v[40:43], v[36:39], v[72:87]
    s_waitcnt vmcnt(1)
    s_barrier
    v_mfma_f32_32x32x16_bf16 v[88:103], v[44:47], v[32:35], v[88:103]
    ds_read_b64_tr_b16 v[24:25], v5 offset:16384
    ds_read_b64_tr_b16 v[26:27], v5 offset:16640
    ds_read_b64_tr_b16 v[28:29], v5 offset:17408
    v_mfma_f32_32x32x16_bf16 v[104:119], v[44:47], v[36:39], v[104:119]
    ds_read_b64_tr_b16 v[30:31], v5 offset:17664
    ds_read_b128 v[16:19], v3 offset:8192
    ds_read_b128 v[20:23], v3 offset:10240
    s_waitcnt lgkmcnt(0)
    v_mfma_f32_32x32x16_bf16 v[56:71], v[24:27], v[16:19], v[56:71]
    v_mfma_f32_32x32x16_bf16 v[72:87], v[24:27], v[20:23], v[72:87]
    s_waitcnt vmcnt(0)
    s_barrier
    v_mfma_f32_32x32x16_bf16 v[88:103], v[28:31], v[16:19], v[88:103]
    ds_read_b64_tr_b16 v[40:41], v5 offset:24576
    ds_read_b64_tr_b16 v[42:43], v5 offset:24832
    ds_read_b64_tr_b16 v[44:45], v5 offset:25600
    v_mfma_f32_32x32x16_bf16 v[104:119], v[28:31], v[20:23], v[104:119]
    ds_read_b64_tr_b16 v[46:47], v5 offset:25856
    ds_read_b128 v[32:35], v4 offset:8192
    ds_read_b128 v[36:39], v4 offset:10240
    s_waitcnt lgkmcnt(0)
    v_mfma_f32_32x32x16_bf16 v[56:71], v[40:43], v[32:35], v[56:71]
    v_mfma_f32_32x32x16_bf16 v[72:87], v[40:43], v[36:39], v[72:87]
    v_mfma_f32_32x32x16_bf16 v[88:103], v[44:47], v[32:35], v[88:103]
    v_mfma_f32_32x32x16_bf16 v[104:119], v[44:47], v[36:39], v[104:119]
    s_barrier
    s_nop 10
    s_mov_b32 s36, 0xbfb8aa3b
    v_mul_f32 v16, s36, v56
    v_mul_f32 v17, s36, v57
    v_mul_f32 v18, s36, v58
    v_mul_f32 v19, s36, v59
    v_exp_f32 v16, v16
    v_exp_f32 v17, v17
    v_exp_f32 v18, v18
    v_exp_f32 v19, v19
    v_mul_f32 v56, v56, v88
    v_mul_f32 v57, v57, v89
    v_mul_f32 v58, v58, v90
    v_mul_f32 v59, v59, v91
    v_add_f32 v16, 1.0, v16
    v_add_f32 v17, 1.0, v17
    v_add_f32 v18, 1.0, v18
    v_add_f32 v19, 1.0, v19
    v_rcp_f32 v16, v16
    v_rcp_f32 v17, v17
    v_rcp_f32 v18, v18
    v_rcp_f32 v19, v19
    s_nop 0
    v_mul_f32 v56, v56, v16
    v_mul_f32 v57, v57, v17
    v_mul_f32 v58, v58, v18
    v_mul_f32 v59, v59, v19
    v_mul_f32 v16, s36, v60
    v_mul_f32 v17, s36, v61
    v_mul_f32 v18, s36, v62
    v_mul_f32 v19, s36, v63
    v_exp_f32 v16, v16
    v_exp_f32 v17, v17
    v_exp_f32 v18, v18
    v_exp_f32 v19, v19
    v_mul_f32 v60, v60, v92
    v_mul_f32 v61, v61, v93
    v_mul_f32 v62, v62, v94
    v_mul_f32 v63, v63, v95
    v_add_f32 v16, 1.0, v16
    v_add_f32 v17, 1.0, v17
    v_add_f32 v18, 1.0, v18
    v_add_f32 v19, 1.0, v19
    v_rcp_f32 v16, v16
    v_rcp_f32 v17, v17
    v_rcp_f32 v18, v18
    v_rcp_f32 v19, v19
    s_nop 0
    v_mul_f32 v60, v60, v16
    v_mul_f32 v61, v61, v17
    v_mul_f32 v62, v62, v18
    v_mul_f32 v63, v63, v19
    v_mul_f32 v16, s36, v64
    v_mul_f32 v17, s36, v65
    v_mul_f32 v18, s36, v66
    v_mul_f32 v19, s36, v67
    v_exp_f32 v16, v16
    v_exp_f32 v17, v17
    v_exp_f32 v18, v18
    v_exp_f32 v19, v19
    v_mul_f32 v64, v64, v96
    v_mul_f32 v65, v65, v97
    v_mul_f32 v66, v66, v98
    v_mul_f32 v67, v67, v99
    v_add_f32 v16, 1.0, v16
    v_add_f32 v17, 1.0, v17
    v_add_f32 v18, 1.0, v18
    v_add_f32 v19, 1.0, v19
    v_rcp_f32 v16, v16
    v_rcp_f32 v17, v17
    v_rcp_f32 v18, v18
    v_rcp_f32 v19, v19
    s_nop 0
    v_mul_f32 v64, v64, v16
    v_mul_f32 v65, v65, v17
    v_mul_f32 v66, v66, v18
    v_mul_f32 v67, v67, v19
    v_mul_f32 v16, s36, v68
    v_mul_f32 v17, s36, v69
    v_mul_f32 v18, s36, v70
    v_mul_f32 v19, s36, v71
    v_exp_f32 v16, v16
    v_exp_f32 v17, v17
    v_exp_f32 v18, v18
    v_exp_f32 v19, v19
    v_mul_f32 v68, v68, v100
    v_mul_f32 v69, v69, v101
    v_mul_f32 v70, v70, v102
    v_mul_f32 v71, v71, v103
    v_add_f32 v16, 1.0, v16
    v_add_f32 v17, 1.0, v17
    v_add_f32 v18, 1.0, v18
    v_add_f32 v19, 1.0, v19
    v_rcp_f32 v16, v16
    v_rcp_f32 v17, v17
    v_rcp_f32 v18, v18
    v_rcp_f32 v19, v19
    s_nop 0
    v_mul_f32 v68, v68, v16
    v_mul_f32 v69, v69, v17
    v_mul_f32 v70, v70, v18
    v_mul_f32 v71, v71, v19
    v_cvt_pk_bf16_f32 v88, v56, v57
    v_cvt_pk_bf16_f32 v89, v58, v59
    v_cvt_pk_bf16_f32 v90, v60, v61
    v_cvt_pk_bf16_f32 v91, v62, v63
    v_cvt_pk_bf16_f32 v92, v64, v65
    v_cvt_pk_bf16_f32 v93, v66, v67
    v_cvt_pk_bf16_f32 v94, v68, v69
    v_cvt_pk_bf16_f32 v95, v70, v71
    s_mul_i32 s35, s43, 144
    s_add_u32 s35, s35, s45
    s_lshl_b32 s35, s35, 10
    s_add_u32 s35, s35, 6291456
    buffer_store_dwordx4 v[88:91], v2, s[20:23], s35 offen sc0 sc1
    buffer_store_dwordx4 v[92:95], v2, s[20:23], s35 offen offset:1024 sc0 sc1
    s_mov_b32 s36, 0xbfb8aa3b
    v_mul_f32 v16, s36, v72
    v_mul_f32 v17, s36, v73
    v_mul_f32 v18, s36, v74
    v_mul_f32 v19, s36, v75
    v_exp_f32 v16, v16
    v_exp_f32 v17, v17
    v_exp_f32 v18, v18
    v_exp_f32 v19, v19
    v_mul_f32 v72, v72, v104
    v_mul_f32 v73, v73, v105
    v_mul_f32 v74, v74, v106
    v_mul_f32 v75, v75, v107
    v_add_f32 v16, 1.0, v16
    v_add_f32 v17, 1.0, v17
    v_add_f32 v18, 1.0, v18
    v_add_f32 v19, 1.0, v19
    v_rcp_f32 v16, v16
    v_rcp_f32 v17, v17
    v_rcp_f32 v18, v18
    v_rcp_f32 v19, v19
    s_nop 0
    v_mul_f32 v72, v72, v16
    v_mul_f32 v73, v73, v17
    v_mul_f32 v74, v74, v18
    v_mul_f32 v75, v75, v19
    v_mul_f32 v16, s36, v76
    v_mul_f32 v17, s36, v77
    v_mul_f32 v18, s36, v78
    v_mul_f32 v19, s36, v79
    v_exp_f32 v16, v16
    v_exp_f32 v17, v17
    v_exp_f32 v18, v18
    v_exp_f32 v19, v19
    v_mul_f32 v76, v76, v108
    v_mul_f32 v77, v77, v109
    v_mul_f32 v78, v78, v110
    v_mul_f32 v79, v79, v111
    v_add_f32 v16, 1.0, v16
    v_add_f32 v17, 1.0, v17
    v_add_f32 v18, 1.0, v18
    v_add_f32 v19, 1.0, v19
    v_rcp_f32 v16, v16
    v_rcp_f32 v17, v17
    v_rcp_f32 v18, v18
    v_rcp_f32 v19, v19
    s_nop 0
    v_mul_f32 v76, v76, v16
    v_mul_f32 v77, v77, v17
    v_mul_f32 v78, v78, v18
    v_mul_f32 v79, v79, v19
    v_mul_f32 v16, s36, v80
    v_mul_f32 v17, s36, v81
    v_mul_f32 v18, s36, v82
    v_mul_f32 v19, s36, v83
    v_exp_f32 v16, v16
    v_exp_f32 v17, v17
    v_exp_f32 v18, v18
    v_exp_f32 v19, v19
    v_mul_f32 v80, v80, v112
    v_mul_f32 v81, v81, v113
    v_mul_f32 v82, v82, v114
    v_mul_f32 v83, v83, v115
    v_add_f32 v16, 1.0, v16
    v_add_f32 v17, 1.0, v17
    v_add_f32 v18, 1.0, v18
    v_add_f32 v19, 1.0, v19
    v_rcp_f32 v16, v16
    v_rcp_f32 v17, v17
    v_rcp_f32 v18, v18
    v_rcp_f32 v19, v19
    s_nop 0
    v_mul_f32 v80, v80, v16
    v_mul_f32 v81, v81, v17
    v_mul_f32 v82, v82, v18
    v_mul_f32 v83, v83, v19
    v_mul_f32 v16, s36, v84
    v_mul_f32 v17, s36, v85
    v_mul_f32 v18, s36, v86
    v_mul_f32 v19, s36, v87
    v_exp_f32 v16, v16
    v_exp_f32 v17, v17
    v_exp_f32 v18, v18
    v_exp_f32 v19, v19
    v_mul_f32 v84, v84, v116
    v_mul_f32 v85, v85, v117
    v_mul_f32 v86, v86, v118
    v_mul_f32 v87, v87, v119
    v_add_f32 v16, 1.0, v16
    v_add_f32 v17, 1.0, v17
    v_add_f32 v18, 1.0, v18
    v_add_f32 v19, 1.0, v19
    v_rcp_f32 v16, v16
    v_rcp_f32 v17, v17
    v_rcp_f32 v18, v18
    v_rcp_f32 v19, v19
    s_nop 0
    v_mul_f32 v84, v84, v16
    v_mul_f32 v85, v85, v17
    v_mul_f32 v86, v86, v18
    v_mul_f32 v87, v87, v19
    v_cvt_pk_bf16_f32 v104, v72, v73
    v_cvt_pk_bf16_f32 v105, v74, v75
    v_cvt_pk_bf16_f32 v106, v76, v77
    v_cvt_pk_bf16_f32 v107, v78, v79
    v_cvt_pk_bf16_f32 v108, v80, v81
    v_cvt_pk_bf16_f32 v109, v82, v83
    v_cvt_pk_bf16_f32 v110, v84, v85
    v_cvt_pk_bf16_f32 v111, v86, v87
    s_mul_i32 s35, s44, 144
    s_add_u32 s35, s35, s45
    s_lshl_b32 s35, s35, 10
    s_add_u32 s35, s35, 6291456
    buffer_store_dwordx4 v[104:107], v2, s[20:23], s35 offen sc0 sc1
    buffer_store_dwordx4 v[108:111], v2, s[20:23], s35 offen offset:1024 sc0 sc1
    s_waitcnt vmcnt(0)
    v_mov_b32 v9, 155652
    v_mov_b32 v10, 1
    s_mov_b64 exec, 1
    ds_add_rtn_u32 v10, v9, v10
    s_waitcnt lgkmcnt(0)
    s_mov_b64 exec, -1
    v_readfirstlane_b32 s35, v10
    s_nop 3
    s_cmp_lg_u32 s35, 7
    s_cbranch_scc1 parallel_sum__softmax_full_mha__swiglu_ffn__prompt_kernel_arr_35
    s_lshl_b32 s35, s2, 6
    s_add_u32 s35, s35, 25165824
    v_mov_b32 v9, s74
    v_mov_b32 v10, 0
    s_mov_b64 exec, 1
    buffer_store_dword v9, v10, s[20:23], s35 offen sc0 sc1
    s_mov_b64 exec, -1
parallel_sum__softmax_full_mha__swiglu_ffn__prompt_kernel_arr_35:
    s_load_dwordx2 s[52:53], s[0:1], 56
    s_sub_u32 s39, s3, 4
    s_and_b32 s33, s2, 7
    s_lshr_b32 s34, s2, 3
    s_and_b32 s24, s34, 3
    s_lshl_b32 s33, s33, 2
    s_add_u32 s24, s24, s33
    s_lshr_b32 s29, s34, 2
    v_lshrrev_b32 v7, 3, v1
    v_and_b32 v8, 7, v1
    v_bfe_u32 v11, v1, 4, 1
    v_lshlrev_b32 v11, 2, v11
    v_xor_b32 v8, v8, v11
    v_lshlrev_b32 v8, 4, v8
    v_mul_u32_u24 v7, 896, v7
    s_lshl_b32 s33, s29, 7
    v_add3_u32 v3, v7, v8, s33
    v_lshrrev_b32 v7, 5, v1
    v_bfe_u32 v8, v1, 2, 2
    v_lshl_add_u32 v7, v7, 2, v8
    v_lshlrev_b32 v7, 7, v7
    v_bfe_u32 v11, v1, 4, 1
    v_bfe_u32 v12, v1, 1, 1
    v_lshl_add_u32 v11, v11, 1, v12
    v_bfe_u32 v12, v1, 3, 1
    v_lshlrev_b32 v12, 2, v12
    v_xor_b32 v11, v11, v12
    v_lshl_add_u32 v7, v11, 4, v7
    v_and_b32 v12, 1, v1
    v_lshl_add_u32 v7, v12, 3, v7
    s_mul_i32 s38, s39, 16384
    s_add_u32 s38, s38, 66560
    v_add_u32 v4, s38, v7
    v_xor_b32 v5, 64, v4
    s_and_b32 s34, s39, 1
    s_lshl_b32 s34, s34, 5
    s_lshl_b32 s33, s24, 6
    s_add_u32 s34, s34, s33
    v_and_b32 v7, 31, v1
    v_add_u32 v7, s34, v7
    v_mul_u32_u24 v7, 896, v7
    s_lshr_b32 s33, s39, 1
    s_lshl_b32 s33, s33, 6
    s_lshl_b32 s34, s29, 7
    s_add_u32 s33, s33, s34
    v_lshrrev_b32 v8, 5, v1
    v_lshlrev_b32 v8, 4, v8
    v_add3_u32 v6, v7, v8, s33
    s_waitcnt lgkmcnt(0)
    s_mov_b32 s4, s70
    s_and_b32 s5, s71, 0xffff
    s_mov_b32 s6, 33554432
    s_mov_b32 s7, 0x20000
    s_mov_b32 s8, s64
    s_and_b32 s9, s65, 0xffff
    s_mov_b32 s10, 1605632
    s_mov_b32 s11, 0x20000
    s_mov_b32 s12, s66
    s_and_b32 s13, s67, 0xffff
    s_mov_b32 s14, 401408
    s_mov_b32 s15, 0x20000
    s_mov_b32 s16, s56
    s_and_b32 s17, s57, 0xffff
    s_mov_b32 s18, 1835008
    s_mov_b32 s19, 0x20000
    s_mov_b32 s60, s52
    s_and_b32 s61, s53, 0xffff
    s_mov_b32 s62, 1835008
    s_mov_b32 s63, 0x20000
    s_lshl_b32 s48, s39, 3
    s_add_u32 s48, s48, 24
    s_mul_i32 s49, s39, 6
    s_mul_i32 s31, s24, 288
    s_lshl_b32 s33, s49, 1
    s_add_u32 s31, s31, s33
    s_lshl_b32 s31, s31, 10
    s_add_u32 s31, s31, 6291456
    s_mov_b32 s51, s31
    s_mul_i32 s50, s49, 28672
    s_mul_i32 s31, s24, 288
    s_lshl_b32 s33, s48, 1
    s_add_u32 s31, s31, s33
    s_lshl_b32 s31, s31, 10
    s_add_u32 s31, s31, 6291456
    s_mul_i32 s32, s48, 28672
    s_add_u32 m0, s38, 0
    s_nop 0
    buffer_load_dwordx4 v3, s[8:11], s32 offen lds
    s_add_u32 m0, s38, 1024
    s_add_u32 s32, s32, 7168
    buffer_load_dwordx4 v3, s[8:11], s32 offen lds
    s_add_u32 m0, s38, 2048
    s_add_u32 s32, s32, 7168
    buffer_load_dwordx4 v3, s[8:11], s32 offen lds
    s_add_u32 m0, s38, 3072
    s_add_u32 s32, s32, 7168
    buffer_load_dwordx4 v3, s[8:11], s32 offen lds
    s_add_u32 s32, s32, 7168
    s_add_u32 m0, s38, 4096
    s_nop 0
    buffer_load_dwordx4 v3, s[8:11], s32 offen lds
    s_add_u32 m0, s38, 5120
    s_add_u32 s32, s32, 7168
    buffer_load_dwordx4 v3, s[8:11], s32 offen lds
    s_add_u32 m0, s38, 6144
    s_add_u32 s32, s32, 7168
    buffer_load_dwordx4 v3, s[8:11], s32 offen lds
    s_add_u32 m0, s38, 7168
    s_add_u32 s32, s32, 7168
    buffer_load_dwordx4 v3, s[8:11], s32 offen lds
    s_add_u32 s32, s32, 7168
    s_add_u32 m0, s38, 8192
    s_nop 0
    buffer_load_dwordx4 v3, s[8:11], s32 offen lds
    s_add_u32 m0, s38, 9216
    s_add_u32 s32, s32, 7168
    buffer_load_dwordx4 v3, s[8:11], s32 offen lds
    s_add_u32 m0, s38, 10240
    s_add_u32 s32, s32, 7168
    buffer_load_dwordx4 v3, s[8:11], s32 offen lds
    s_add_u32 m0, s38, 11264
    s_add_u32 s32, s32, 7168
    buffer_load_dwordx4 v3, s[8:11], s32 offen lds
    s_add_u32 s32, s32, 7168
    buffer_load_dwordx4 v[188:191], v6, s[16:19], 0 offen
    buffer_load_dwordx4 v[192:195], v6, s[16:19], 0 offen offset:32
    s_branch parallel_sum__softmax_full_mha__swiglu_ffn__prompt_kernel_phaseB_gemm
parallel_sum__softmax_full_mha__swiglu_ffn__prompt_kernel_phaseB_attn:
    v_mov_b32 v44, 0
    v_mov_b32 v45, 0
    v_mov_b32 v46, 0
    v_mov_b32 v47, 0
    v_mov_b32 v48, 0
    v_mov_b32 v49, 0
    v_mov_b32 v50, 0
    v_mov_b32 v51, 0
    v_mov_b32 v52, 0
    v_mov_b32 v53, 0
    v_mov_b32 v54, 0
    v_mov_b32 v55, 0
    v_mov_b32 v56, 0
    v_mov_b32 v57, 0
    v_mov_b32 v58, 0
    v_mov_b32 v59, 0
    v_mov_b32 v60, 0
    v_mov_b32 v61, 0
    v_mov_b32 v62, 0
    v_mov_b32 v63, 0
    v_mov_b32 v64, 0
    v_mov_b32 v65, 0
    v_mov_b32 v66, 0
    v_mov_b32 v67, 0
    v_mov_b32 v68, 0
    v_mov_b32 v69, 0
    v_mov_b32 v70, 0
    v_mov_b32 v71, 0
    v_mov_b32 v72, 0
    v_mov_b32 v73, 0
    v_mov_b32 v74, 0
    v_mov_b32 v75, 0
    v_mov_b32 v76, 0
    v_mov_b32 v77, 0
    v_mov_b32 v78, 0
    v_mov_b32 v79, 0
    v_mov_b32 v80, 0
    v_mov_b32 v81, 0
    v_mov_b32 v82, 0
    v_mov_b32 v83, 0
    v_mov_b32 v84, 0
    v_mov_b32 v85, 0
    v_mov_b32 v86, 0
    v_mov_b32 v87, 0
    v_mov_b32 v88, 0
    v_mov_b32 v89, 0
    v_mov_b32 v90, 0
    v_mov_b32 v91, 0
    v_mov_b32 v92, 0
    v_mov_b32 v93, 0
    v_mov_b32 v94, 0
    v_mov_b32 v95, 0
    v_mov_b32 v96, 0
    v_mov_b32 v97, 0
    v_mov_b32 v98, 0
    v_mov_b32 v99, 0
    v_mov_b32 v100, 0
    v_mov_b32 v101, 0
    v_mov_b32 v102, 0
    v_mov_b32 v103, 0
    v_mov_b32 v104, 0
    v_mov_b32 v105, 0
    v_mov_b32 v106, 0
    v_mov_b32 v107, 0
    v_mov_b32 v112, 0
    v_mov_b32 v113, 0
    v_mov_b32 v114, 0
    v_mov_b32 v115, 0
    s_waitcnt vmcnt(16)
    v_mfma_f32_32x32x16_bf16 v[12:27], v[200:203], v[120:123], 0
    v_mfma_f32_32x32x16_bf16 v[12:27], v[204:207], v[124:127], v[12:27]
    v_mfma_f32_32x32x16_bf16 v[28:43], v[200:203], v[128:131], 0
    v_mfma_f32_32x32x16_bf16 v[28:43], v[204:207], v[132:135], v[28:43]
    s_nop 9
    v_max3_f32 v216, v12, v13, v14
    v_max3_f32 v216, v216, v15, v16
    v_max3_f32 v216, v216, v17, v18
    v_max3_f32 v216, v216, v19, v20
    v_max3_f32 v216, v216, v21, v22
    v_max3_f32 v216, v216, v23, v24
    v_max3_f32 v216, v216, v25, v26
    v_max_f32 v216, v216, v27
    v_mfma_f32_32x32x16_bf16 v[12:27], v[200:203], v[136:139], 0
    v_mfma_f32_32x32x16_bf16 v[12:27], v[204:207], v[140:143], v[12:27]
    s_nop 9
    v_max3_f32 v217, v28, v29, v30
    v_max3_f32 v217, v217, v31, v32
    v_max3_f32 v217, v217, v33, v34
    v_max3_f32 v217, v217, v35, v36
    v_max3_f32 v217, v217, v37, v38
    v_max3_f32 v217, v217, v39, v40
    v_max3_f32 v217, v217, v41, v42
    v_max_f32 v217, v217, v43
    v_mfma_f32_32x32x16_bf16 v[28:43], v[200:203], v[144:147], 0
    v_mfma_f32_32x32x16_bf16 v[28:43], v[204:207], v[148:151], v[28:43]
    s_nop 9
    v_max3_f32 v218, v12, v13, v14
    v_max3_f32 v218, v218, v15, v16
    v_max3_f32 v218, v218, v17, v18
    v_max3_f32 v218, v218, v19, v20
    v_max3_f32 v218, v218, v21, v22
    v_max3_f32 v218, v218, v23, v24
    v_max3_f32 v218, v218, v25, v26
    v_max_f32 v218, v218, v27
    s_nop 11
    v_max3_f32 v219, v28, v29, v30
    v_max3_f32 v219, v219, v31, v32
    v_max3_f32 v219, v219, v33, v34
    v_max3_f32 v219, v219, v35, v36
    v_max3_f32 v219, v219, v37, v38
    v_max3_f32 v219, v219, v39, v40
    v_max3_f32 v219, v219, v41, v42
    v_max_f32 v219, v219, v43
    v_mov_b32 v7, v216
    s_nop 1
    v_permlane32_swap_b32 v216, v7
    s_nop 1
    v_max_f32 v216, v216, v7
    v_add_f32 v216, 0x42c00000, v216
    v_sub_f32 v3, 0, v216
    v_cvt_pk_bf16_f32 v4, v3, v3
    v_and_b32 v5, 0xffff0000, v4
    v_sub_f32 v3, v3, v5
    v_cvt_pk_bf16_f32 v5, v3, v3
    v_and_b32 v6, 0xffff0000, v5
    v_sub_f32 v3, v3, v6
    v_cvt_pk_bf16_f32 v3, v3, 0
    v_and_b32 v4, 0xffff, v4
    v_or_b32 v4, v4, v6
    s_mov_b64 exec, s[30:31]
    v_mov_b32 v126, v4
    v_mov_b32 v127, v3
    s_mov_b64 exec, -1
    v_mov_b32 v7, v217
    s_nop 1
    v_permlane32_swap_b32 v217, v7
    s_nop 1
    v_max_f32 v217, v217, v7
    v_add_f32 v217, 0x42c00000, v217
    v_sub_f32 v3, 0, v217
    v_cvt_pk_bf16_f32 v4, v3, v3
    v_and_b32 v5, 0xffff0000, v4
    v_sub_f32 v3, v3, v5
    v_cvt_pk_bf16_f32 v5, v3, v3
    v_and_b32 v6, 0xffff0000, v5
    v_sub_f32 v3, v3, v6
    v_cvt_pk_bf16_f32 v3, v3, 0
    v_and_b32 v4, 0xffff, v4
    v_or_b32 v4, v4, v6
    s_mov_b64 exec, s[30:31]
    v_mov_b32 v134, v4
    v_mov_b32 v135, v3
    s_mov_b64 exec, -1
    v_mov_b32 v7, v218
    s_nop 1
    v_permlane32_swap_b32 v218, v7
    s_nop 1
    v_max_f32 v218, v218, v7
    v_add_f32 v218, 0x42c00000, v218
    v_sub_f32 v3, 0, v218
    v_cvt_pk_bf16_f32 v4, v3, v3
    v_and_b32 v5, 0xffff0000, v4
    v_sub_f32 v3, v3, v5
    v_cvt_pk_bf16_f32 v5, v3, v3
    v_and_b32 v6, 0xffff0000, v5
    v_sub_f32 v3, v3, v6
    v_cvt_pk_bf16_f32 v3, v3, 0
    v_and_b32 v4, 0xffff, v4
    v_or_b32 v4, v4, v6
    s_mov_b64 exec, s[30:31]
    v_mov_b32 v142, v4
    v_mov_b32 v143, v3
    s_mov_b64 exec, -1
    v_mov_b32 v7, v219
    s_nop 1
    v_permlane32_swap_b32 v219, v7
    s_nop 1
    v_max_f32 v219, v219, v7
    v_add_f32 v219, 0x42c00000, v219
    v_sub_f32 v3, 0, v219
    v_cvt_pk_bf16_f32 v4, v3, v3
    v_and_b32 v5, 0xffff0000, v4
    v_sub_f32 v3, v3, v5
    v_cvt_pk_bf16_f32 v5, v3, v3
    v_and_b32 v6, 0xffff0000, v5
    v_sub_f32 v3, v3, v6
    v_cvt_pk_bf16_f32 v3, v3, 0
    v_and_b32 v4, 0xffff, v4
    v_or_b32 v4, v4, v6
    s_mov_b64 exec, s[30:31]
    v_mov_b32 v150, v4
    v_mov_b32 v151, v3
    s_mov_b64 exec, -1
    s_branch parallel_sum__softmax_full_mha__swiglu_ffn__prompt_kernel_amain2
parallel_sum__softmax_full_mha__swiglu_ffn__prompt_kernel_amain:
    s_mov_b32 s48, s27
    s_mov_b32 s49, s18
    buffer_load_dwordx4 v[152:155], v2, s[8:11], s48 offen sc1
    buffer_load_dwordx4 v[156:159], v2, s[8:11], s48 offen offset:1024 sc1
    buffer_load_dwordx4 v[160:163], v2, s[12:15], s49 offen sc1
    buffer_load_dwordx4 v[164:167], v2, s[12:15], s49 offen offset:1024 sc1
    s_add_u32 s48, s48, 2048
    s_add_u32 s49, s49, 2048
    buffer_load_dwordx4 v[168:171], v2, s[8:11], s48 offen sc1
    buffer_load_dwordx4 v[172:175], v2, s[8:11], s48 offen offset:1024 sc1
    buffer_load_dwordx4 v[176:179], v2, s[12:15], s49 offen sc1
    buffer_load_dwordx4 v[180:183], v2, s[12:15], s49 offen offset:1024 sc1
    s_add_u32 s48, s48, 2048
    s_add_u32 s49, s49, 2048
    buffer_load_dwordx4 v[184:187], v2, s[8:11], s48 offen sc1
    buffer_load_dwordx4 v[188:191], v2, s[8:11], s48 offen offset:1024 sc1
    buffer_load_dwordx4 v[192:195], v2, s[12:15], s49 offen sc1
    buffer_load_dwordx4 v[196:199], v2, s[12:15], s49 offen offset:1024 sc1
    s_add_u32 s48, s48, 2048
    s_add_u32 s49, s49, 2048
    v_mov_b32 v44, 0
    v_mov_b32 v45, 0
    v_mov_b32 v46, 0
    v_mov_b32 v47, 0
    v_mov_b32 v48, 0
    v_mov_b32 v49, 0
    v_mov_b32 v50, 0
    v_mov_b32 v51, 0
    v_mov_b32 v52, 0
    v_mov_b32 v53, 0
    v_mov_b32 v54, 0
    v_mov_b32 v55, 0
    v_mov_b32 v56, 0
    v_mov_b32 v57, 0
    v_mov_b32 v58, 0
    v_mov_b32 v59, 0
    v_mov_b32 v60, 0
    v_mov_b32 v61, 0
    v_mov_b32 v62, 0
    v_mov_b32 v63, 0
    v_mov_b32 v64, 0
    v_mov_b32 v65, 0
    v_mov_b32 v66, 0
    v_mov_b32 v67, 0
    v_mov_b32 v68, 0
    v_mov_b32 v69, 0
    v_mov_b32 v70, 0
    v_mov_b32 v71, 0
    v_mov_b32 v72, 0
    v_mov_b32 v73, 0
    v_mov_b32 v74, 0
    v_mov_b32 v75, 0
    v_mov_b32 v76, 0
    v_mov_b32 v77, 0
    v_mov_b32 v78, 0
    v_mov_b32 v79, 0
    v_mov_b32 v80, 0
    v_mov_b32 v81, 0
    v_mov_b32 v82, 0
    v_mov_b32 v83, 0
    v_mov_b32 v84, 0
    v_mov_b32 v85, 0
    v_mov_b32 v86, 0
    v_mov_b32 v87, 0
    v_mov_b32 v88, 0
    v_mov_b32 v89, 0
    v_mov_b32 v90, 0
    v_mov_b32 v91, 0
    v_mov_b32 v92, 0
    v_mov_b32 v93, 0
    v_mov_b32 v94, 0
    v_mov_b32 v95, 0
    v_mov_b32 v96, 0
    v_mov_b32 v97, 0
    v_mov_b32 v98, 0
    v_mov_b32 v99, 0
    v_mov_b32 v100, 0
    v_mov_b32 v101, 0
    v_mov_b32 v102, 0
    v_mov_b32 v103, 0
    v_mov_b32 v104, 0
    v_mov_b32 v105, 0
    v_mov_b32 v106, 0
    v_mov_b32 v107, 0
    v_mov_b32 v112, 0
    v_mov_b32 v113, 0
    v_mov_b32 v114, 0
    v_mov_b32 v115, 0
parallel_sum__softmax_full_mha__swiglu_ffn__prompt_kernel_amain2:
    v_mov_b32 v212, 0
    v_mov_b32 v213, 0
    v_mov_b32 v214, 0
    v_mov_b32 v215, 0
    s_waitcnt vmcnt(8)
    v_mfma_f32_32x32x16_bf16 v[12:27], v[152:155], v[120:123], 0
    v_mfma_f32_32x32x16_bf16 v[12:27], v[156:159], v[124:127], v[12:27]
    s_cmp_eq_u32 s29, 1
    s_cbranch_scc1 parallel_sum__softmax_full_mha__swiglu_ffn__prompt_kernel_noh_36
    v_mov_b32 v9, 155652
    v_mov_b32 v10, 1
    s_mov_b64 exec, 1
    ds_add_rtn_u32 v10, v9, v10
    s_waitcnt lgkmcnt(0)
    s_mov_b64 exec, -1
    v_readfirstlane_b32 s35, v10
    s_nop 3
    s_cmp_lg_u32 s35, 7
    s_cbranch_scc1 parallel_sum__softmax_full_mha__swiglu_ffn__prompt_kernel_arr_37
    s_lshl_b32 s35, s2, 6
    s_add_u32 s35, s35, 25165824
    v_mov_b32 v9, s74
    v_mov_b32 v10, 0
    s_mov_b64 exec, 1
    buffer_store_dword v9, v10, s[20:23], s35 offen sc0 sc1
    s_mov_b64 exec, -1
parallel_sum__softmax_full_mha__swiglu_ffn__prompt_kernel_arr_37:
parallel_sum__softmax_full_mha__swiglu_ffn__prompt_kernel_noh_36:
    s_nop 11
    s_mov_b32 s51, 4
parallel_sum__softmax_full_mha__swiglu_ffn__prompt_kernel_aloop:
    s_cmp_lg_u32 s51, 4
    s_cbranch_scc1 parallel_sum__softmax_full_mha__swiglu_ffn__prompt_kernel_go_38
    v_mov_b32 v3, 155688
    v_mov_b32 v4, 1
    ds_write_b32 v3, v4
parallel_sum__softmax_full_mha__swiglu_ffn__prompt_kernel_go_38:
    v_mfma_f32_32x32x16_bf16 v[28:43], v[152:155], v[128:131], 0
    v_exp_f32 v116, v12
    v_exp_f32 v117, v13
    v_exp_f32 v118, v14
    v_exp_f32 v119, v15
    v_cvt_pk_bf16_f32 v108, v116, v117
    v_cvt_pk_bf16_f32 v109, v118, v119
    v_mfma_f32_32x32x16_bf16 v[92:107], v[212:215], v[112:115], v[92:107]
    buffer_load_dwordx4 v[200:203], v2, s[8:11], s48 offen sc1
    buffer_load_dwordx4 v[204:207], v2, s[8:11], s48 offen offset:1024 sc1
    buffer_load_dwordx4 v[208:211], v2, s[12:15], s49 offen sc1
    buffer_load_dwordx4 v[212:215], v2, s[12:15], s49 offen offset:1024 sc1
    s_add_u32 s48, s48, 2048
    s_add_u32 s49, s49, 2048
    v_exp_f32 v116, v16
    v_exp_f32 v117, v17
    v_exp_f32 v118, v18
    v_exp_f32 v119, v19
    v_cvt_pk_bf16_f32 v110, v116, v117
    v_cvt_pk_bf16_f32 v111, v118, v119
    v_mfma_f32_32x32x16_bf16 v[28:43], v[156:159], v[132:135], v[28:43]
    v_exp_f32 v116, v20
    v_exp_f32 v117, v21
    v_exp_f32 v118, v22
    v_exp_f32 v119, v23
    v_cvt_pk_bf16_f32 v112, v116, v117
    v_cvt_pk_bf16_f32 v113, v118, v119
    v_mfma_f32_32x32x16_bf16 v[44:59], v[160:163], v[108:111], v[44:59]
    v_exp_f32 v116, v24
    v_exp_f32 v117, v25
    v_exp_f32 v118, v26
    v_exp_f32 v119, v27
    v_cvt_pk_bf16_f32 v114, v116, v117
    v_cvt_pk_bf16_f32 v115, v118, v119
    v_mfma_f32_32x32x16_bf16 v[12:27], v[152:155], v[136:139], 0
    v_exp_f32 v116, v28
    v_exp_f32 v117, v29
    v_exp_f32 v118, v30
    v_exp_f32 v119, v31
    v_cvt_pk_bf16_f32 v108, v116, v117
    v_cvt_pk_bf16_f32 v109, v118, v119
    v_mfma_f32_32x32x16_bf16 v[44:59], v[164:167], v[112:115], v[44:59]
    v_exp_f32 v116, v32
    v_exp_f32 v117, v33
    v_exp_f32 v118, v34
    v_exp_f32 v119, v35
    v_cvt_pk_bf16_f32 v110, v116, v117
    v_cvt_pk_bf16_f32 v111, v118, v119
    v_mfma_f32_32x32x16_bf16 v[12:27], v[156:159], v[140:143], v[12:27]
    v_exp_f32 v116, v36
    v_exp_f32 v117, v37
    v_exp_f32 v118, v38
    v_exp_f32 v119, v39
    v_cvt_pk_bf16_f32 v112, v116, v117
    v_cvt_pk_bf16_f32 v113, v118, v119
    v_mfma_f32_32x32x16_bf16 v[60:75], v[160:163], v[108:111], v[60:75]
    v_exp_f32 v116, v40
    v_exp_f32 v117, v41
    v_exp_f32 v118, v42
    v_exp_f32 v119, v43
    v_cvt_pk_bf16_f32 v114, v116, v117
    v_cvt_pk_bf16_f32 v115, v118, v119
    v_mfma_f32_32x32x16_bf16 v[28:43], v[152:155], v[144:147], 0
    v_exp_f32 v116, v12
    v_exp_f32 v117, v13
    v_exp_f32 v118, v14
    v_exp_f32 v119, v15
    v_cvt_pk_bf16_f32 v108, v116, v117
    v_cvt_pk_bf16_f32 v109, v118, v119
    v_mfma_f32_32x32x16_bf16 v[60:75], v[164:167], v[112:115], v[60:75]
    v_exp_f32 v116, v16
    v_exp_f32 v117, v17
    v_exp_f32 v118, v18
    v_exp_f32 v119, v19
    v_cvt_pk_bf16_f32 v110, v116, v117
    v_cvt_pk_bf16_f32 v111, v118, v119
    v_mfma_f32_32x32x16_bf16 v[28:43], v[156:159], v[148:151], v[28:43]
    v_exp_f32 v116, v20
    v_exp_f32 v117, v21
    v_exp_f32 v118, v22
    v_exp_f32 v119, v23
    v_cvt_pk_bf16_f32 v112, v116, v117
    v_cvt_pk_bf16_f32 v113, v118, v119
    v_mfma_f32_32x32x16_bf16 v[76:91], v[160:163], v[108:111], v[76:91]
    v_exp_f32 v116, v24
    v_exp_f32 v117, v25
    v_exp_f32 v118, v26
    v_exp_f32 v119, v27
    v_cvt_pk_bf16_f32 v114, v116, v117
    v_cvt_pk_bf16_f32 v115, v118, v119
    s_waitcnt vmcnt(8)
    v_mfma_f32_32x32x16_bf16 v[12:27], v[168:171], v[120:123], 0
    v_exp_f32 v116, v28
    v_exp_f32 v117, v29
    v_exp_f32 v118, v30
    v_exp_f32 v119, v31
    v_cvt_pk_bf16_f32 v108, v116, v117
    v_cvt_pk_bf16_f32 v109, v118, v119
    v_mfma_f32_32x32x16_bf16 v[76:91], v[164:167], v[112:115], v[76:91]
    v_exp_f32 v116, v32
    v_exp_f32 v117, v33
    v_exp_f32 v118, v34
    v_exp_f32 v119, v35
    v_cvt_pk_bf16_f32 v110, v116, v117
    v_cvt_pk_bf16_f32 v111, v118, v119
    v_mfma_f32_32x32x16_bf16 v[12:27], v[172:175], v[124:127], v[12:27]
    v_exp_f32 v116, v36
    v_exp_f32 v117, v37
    v_exp_f32 v118, v38
    v_exp_f32 v119, v39
    v_cvt_pk_bf16_f32 v112, v116, v117
    v_cvt_pk_bf16_f32 v113, v118, v119
    v_mfma_f32_32x32x16_bf16 v[92:107], v[160:163], v[108:111], v[92:107]
    v_exp_f32 v116, v40
    v_exp_f32 v117, v41
    v_exp_f32 v118, v42
    v_exp_f32 v119, v43
    v_cvt_pk_bf16_f32 v114, v116, v117
    v_cvt_pk_bf16_f32 v115, v118, v119
    v_mfma_f32_32x32x16_bf16 v[28:43], v[168:171], v[128:131], 0
    v_exp_f32 v116, v12
    v_exp_f32 v117, v13
    v_exp_f32 v118, v14
    v_exp_f32 v119, v15
    v_cvt_pk_bf16_f32 v108, v116, v117
    v_cvt_pk_bf16_f32 v109, v118, v119
    v_mfma_f32_32x32x16_bf16 v[92:107], v[164:167], v[112:115], v[92:107]
    buffer_load_dwordx4 v[152:155], v2, s[8:11], s48 offen sc1
    buffer_load_dwordx4 v[156:159], v2, s[8:11], s48 offen offset:1024 sc1
    buffer_load_dwordx4 v[160:163], v2, s[12:15], s49 offen sc1
    buffer_load_dwordx4 v[164:167], v2, s[12:15], s49 offen offset:1024 sc1
    s_add_u32 s48, s48, 2048
    s_add_u32 s49, s49, 2048
    v_exp_f32 v116, v16
    v_exp_f32 v117, v17
    v_exp_f32 v118, v18
    v_exp_f32 v119, v19
    v_cvt_pk_bf16_f32 v110, v116, v117
    v_cvt_pk_bf16_f32 v111, v118, v119
    v_mfma_f32_32x32x16_bf16 v[28:43], v[172:175], v[132:135], v[28:43]
    v_exp_f32 v116, v20
    v_exp_f32 v117, v21
    v_exp_f32 v118, v22
    v_exp_f32 v119, v23
    v_cvt_pk_bf16_f32 v112, v116, v117
    v_cvt_pk_bf16_f32 v113, v118, v119
    v_mfma_f32_32x32x16_bf16 v[44:59], v[176:179], v[108:111], v[44:59]
    v_exp_f32 v116, v24
    v_exp_f32 v117, v25
    v_exp_f32 v118, v26
    v_exp_f32 v119, v27
    v_cvt_pk_bf16_f32 v114, v116, v117
    v_cvt_pk_bf16_f32 v115, v118, v119
    v_mfma_f32_32x32x16_bf16 v[12:27], v[168:171], v[136:139], 0
    v_exp_f32 v116, v28
    v_exp_f32 v117, v29
    v_exp_f32 v118, v30
    v_exp_f32 v119, v31
    v_cvt_pk_bf16_f32 v108, v116, v117
    v_cvt_pk_bf16_f32 v109, v118, v119
    v_mfma_f32_32x32x16_bf16 v[44:59], v[180:183], v[112:115], v[44:59]
    v_exp_f32 v116, v32
    v_exp_f32 v117, v33
    v_exp_f32 v118, v34
    v_exp_f32 v119, v35
    v_cvt_pk_bf16_f32 v110, v116, v117
    v_cvt_pk_bf16_f32 v111, v118, v119
    v_mfma_f32_32x32x16_bf16 v[12:27], v[172:175], v[140:143], v[12:27]
    v_exp_f32 v116, v36
    v_exp_f32 v117, v37
    v_exp_f32 v118, v38
    v_exp_f32 v119, v39
    v_cvt_pk_bf16_f32 v112, v116, v117
    v_cvt_pk_bf16_f32 v113, v118, v119
    v_mfma_f32_32x32x16_bf16 v[60:75], v[176:179], v[108:111], v[60:75]
    v_exp_f32 v116, v40
    v_exp_f32 v117, v41
    v_exp_f32 v118, v42
    v_exp_f32 v119, v43
    v_cvt_pk_bf16_f32 v114, v116, v117
    v_cvt_pk_bf16_f32 v115, v118, v119
    v_mfma_f32_32x32x16_bf16 v[28:43], v[168:171], v[144:147], 0
    v_exp_f32 v116, v12
    v_exp_f32 v117, v13
    v_exp_f32 v118, v14
    v_exp_f32 v119, v15
    v_cvt_pk_bf16_f32 v108, v116, v117
    v_cvt_pk_bf16_f32 v109, v118, v119
    v_mfma_f32_32x32x16_bf16 v[60:75], v[180:183], v[112:115], v[60:75]
    v_exp_f32 v116, v16
    v_exp_f32 v117, v17
    v_exp_f32 v118, v18
    v_exp_f32 v119, v19
    v_cvt_pk_bf16_f32 v110, v116, v117
    v_cvt_pk_bf16_f32 v111, v118, v119
    v_mfma_f32_32x32x16_bf16 v[28:43], v[172:175], v[148:151], v[28:43]
    v_exp_f32 v116, v20
    v_exp_f32 v117, v21
    v_exp_f32 v118, v22
    v_exp_f32 v119, v23
    v_cvt_pk_bf16_f32 v112, v116, v117
    v_cvt_pk_bf16_f32 v113, v118, v119
    v_mfma_f32_32x32x16_bf16 v[76:91], v[176:179], v[108:111], v[76:91]
    v_exp_f32 v116, v24
    v_exp_f32 v117, v25
    v_exp_f32 v118, v26
    v_exp_f32 v119, v27
    v_cvt_pk_bf16_f32 v114, v116, v117
    v_cvt_pk_bf16_f32 v115, v118, v119
    s_waitcnt vmcnt(8)
    v_mfma_f32_32x32x16_bf16 v[12:27], v[184:187], v[120:123], 0
    v_exp_f32 v116, v28
    v_exp_f32 v117, v29
    v_exp_f32 v118, v30
    v_exp_f32 v119, v31
    v_cvt_pk_bf16_f32 v108, v116, v117
    v_cvt_pk_bf16_f32 v109, v118, v119
    v_mfma_f32_32x32x16_bf16 v[76:91], v[180:183], v[112:115], v[76:91]
    v_exp_f32 v116, v32
    v_exp_f32 v117, v33
    v_exp_f32 v118, v34
    v_exp_f32 v119, v35
    v_cvt_pk_bf16_f32 v110, v116, v117
    v_cvt_pk_bf16_f32 v111, v118, v119
    v_mfma_f32_32x32x16_bf16 v[12:27], v[188:191], v[124:127], v[12:27]
    v_exp_f32 v116, v36
    v_exp_f32 v117, v37
    v_exp_f32 v118, v38
    v_exp_f32 v119, v39
    v_cvt_pk_bf16_f32 v112, v116, v117
    v_cvt_pk_bf16_f32 v113, v118, v119
    v_mfma_f32_32x32x16_bf16 v[92:107], v[176:179], v[108:111], v[92:107]
    v_exp_f32 v116, v40
    v_exp_f32 v117, v41
    v_exp_f32 v118, v42
    v_exp_f32 v119, v43
    v_cvt_pk_bf16_f32 v114, v116, v117
    v_cvt_pk_bf16_f32 v115, v118, v119
    v_mfma_f32_32x32x16_bf16 v[28:43], v[184:187], v[128:131], 0
    v_exp_f32 v116, v12
    v_exp_f32 v117, v13
    v_exp_f32 v118, v14
    v_exp_f32 v119, v15
    v_cvt_pk_bf16_f32 v108, v116, v117
    v_cvt_pk_bf16_f32 v109, v118, v119
    v_mfma_f32_32x32x16_bf16 v[92:107], v[180:183], v[112:115], v[92:107]
    buffer_load_dwordx4 v[168:171], v2, s[8:11], s48 offen sc1
    buffer_load_dwordx4 v[172:175], v2, s[8:11], s48 offen offset:1024 sc1
    buffer_load_dwordx4 v[176:179], v2, s[12:15], s49 offen sc1
    buffer_load_dwordx4 v[180:183], v2, s[12:15], s49 offen offset:1024 sc1
    s_add_u32 s48, s48, 2048
    s_add_u32 s49, s49, 2048
    v_exp_f32 v116, v16
    v_exp_f32 v117, v17
    v_exp_f32 v118, v18
    v_exp_f32 v119, v19
    v_cvt_pk_bf16_f32 v110, v116, v117
    v_cvt_pk_bf16_f32 v111, v118, v119
    v_mfma_f32_32x32x16_bf16 v[28:43], v[188:191], v[132:135], v[28:43]
    v_exp_f32 v116, v20
    v_exp_f32 v117, v21
    v_exp_f32 v118, v22
    v_exp_f32 v119, v23
    v_cvt_pk_bf16_f32 v112, v116, v117
    v_cvt_pk_bf16_f32 v113, v118, v119
    v_mfma_f32_32x32x16_bf16 v[44:59], v[192:195], v[108:111], v[44:59]
    v_exp_f32 v116, v24
    v_exp_f32 v117, v25
    v_exp_f32 v118, v26
    v_exp_f32 v119, v27
    v_cvt_pk_bf16_f32 v114, v116, v117
    v_cvt_pk_bf16_f32 v115, v118, v119
    v_mfma_f32_32x32x16_bf16 v[12:27], v[184:187], v[136:139], 0
    v_exp_f32 v116, v28
    v_exp_f32 v117, v29
    v_exp_f32 v118, v30
    v_exp_f32 v119, v31
    v_cvt_pk_bf16_f32 v108, v116, v117
    v_cvt_pk_bf16_f32 v109, v118, v119
    v_mfma_f32_32x32x16_bf16 v[44:59], v[196:199], v[112:115], v[44:59]
    v_exp_f32 v116, v32
    v_exp_f32 v117, v33
    v_exp_f32 v118, v34
    v_exp_f32 v119, v35
    v_cvt_pk_bf16_f32 v110, v116, v117
    v_cvt_pk_bf16_f32 v111, v118, v119
    v_mfma_f32_32x32x16_bf16 v[12:27], v[188:191], v[140:143], v[12:27]
    v_exp_f32 v116, v36
    v_exp_f32 v117, v37
    v_exp_f32 v118, v38
    v_exp_f32 v119, v39
    v_cvt_pk_bf16_f32 v112, v116, v117
    v_cvt_pk_bf16_f32 v113, v118, v119
    v_mfma_f32_32x32x16_bf16 v[60:75], v[192:195], v[108:111], v[60:75]
    v_exp_f32 v116, v40
    v_exp_f32 v117, v41
    v_exp_f32 v118, v42
    v_exp_f32 v119, v43
    v_cvt_pk_bf16_f32 v114, v116, v117
    v_cvt_pk_bf16_f32 v115, v118, v119
    v_mfma_f32_32x32x16_bf16 v[28:43], v[184:187], v[144:147], 0
    v_exp_f32 v116, v12
    v_exp_f32 v117, v13
    v_exp_f32 v118, v14
    v_exp_f32 v119, v15
    v_cvt_pk_bf16_f32 v108, v116, v117
    v_cvt_pk_bf16_f32 v109, v118, v119
    v_mfma_f32_32x32x16_bf16 v[60:75], v[196:199], v[112:115], v[60:75]
    v_exp_f32 v116, v16
    v_exp_f32 v117, v17
    v_exp_f32 v118, v18
    v_exp_f32 v119, v19
    v_cvt_pk_bf16_f32 v110, v116, v117
    v_cvt_pk_bf16_f32 v111, v118, v119
    v_mfma_f32_32x32x16_bf16 v[28:43], v[188:191], v[148:151], v[28:43]
    v_exp_f32 v116, v20
    v_exp_f32 v117, v21
    v_exp_f32 v118, v22
    v_exp_f32 v119, v23
    v_cvt_pk_bf16_f32 v112, v116, v117
    v_cvt_pk_bf16_f32 v113, v118, v119
    v_mfma_f32_32x32x16_bf16 v[76:91], v[192:195], v[108:111], v[76:91]
    v_exp_f32 v116, v24
    v_exp_f32 v117, v25
    v_exp_f32 v118, v26
    v_exp_f32 v119, v27
    v_cvt_pk_bf16_f32 v114, v116, v117
    v_cvt_pk_bf16_f32 v115, v118, v119
    s_waitcnt vmcnt(8)
    v_mfma_f32_32x32x16_bf16 v[12:27], v[200:203], v[120:123], 0
    v_exp_f32 v116, v28
    v_exp_f32 v117, v29
    v_exp_f32 v118, v30
    v_exp_f32 v119, v31
    v_cvt_pk_bf16_f32 v108, v116, v117
    v_cvt_pk_bf16_f32 v109, v118, v119
    v_mfma_f32_32x32x16_bf16 v[76:91], v[196:199], v[112:115], v[76:91]
    v_exp_f32 v116, v32
    v_exp_f32 v117, v33
    v_exp_f32 v118, v34
    v_exp_f32 v119, v35
    v_cvt_pk_bf16_f32 v110, v116, v117
    v_cvt_pk_bf16_f32 v111, v118, v119
    v_mfma_f32_32x32x16_bf16 v[12:27], v[204:207], v[124:127], v[12:27]
    v_exp_f32 v116, v36
    v_exp_f32 v117, v37
    v_exp_f32 v118, v38
    v_exp_f32 v119, v39
    v_cvt_pk_bf16_f32 v112, v116, v117
    v_cvt_pk_bf16_f32 v113, v118, v119
    v_mfma_f32_32x32x16_bf16 v[92:107], v[192:195], v[108:111], v[92:107]
    v_exp_f32 v116, v40
    v_exp_f32 v117, v41
    v_exp_f32 v118, v42
    v_exp_f32 v119, v43
    v_cvt_pk_bf16_f32 v114, v116, v117
    v_cvt_pk_bf16_f32 v115, v118, v119
    v_mfma_f32_32x32x16_bf16 v[28:43], v[200:203], v[128:131], 0
    v_exp_f32 v116, v12
    v_exp_f32 v117, v13
    v_exp_f32 v118, v14
    v_exp_f32 v119, v15
    v_cvt_pk_bf16_f32 v108, v116, v117
    v_cvt_pk_bf16_f32 v109, v118, v119
    v_mfma_f32_32x32x16_bf16 v[92:107], v[196:199], v[112:115], v[92:107]
    buffer_load_dwordx4 v[184:187], v2, s[8:11], s48 offen sc1
    buffer_load_dwordx4 v[188:191], v2, s[8:11], s48 offen offset:1024 sc1
    buffer_load_dwordx4 v[192:195], v2, s[12:15], s49 offen sc1
    buffer_load_dwordx4 v[196:199], v2, s[12:15], s49 offen offset:1024 sc1
    s_add_u32 s48, s48, 2048
    s_add_u32 s49, s49, 2048
    v_exp_f32 v116, v16
    v_exp_f32 v117, v17
    v_exp_f32 v118, v18
    v_exp_f32 v119, v19
    v_cvt_pk_bf16_f32 v110, v116, v117
    v_cvt_pk_bf16_f32 v111, v118, v119
    v_mfma_f32_32x32x16_bf16 v[28:43], v[204:207], v[132:135], v[28:43]
    v_exp_f32 v116, v20
    v_exp_f32 v117, v21
    v_exp_f32 v118, v22
    v_exp_f32 v119, v23
    v_cvt_pk_bf16_f32 v112, v116, v117
    v_cvt_pk_bf16_f32 v113, v118, v119
    v_mfma_f32_32x32x16_bf16 v[44:59], v[208:211], v[108:111], v[44:59]
    v_exp_f32 v116, v24
    v_exp_f32 v117, v25
    v_exp_f32 v118, v26
    v_exp_f32 v119, v27
    v_cvt_pk_bf16_f32 v114, v116, v117
    v_cvt_pk_bf16_f32 v115, v118, v119
    v_mfma_f32_32x32x16_bf16 v[12:27], v[200:203], v[136:139], 0
    v_exp_f32 v116, v28
    v_exp_f32 v117, v29
    v_exp_f32 v118, v30
    v_exp_f32 v119, v31
    v_cvt_pk_bf16_f32 v108, v116, v117
    v_cvt_pk_bf16_f32 v109, v118, v119
    v_mfma_f32_32x32x16_bf16 v[44:59], v[212:215], v[112:115], v[44:59]
    v_exp_f32 v116, v32
    v_exp_f32 v117, v33
    v_exp_f32 v118, v34
    v_exp_f32 v119, v35
    v_cvt_pk_bf16_f32 v110, v116, v117
    v_cvt_pk_bf16_f32 v111, v118, v119
    v_mfma_f32_32x32x16_bf16 v[12:27], v[204:207], v[140:143], v[12:27]
    v_exp_f32 v116, v36
    v_exp_f32 v117, v37
    v_exp_f32 v118, v38
    v_exp_f32 v119, v39
    v_cvt_pk_bf16_f32 v112, v116, v117
    v_cvt_pk_bf16_f32 v113, v118, v119
    v_mfma_f32_32x32x16_bf16 v[60:75], v[208:211], v[108:111], v[60:75]
    v_exp_f32 v116, v40
    v_exp_f32 v117, v41
    v_exp_f32 v118, v42
    v_exp_f32 v119, v43
    v_cvt_pk_bf16_f32 v114, v116, v117
    v_cvt_pk_bf16_f32 v115, v118, v119
    v_mfma_f32_32x32x16_bf16 v[28:43], v[200:203], v[144:147], 0
    v_exp_f32 v116, v12
    v_exp_f32 v117, v13
    v_exp_f32 v118, v14
    v_exp_f32 v119, v15
    v_cvt_pk_bf16_f32 v108, v116, v117
    v_cvt_pk_bf16_f32 v109, v118, v119
    v_mfma_f32_32x32x16_bf16 v[60:75], v[212:215], v[112:115], v[60:75]
    v_exp_f32 v116, v16
    v_exp_f32 v117, v17
    v_exp_f32 v118, v18
    v_exp_f32 v119, v19
    v_cvt_pk_bf16_f32 v110, v116, v117
    v_cvt_pk_bf16_f32 v111, v118, v119
    v_mfma_f32_32x32x16_bf16 v[28:43], v[204:207], v[148:151], v[28:43]
    v_exp_f32 v116, v20
    v_exp_f32 v117, v21
    v_exp_f32 v118, v22
    v_exp_f32 v119, v23
    v_cvt_pk_bf16_f32 v112, v116, v117
    v_cvt_pk_bf16_f32 v113, v118, v119
    v_mfma_f32_32x32x16_bf16 v[76:91], v[208:211], v[108:111], v[76:91]
    v_exp_f32 v116, v24
    v_exp_f32 v117, v25
    v_exp_f32 v118, v26
    v_exp_f32 v119, v27
    v_cvt_pk_bf16_f32 v114, v116, v117
    v_cvt_pk_bf16_f32 v115, v118, v119
    s_waitcnt vmcnt(8)
    v_mfma_f32_32x32x16_bf16 v[12:27], v[152:155], v[120:123], 0
    v_exp_f32 v116, v28
    v_exp_f32 v117, v29
    v_exp_f32 v118, v30
    v_exp_f32 v119, v31
    v_cvt_pk_bf16_f32 v108, v116, v117
    v_cvt_pk_bf16_f32 v109, v118, v119
    v_mfma_f32_32x32x16_bf16 v[76:91], v[212:215], v[112:115], v[76:91]
    v_exp_f32 v116, v32
    v_exp_f32 v117, v33
    v_exp_f32 v118, v34
    v_exp_f32 v119, v35
    v_cvt_pk_bf16_f32 v110, v116, v117
    v_cvt_pk_bf16_f32 v111, v118, v119
    v_mfma_f32_32x32x16_bf16 v[12:27], v[156:159], v[124:127], v[12:27]
    v_exp_f32 v116, v36
    v_exp_f32 v117, v37
    v_exp_f32 v118, v38
    v_exp_f32 v119, v39
    v_cvt_pk_bf16_f32 v112, v116, v117
    v_cvt_pk_bf16_f32 v113, v118, v119
    v_mfma_f32_32x32x16_bf16 v[92:107], v[208:211], v[108:111], v[92:107]
    v_exp_f32 v116, v40
    v_exp_f32 v117, v41
    v_exp_f32 v118, v42
    v_exp_f32 v119, v43
    v_cvt_pk_bf16_f32 v114, v116, v117
    v_cvt_pk_bf16_f32 v115, v118, v119
    s_sub_u32 s51, s51, 1
    s_cmp_lg_u32 s51, 0
    s_cbranch_scc1 parallel_sum__softmax_full_mha__swiglu_ffn__prompt_kernel_aloop
    s_nop 1
    v_mfma_f32_32x32x16_bf16 v[92:107], v[212:215], v[112:115], v[92:107]
    s_waitcnt vmcnt(0)
    s_nop 11
    v_add_f32 v4, v56, v72
    v_add_f32 v4, v4, v88
    v_add_f32 v4, v4, v104
    s_mov_b32 s24, 0x5d800000
    v_cmp_ngt_f32 vcc, s24, v4
    s_nop 3
    s_and_b64 s[32:33], vcc, s[30:31]
    v_min3_f32 v3, v56, v72, v88
    v_min_f32 v3, v3, v104
    s_mov_b32 s24, 0x8800000
    v_cmp_gt_f32 vcc, s24, v3
    s_nop 3
    s_and_b64 vcc, vcc, s[30:31]
    s_cmp_eq_u32 s3, 0
    s_cselect_b64 vcc, vcc, 0
    s_or_b64 s[32:33], s[32:33], vcc
    s_cmp_lg_u64 s[32:33], 0
    s_cselect_b32 s24, 1, 0
    s_cmp_eq_u32 s29, 1
    s_cselect_b32 s24, 0, s24
    s_lshl_b32 s25, s3, 14
    v_add_u32 v3, s25, v2
    ds_write_b128 v3, v[44:47] offset:0
    ds_write_b128 v3, v[48:51] offset:1024
    ds_write_b128 v3, v[52:55] offset:2048
    ds_write_b128 v3, v[56:59] offset:3072
    ds_write_b128 v3, v[60:63] offset:4096
    ds_write_b128 v3, v[64:67] offset:5120
    ds_write_b128 v3, v[68:71] offset:6144
    ds_write_b128 v3, v[72:75] offset:7168
    ds_write_b128 v3, v[76:79] offset:8192
    ds_write_b128 v3, v[80:83] offset:9216
    ds_write_b128 v3, v[84:87] offset:10240
    ds_write_b128 v3, v[88:91] offset:11264
    ds_write_b128 v3, v[92:95] offset:12288
    ds_write_b128 v3, v[96:99] offset:13312
    ds_write_b128 v3, v[100:103] offset:14336
    ds_write_b128 v3, v[104:107] offset:15360
    s_lshl_b32 s25, s3, 2
    s_add_u32 s25, s25, 65536
    v_mov_b32 v3, s25
    v_mov_b32 v4, s24
    ds_write_b32 v3, v4
    s_waitcnt lgkmcnt(0)
    s_cmp_eq_u32 s29, 1
    s_cbranch_scc1 parallel_sum__softmax_full_mha__swiglu_ffn__prompt_kernel_r1x_39
    s_waitcnt lgkmcnt(0)
    v_mov_b32 v5, 155684
    v_mov_b32 v6, 1
    s_mov_b64 exec, 1
    ds_add_u32 v5, v6
    s_mov_b64 exec, -1
    s_mov_b32 s25, 4194304
parallel_sum__softmax_full_mha__swiglu_ffn__prompt_kernel_fbs_41:
    ds_read_b32 v6, v5
    s_waitcnt lgkmcnt(0)
    v_readfirstlane_b32 s24, v6
    s_sub_u32 s25, s25, 1
    s_cmp_eq_u32 s25, 0
    s_cbranch_scc1 parallel_sum__softmax_full_mha__swiglu_ffn__prompt_kernel_fbsx_42
    s_cmp_lt_u32 s24, 4
    s_cbranch_scc1 parallel_sum__softmax_full_mha__swiglu_ffn__prompt_kernel_fbs_41
parallel_sum__softmax_full_mha__swiglu_ffn__prompt_kernel_fbsx_42:
    s_branch parallel_sum__softmax_full_mha__swiglu_ffn__prompt_kernel_r1y_40
parallel_sum__softmax_full_mha__swiglu_ffn__prompt_kernel_r1x_39:
    s_waitcnt lgkmcnt(0)
    v_mov_b32 v5, 155680
    v_mov_b32 v6, 1
    s_mov_b64 exec, 1
    ds_add_u32 v5, v6
    s_mov_b64 exec, -1
    s_mov_b32 s25, 4194304
parallel_sum__softmax_full_mha__swiglu_ffn__prompt_kernel_fbs_43:
    ds_read_b32 v6, v5
    s_waitcnt lgkmcnt(0)
    v_readfirstlane_b32 s24, v6
    s_sub_u32 s25, s25, 1
    s_cmp_eq_u32 s25, 0
    s_cbranch_scc1 parallel_sum__softmax_full_mha__swiglu_ffn__prompt_kernel_fbsx_44
    s_cmp_lt_u32 s24, 4
    s_cbranch_scc1 parallel_sum__softmax_full_mha__swiglu_ffn__prompt_kernel_fbs_43
parallel_sum__softmax_full_mha__swiglu_ffn__prompt_kernel_fbsx_44:
parallel_sum__softmax_full_mha__swiglu_ffn__prompt_kernel_r1y_40:
    v_mov_b32 v3, 0x10000
    ds_read_b128 v[116:119], v3
    s_lshl_b32 s25, s3, 12
    v_add_u32 v4, s25, v2
    ds_read_b128 v[44:47], v4 offset:0
    ds_read_b128 v[48:51], v4 offset:1024
    ds_read_b128 v[52:55], v4 offset:2048
    ds_read_b128 v[56:59], v4 offset:3072
    ds_read_b128 v[60:63], v4 offset:16384
    ds_read_b128 v[64:67], v4 offset:17408
    ds_read_b128 v[68:71], v4 offset:18432
    ds_read_b128 v[72:75], v4 offset:19456
    ds_read_b128 v[76:79], v4 offset:32768
    ds_read_b128 v[80:83], v4 offset:33792
    ds_read_b128 v[84:87], v4 offset:34816
    ds_read_b128 v[88:91], v4 offset:35840
    ds_read_b128 v[92:95], v4 offset:49152
    ds_read_b128 v[96:99], v4 offset:50176
    ds_read_b128 v[100:103], v4 offset:51200
    ds_read_b128 v[104:107], v4 offset:52224
    s_waitcnt lgkmcnt(0)
    v_or_b32 v116, v116, v117
    v_or_b32 v118, v118, v119
    v_or_b32 v116, v116, v118
    s_nop 1
    v_readfirstlane_b32 s24, v116
    s_nop 3
    s_cmp_lg_u32 s24, 0
    s_cbranch_scc1 parallel_sum__softmax_full_mha__swiglu_ffn__prompt_kernel_fallback
    v_add_f32 v44, v44, v60
    v_add_f32 v76, v76, v92
    v_add_f32 v45, v45, v61
    v_add_f32 v77, v77, v93
    v_add_f32 v46, v46, v62
    v_add_f32 v78, v78, v94
    v_add_f32 v47, v47, v63
    v_add_f32 v79, v79, v95
    v_add_f32 v48, v48, v64
    v_add_f32 v80, v80, v96
    v_add_f32 v49, v49, v65
    v_add_f32 v81, v81, v97
    v_add_f32 v50, v50, v66
    v_add_f32 v82, v82, v98
    v_add_f32 v51, v51, v67
    v_add_f32 v83, v83, v99
    v_add_f32 v52, v52, v68
    v_add_f32 v84, v84, v100
    v_add_f32 v53, v53, v69
    v_add_f32 v85, v85, v101
    v_add_f32 v54, v54, v70
    v_add_f32 v86, v86, v102
    v_add_f32 v55, v55, v71
    v_add_f32 v87, v87, v103
    v_add_f32 v56, v56, v72
    v_add_f32 v88, v88, v104
    v_add_f32 v57, v57, v73
    v_add_f32 v89, v89, v105
    v_add_f32 v58, v58, v74
    v_add_f32 v90, v90, v106
    v_add_f32 v59, v59, v75
    v_add_f32 v91, v91, v107
    v_add_f32 v44, v44, v76
    v_add_f32 v45, v45, v77
    v_add_f32 v46, v46, v78
    v_add_f32 v47, v47, v79
    v_add_f32 v48, v48, v80
    v_add_f32 v49, v49, v81
    v_add_f32 v50, v50, v82
    v_add_f32 v51, v51, v83
    v_add_f32 v52, v52, v84
    v_add_f32 v53, v53, v85
    v_add_f32 v54, v54, v86
    v_add_f32 v55, v55, v87
    v_add_f32 v56, v56, v88
    v_add_f32 v57, v57, v89
    v_add_f32 v58, v58, v90
    v_add_f32 v59, v59, v91
    v_mov_b32 v3, v56
    v_mov_b32 v4, v56
    s_nop 1
    v_permlane32_swap_b32 v3, v4
    s_nop 1
    v_rcp_f32 v4, v4
    s_nop 0
    v_mul_f32 v44, v44, v4
    v_mul_f32 v45, v45, v4
    v_mul_f32 v46, v46, v4
    v_mul_f32 v47, v47, v4
    v_mul_f32 v48, v48, v4
    v_mul_f32 v49, v49, v4
    v_mul_f32 v50, v50, v4
    v_mul_f32 v51, v51, v4
    v_mul_f32 v52, v52, v4
    v_mul_f32 v53, v53, v4
    v_mul_f32 v54, v54, v4
    v_mul_f32 v55, v55, v4
    v_mul_f32 v56, v56, v4
    v_mul_f32 v57, v57, v4
    v_mul_f32 v58, v58, v4
    v_mul_f32 v59, v59, v4
    v_cvt_pk_bf16_f32 v108, v44, v45
    v_cvt_pk_bf16_f32 v109, v46, v47
    v_cvt_pk_bf16_f32 v110, v48, v49
    v_cvt_pk_bf16_f32 v111, v50, v51
    v_cvt_pk_bf16_f32 v112, v52, v53
    v_cvt_pk_bf16_f32 v113, v54, v55
    v_cvt_pk_bf16_f32 v114, v56, v57
    v_cvt_pk_bf16_f32 v115, v58, v59
    s_mov_b64 exec, s[30:31]
    v_mov_b32 v114, 0
    v_mov_b32 v115, 0
    s_mov_b64 exec, -1
    s_lshl_b32 s24, s17, 2
    s_add_u32 s24, s24, s3
    s_mul_i32 s24, s24, 144
    s_lshl_b32 s25, s16, 1
    s_add_u32 s24, s24, s25
    s_add_u32 s24, s24, 112
    s_lshl_b32 s24, s24, 10
    s_add_u32 s24, s24, 6291456
    buffer_store_dwordx4 v[108:111], v2, s[4:7], s24 offen sc0 sc1
    buffer_store_dwordx4 v[112:115], v2, s[4:7], s24 offen offset:1024 sc0 sc1
    s_waitcnt vmcnt(0)
    s_lshl_b32 s35, s2, 2
    s_add_u32 s35, s35, s3
    s_lshl_b32 s35, s35, 6
    s_add_u32 s35, s35, 25231360
    s_add_u32 s36, s74, 1
    v_mov_b32 v3, s36
    v_mov_b32 v4, 0
    s_mov_b64 exec, 1
    buffer_store_dword v3, v4, s[4:7], s35 offen sc0 sc1
    s_mov_b64 exec, -1
    s_endpgm
parallel_sum__softmax_full_mha__swiglu_ffn__prompt_kernel_fallback:
    s_mov_b32 s29, 1
    s_waitcnt lgkmcnt(0)
    v_mov_b32 v3, 155668
    v_mov_b32 v4, 1
    s_mov_b64 exec, 1
    ds_add_u32 v3, v4
    s_mov_b64 exec, -1
    s_mov_b32 s25, 4194304
parallel_sum__softmax_full_mha__swiglu_ffn__prompt_kernel_fbs_45:
    ds_read_b32 v4, v3
    s_waitcnt lgkmcnt(0)
    v_readfirstlane_b32 s24, v4
    s_sub_u32 s25, s25, 1
    s_cmp_eq_u32 s25, 0
    s_cbranch_scc1 parallel_sum__softmax_full_mha__swiglu_ffn__prompt_kernel_fbsx_46
    s_cmp_lt_u32 s24, 4
    s_cbranch_scc1 parallel_sum__softmax_full_mha__swiglu_ffn__prompt_kernel_fbs_45
parallel_sum__softmax_full_mha__swiglu_ffn__prompt_kernel_fbsx_46:
    s_mov_b64 exec, s[30:31]
    v_mov_b32 v126, 0
    v_mov_b32 v127, 0
    v_mov_b32 v134, 0
    v_mov_b32 v135, 0
    v_mov_b32 v142, 0
    v_mov_b32 v143, 0
    v_mov_b32 v150, 0
    v_mov_b32 v151, 0
    s_mov_b64 exec, -1
    v_mov_b32 v216, 0xff800000
    v_mov_b32 v217, 0xff800000
    v_mov_b32 v218, 0xff800000
    v_mov_b32 v219, 0xff800000
    s_mov_b32 s48, s27
    s_mov_b32 s51, 16
parallel_sum__softmax_full_mha__swiglu_ffn__prompt_kernel_fbloop:
    buffer_load_dwordx4 v[152:155], v2, s[8:11], s48 offen sc1
    buffer_load_dwordx4 v[156:159], v2, s[8:11], s48 offen offset:1024 sc1
    s_add_u32 s48, s48, 2048
    s_waitcnt vmcnt(0)
    v_mfma_f32_32x32x16_bf16 v[12:27], v[152:155], v[120:123], 0
    v_mfma_f32_32x32x16_bf16 v[12:27], v[156:159], v[124:127], v[12:27]
    s_nop 11
    v_max3_f32 v9, v12, v13, v14
    v_max3_f32 v9, v9, v15, v16
    v_max3_f32 v9, v9, v17, v18
    v_max3_f32 v9, v9, v19, v20
    v_max3_f32 v9, v9, v21, v22
    v_max3_f32 v9, v9, v23, v24
    v_max3_f32 v9, v9, v25, v26
    v_max_f32 v9, v9, v27
    v_max_f32 v216, v216, v9
    s_nop 7
    v_mfma_f32_32x32x16_bf16 v[12:27], v[152:155], v[128:131], 0
    v_mfma_f32_32x32x16_bf16 v[12:27], v[156:159], v[132:135], v[12:27]
    s_nop 11
    v_max3_f32 v9, v12, v13, v14
    v_max3_f32 v9, v9, v15, v16
    v_max3_f32 v9, v9, v17, v18
    v_max3_f32 v9, v9, v19, v20
    v_max3_f32 v9, v9, v21, v22
    v_max3_f32 v9, v9, v23, v24
    v_max3_f32 v9, v9, v25, v26
    v_max_f32 v9, v9, v27
    v_max_f32 v217, v217, v9
    s_nop 7
    v_mfma_f32_32x32x16_bf16 v[12:27], v[152:155], v[136:139], 0
    v_mfma_f32_32x32x16_bf16 v[12:27], v[156:159], v[140:143], v[12:27]
    s_nop 11
    v_max3_f32 v9, v12, v13, v14
    v_max3_f32 v9, v9, v15, v16
    v_max3_f32 v9, v9, v17, v18
    v_max3_f32 v9, v9, v19, v20
    v_max3_f32 v9, v9, v21, v22
    v_max3_f32 v9, v9, v23, v24
    v_max3_f32 v9, v9, v25, v26
    v_max_f32 v9, v9, v27
    v_max_f32 v218, v218, v9
    s_nop 7
    v_mfma_f32_32x32x16_bf16 v[12:27], v[152:155], v[144:147], 0
    v_mfma_f32_32x32x16_bf16 v[12:27], v[156:159], v[148:151], v[12:27]
    s_nop 11
    v_max3_f32 v9, v12, v13, v14
    v_max3_f32 v9, v9, v15, v16
    v_max3_f32 v9, v9, v17, v18
    v_max3_f32 v9, v9, v19, v20
    v_max3_f32 v9, v9, v21, v22
    v_max3_f32 v9, v9, v23, v24
    v_max3_f32 v9, v9, v25, v26
    v_max_f32 v9, v9, v27
    v_max_f32 v219, v219, v9
    s_nop 7
    s_sub_u32 s51, s51, 1
    s_cmp_lg_u32 s51, 0
    s_cbranch_scc1 parallel_sum__softmax_full_mha__swiglu_ffn__prompt_kernel_fbloop
    v_mov_b32 v7, v216
    s_nop 1
    v_permlane32_swap_b32 v216, v7
    s_nop 1
    v_max_f32 v216, v216, v7
    v_mov_b32 v7, v217
    s_nop 1
    v_permlane32_swap_b32 v217, v7
    s_nop 1
    v_max_f32 v217, v217, v7
    v_mov_b32 v7, v218
    s_nop 1
    v_permlane32_swap_b32 v218, v7
    s_nop 1
    v_max_f32 v218, v218, v7
    v_mov_b32 v7, v219
    s_nop 1
    v_permlane32_swap_b32 v219, v7
    s_nop 1
    v_max_f32 v219, v219, v7
    s_lshl_b32 s25, s3, 10
    v_lshrrev_b32 v3, 2, v2
    v_add_u32 v4, s25, v3
    ds_write_b32 v4, v216 offset:0
    ds_write_b32 v4, v217 offset:256
    ds_write_b32 v4, v218 offset:512
    ds_write_b32 v4, v219 offset:768
    s_waitcnt lgkmcnt(0)
    s_waitcnt lgkmcnt(0)
    v_mov_b32 v5, 155672
    v_mov_b32 v6, 1
    s_mov_b64 exec, 1
    ds_add_u32 v5, v6
    s_mov_b64 exec, -1
    s_mov_b32 s25, 4194304
parallel_sum__softmax_full_mha__swiglu_ffn__prompt_kernel_fbs_47:
    ds_read_b32 v6, v5
    s_waitcnt lgkmcnt(0)
    v_readfirstlane_b32 s24, v6
    s_sub_u32 s25, s25, 1
    s_cmp_eq_u32 s25, 0
    s_cbranch_scc1 parallel_sum__softmax_full_mha__swiglu_ffn__prompt_kernel_fbsx_48
    s_cmp_lt_u32 s24, 4
    s_cbranch_scc1 parallel_sum__softmax_full_mha__swiglu_ffn__prompt_kernel_fbs_47
parallel_sum__softmax_full_mha__swiglu_ffn__prompt_kernel_fbsx_48:
    v_lshrrev_b32 v3, 2, v2
    ds_read_b32 v116, v3 offset:0
    ds_read_b32 v117, v3 offset:1024
    ds_read_b32 v118, v3 offset:2048
    ds_read_b32 v119, v3 offset:3072
    s_waitcnt lgkmcnt(0)
    v_max3_f32 v216, v116, v117, v118
    v_max_f32 v216, v216, v119
    ds_read_b32 v116, v3 offset:256
    ds_read_b32 v117, v3 offset:1280
    ds_read_b32 v118, v3 offset:2304
    ds_read_b32 v119, v3 offset:3328
    s_waitcnt lgkmcnt(0)
    v_max3_f32 v217, v116, v117, v118
    v_max_f32 v217, v217, v119
    ds_read_b32 v116, v3 offset:512
    ds_read_b32 v117, v3 offset:1536
    ds_read_b32 v118, v3 offset:2560
    ds_read_b32 v119, v3 offset:3584
    s_waitcnt lgkmcnt(0)
    v_max3_f32 v218, v116, v117, v118
    v_max_f32 v218, v218, v119
    ds_read_b32 v116, v3 offset:768
    ds_read_b32 v117, v3 offset:1792
    ds_read_b32 v118, v3 offset:2816
    ds_read_b32 v119, v3 offset:3840
    s_waitcnt lgkmcnt(0)
    v_max3_f32 v219, v116, v117, v118
    v_max_f32 v219, v219, v119
    s_waitcnt lgkmcnt(0)
    v_mov_b32 v5, 155676
    v_mov_b32 v6, 1
    s_mov_b64 exec, 1
    ds_add_u32 v5, v6
    s_mov_b64 exec, -1
    s_mov_b32 s25, 4194304
parallel_sum__softmax_full_mha__swiglu_ffn__prompt_kernel_fbs_49:
    ds_read_b32 v6, v5
    s_waitcnt lgkmcnt(0)
    v_readfirstlane_b32 s24, v6
    s_sub_u32 s25, s25, 1
    s_cmp_eq_u32 s25, 0
    s_cbranch_scc1 parallel_sum__softmax_full_mha__swiglu_ffn__prompt_kernel_fbsx_50
    s_cmp_lt_u32 s24, 4
    s_cbranch_scc1 parallel_sum__softmax_full_mha__swiglu_ffn__prompt_kernel_fbs_49
parallel_sum__softmax_full_mha__swiglu_ffn__prompt_kernel_fbsx_50:
    v_sub_f32 v3, 0, v216
    v_cvt_pk_bf16_f32 v4, v3, v3
    v_and_b32 v5, 0xffff0000, v4
    v_sub_f32 v3, v3, v5
    v_cvt_pk_bf16_f32 v5, v3, v3
    v_and_b32 v6, 0xffff0000, v5
    v_sub_f32 v3, v3, v6
    v_cvt_pk_bf16_f32 v3, v3, 0
    v_and_b32 v4, 0xffff, v4
    v_or_b32 v4, v4, v6
    s_mov_b64 exec, s[30:31]
    v_mov_b32 v126, v4
    v_mov_b32 v127, v3
    s_mov_b64 exec, -1
    v_sub_f32 v3, 0, v217
    v_cvt_pk_bf16_f32 v4, v3, v3
    v_and_b32 v5, 0xffff0000, v4
    v_sub_f32 v3, v3, v5
    v_cvt_pk_bf16_f32 v5, v3, v3
    v_and_b32 v6, 0xffff0000, v5
    v_sub_f32 v3, v3, v6
    v_cvt_pk_bf16_f32 v3, v3, 0
    v_and_b32 v4, 0xffff, v4
    v_or_b32 v4, v4, v6
    s_mov_b64 exec, s[30:31]
    v_mov_b32 v134, v4
    v_mov_b32 v135, v3
    s_mov_b64 exec, -1
    v_sub_f32 v3, 0, v218
    v_cvt_pk_bf16_f32 v4, v3, v3
    v_and_b32 v5, 0xffff0000, v4
    v_sub_f32 v3, v3, v5
    v_cvt_pk_bf16_f32 v5, v3, v3
    v_and_b32 v6, 0xffff0000, v5
    v_sub_f32 v3, v3, v6
    v_cvt_pk_bf16_f32 v3, v3, 0
    v_and_b32 v4, 0xffff, v4
    v_or_b32 v4, v4, v6
    s_mov_b64 exec, s[30:31]
    v_mov_b32 v142, v4
    v_mov_b32 v143, v3
    s_mov_b64 exec, -1
    v_sub_f32 v3, 0, v219
    v_cvt_pk_bf16_f32 v4, v3, v3
    v_and_b32 v5, 0xffff0000, v4
    v_sub_f32 v3, v3, v5
    v_cvt_pk_bf16_f32 v5, v3, v3
    v_and_b32 v6, 0xffff0000, v5
    v_sub_f32 v3, v3, v6
    v_cvt_pk_bf16_f32 v3, v3, 0
    v_and_b32 v4, 0xffff, v4
    v_or_b32 v4, v4, v6
    s_mov_b64 exec, s[30:31]
    v_mov_b32 v150, v4
    v_mov_b32 v151, v3
    s_mov_b64 exec, -1
    s_branch parallel_sum__softmax_full_mha__swiglu_ffn__prompt_kernel_amain
parallel_sum__softmax_full_mha__swiglu_ffn__prompt_kernel_phaseB_gemm:
    s_cmp_ge_u32 s2, 224
    s_cbranch_scc1 parallel_sum__softmax_full_mha__swiglu_ffn__prompt_kernel_gskip
    s_lshr_b32 s33, s24, 1
    v_mov_b32 v7, s33
    v_and_b32 v8, 1, v1
    v_lshlrev_b32 v8, 1, v8
    s_lshl_b32 s33, s39, 2
    v_add_u32 v8, s33, v8
    v_lshrrev_b32 v11, 3, v7
    v_lshrrev_b32 v12, 2, v8
    v_lshl_add_u32 v11, v12, 1, v11
    v_and_b32 v12, 7, v7
    v_lshl_add_u32 v11, v12, 3, v11
    v_and_b32 v12, 1, v8
    v_lshl_add_u32 v11, v12, 7, v11
    v_bfe_u32 v12, v8, 1, 1
    v_lshl_add_u32 v11, v12, 6, v11
    v_lshlrev_b32 v11, 6, v11
    v_add_u32 v185, 25165824, v11
    v_add_u32 v8, 1, v8
    v_lshrrev_b32 v11, 3, v7
    v_lshrrev_b32 v12, 2, v8
    v_lshl_add_u32 v11, v12, 1, v11
    v_and_b32 v12, 7, v7
    v_lshl_add_u32 v11, v12, 3, v11
    v_and_b32 v12, 1, v8
    v_lshl_add_u32 v11, v12, 7, v11
    v_bfe_u32 v12, v8, 1, 1
    v_lshl_add_u32 v11, v12, 6, v11
    v_lshlrev_b32 v11, 6, v11
    v_add_u32 v184, 25165824, v11
    s_add_u32 s37, s74, 0
    s_mov_b32 s36, 524288
    s_mov_b32 s68, 0xffffffff
    s_mov_b32 s69, 0xffffffff
parallel_sum__softmax_full_mha__swiglu_ffn__prompt_kernel_poll_51:
    buffer_load_dword v7, v184, s[4:7], 0 offen sc0 sc1
    s_waitcnt vmcnt(0)
    v_cmp_ne_u32 vcc, s37, v7
    s_nop 3
    s_and_b64 vcc, vcc, s[68:69]
    s_sub_u32 s36, s36, 1
    s_cmp_eq_u32 s36, 0
    s_cbranch_scc1 parallel_sum__softmax_full_mha__swiglu_ffn__prompt_kernel_pollx_52
    s_cmp_lg_u64 vcc, 0
    s_cbranch_scc0 parallel_sum__softmax_full_mha__swiglu_ffn__prompt_kernel_pollx_52
    s_sleep 1
    s_branch parallel_sum__softmax_full_mha__swiglu_ffn__prompt_kernel_poll_51
parallel_sum__softmax_full_mha__swiglu_ffn__prompt_kernel_pollx_52:
    s_add_u32 s33, s31, 147456
    buffer_load_dwordx4 v[116:119], v2, s[4:7], s31 offen offset:0 sc1
    buffer_load_dwordx4 v[120:123], v2, s[4:7], s31 offen offset:1024 sc1
    buffer_load_dwordx4 v[124:127], v2, s[4:7], s33 offen offset:0 sc1
    buffer_load_dwordx4 v[128:131], v2, s[4:7], s33 offen offset:1024 sc1
    s_add_u32 s31, s31, 2048
    s_add_u32 s33, s31, 147456
    buffer_load_dwordx4 v[132:135], v2, s[4:7], s31 offen offset:0 sc1
    buffer_load_dwordx4 v[136:139], v2, s[4:7], s31 offen offset:1024 sc1
    buffer_load_dwordx4 v[140:143], v2, s[4:7], s33 offen offset:0 sc1
    buffer_load_dwordx4 v[144:147], v2, s[4:7], s33 offen offset:1024 sc1
    s_add_u32 s31, s31, 2048
    s_add_u32 s33, s31, 147456
    buffer_load_dwordx4 v[148:151], v2, s[4:7], s31 offen offset:0 sc1
    buffer_load_dwordx4 v[152:155], v2, s[4:7], s31 offen offset:1024 sc1
    buffer_load_dwordx4 v[156:159], v2, s[4:7], s33 offen offset:0 sc1
    buffer_load_dwordx4 v[160:163], v2, s[4:7], s33 offen offset:1024 sc1
    s_add_u32 s31, s31, 2048
    s_waitcnt vmcnt(8)
    ds_read_b64_tr_b16 v[84:85], v4 offset:0
    ds_read_b64_tr_b16 v[86:87], v4 offset:1024
    ds_read_b64_tr_b16 v[88:89], v4 offset:2048
    ds_read_b64_tr_b16 v[90:91], v4 offset:3072
    ds_read_b64_tr_b16 v[92:93], v5 offset:0
    ds_read_b64_tr_b16 v[94:95], v5 offset:1024
    ds_read_b64_tr_b16 v[96:97], v5 offset:2048
    ds_read_b64_tr_b16 v[98:99], v5 offset:3072
    s_waitcnt vmcnt(4)
    ds_read_b64_tr_b16 v[100:101], v4 offset:4096
    ds_read_b64_tr_b16 v[102:103], v4 offset:5120
    ds_read_b64_tr_b16 v[104:105], v4 offset:6144
    ds_read_b64_tr_b16 v[106:107], v4 offset:7168
    ds_read_b64_tr_b16 v[108:109], v5 offset:4096
    ds_read_b64_tr_b16 v[110:111], v5 offset:5120
    ds_read_b64_tr_b16 v[112:113], v5 offset:6144
    ds_read_b64_tr_b16 v[114:115], v5 offset:7168
    s_add_u32 m0, s38, 12288
    s_nop 0
    buffer_load_dwordx4 v3, s[8:11], s32 offen lds
    s_add_u32 m0, s38, 13312
    s_add_u32 s32, s32, 7168
    buffer_load_dwordx4 v3, s[8:11], s32 offen lds
    s_add_u32 m0, s38, 14336
    s_add_u32 s32, s32, 7168
    buffer_load_dwordx4 v3, s[8:11], s32 offen lds
    s_add_u32 m0, s38, 15360
    s_add_u32 s32, s32, 7168
    buffer_load_dwordx4 v3, s[8:11], s32 offen lds
    s_add_u32 s32, s32, 7168
    s_add_u32 s33, s31, 147456
    buffer_load_dwordx4 v[164:167], v2, s[4:7], s31 offen offset:0 sc1
    buffer_load_dwordx4 v[168:171], v2, s[4:7], s31 offen offset:1024 sc1
    buffer_load_dwordx4 v[172:175], v2, s[4:7], s33 offen offset:0 sc1
    buffer_load_dwordx4 v[176:179], v2, s[4:7], s33 offen offset:1024 sc1
    s_add_u32 s31, s31, 2048
    s_waitcnt lgkmcnt(8)
    v_mfma_f32_32x32x16_bf16 v[20:35], v[84:87], v[116:119], 0
    v_mfma_f32_32x32x16_bf16 v[36:51], v[84:87], v[124:127], 0
    v_mfma_f32_32x32x16_bf16 v[52:67], v[92:95], v[116:119], 0
    v_mfma_f32_32x32x16_bf16 v[68:83], v[92:95], v[124:127], 0
    v_mfma_f32_32x32x16_bf16 v[20:35], v[88:91], v[120:123], v[20:35]
    v_mfma_f32_32x32x16_bf16 v[36:51], v[88:91], v[128:131], v[36:51]
    v_mfma_f32_32x32x16_bf16 v[52:67], v[96:99], v[120:123], v[52:67]
    v_mfma_f32_32x32x16_bf16 v[68:83], v[96:99], v[128:131], v[68:83]
    s_waitcnt vmcnt(8)
    ds_read_b64_tr_b16 v[84:85], v4 offset:8192
    ds_read_b64_tr_b16 v[86:87], v4 offset:9216
    ds_read_b64_tr_b16 v[88:89], v4 offset:10240
    ds_read_b64_tr_b16 v[90:91], v4 offset:11264
    ds_read_b64_tr_b16 v[92:93], v5 offset:8192
    ds_read_b64_tr_b16 v[94:95], v5 offset:9216
    ds_read_b64_tr_b16 v[96:97], v5 offset:10240
    ds_read_b64_tr_b16 v[98:99], v5 offset:11264
    s_add_u32 m0, s38, 0
    s_nop 0
    buffer_load_dwordx4 v3, s[8:11], s32 offen lds
    s_add_u32 m0, s38, 1024
    s_add_u32 s32, s32, 7168
    buffer_load_dwordx4 v3, s[8:11], s32 offen lds
    s_add_u32 m0, s38, 2048
    s_add_u32 s32, s32, 7168
    buffer_load_dwordx4 v3, s[8:11], s32 offen lds
    s_add_u32 m0, s38, 3072
    s_add_u32 s32, s32, 7168
    buffer_load_dwordx4 v3, s[8:11], s32 offen lds
    s_add_u32 s32, s32, 7168
    s_add_u32 s33, s31, 147456
    buffer_load_dwordx4 v[116:119], v2, s[4:7], s31 offen offset:0 sc1
    buffer_load_dwordx4 v[120:123], v2, s[4:7], s31 offen offset:1024 sc1
    buffer_load_dwordx4 v[124:127], v2, s[4:7], s33 offen offset:0 sc1
    buffer_load_dwordx4 v[128:131], v2, s[4:7], s33 offen offset:1024 sc1
    s_add_u32 s31, s31, 2048
    s_waitcnt lgkmcnt(8)
    v_mfma_f32_32x32x16_bf16 v[20:35], v[100:103], v[132:135], v[20:35]
    v_mfma_f32_32x32x16_bf16 v[36:51], v[100:103], v[140:143], v[36:51]
    v_mfma_f32_32x32x16_bf16 v[52:67], v[108:111], v[132:135], v[52:67]
    v_mfma_f32_32x32x16_bf16 v[68:83], v[108:111], v[140:143], v[68:83]
    v_mfma_f32_32x32x16_bf16 v[20:35], v[104:107], v[136:139], v[20:35]
    v_mfma_f32_32x32x16_bf16 v[36:51], v[104:107], v[144:147], v[36:51]
    v_mfma_f32_32x32x16_bf16 v[52:67], v[112:115], v[136:139], v[52:67]
    v_mfma_f32_32x32x16_bf16 v[68:83], v[112:115], v[144:147], v[68:83]
    s_waitcnt vmcnt(8)
    ds_read_b64_tr_b16 v[100:101], v4 offset:12288
    ds_read_b64_tr_b16 v[102:103], v4 offset:13312
    ds_read_b64_tr_b16 v[104:105], v4 offset:14336
    ds_read_b64_tr_b16 v[106:107], v4 offset:15360
    ds_read_b64_tr_b16 v[108:109], v5 offset:12288
    ds_read_b64_tr_b16 v[110:111], v5 offset:13312
    ds_read_b64_tr_b16 v[112:113], v5 offset:14336
    ds_read_b64_tr_b16 v[114:115], v5 offset:15360
    s_add_u32 m0, s38, 4096
    s_nop 0
    buffer_load_dwordx4 v3, s[8:11], s32 offen lds
    s_add_u32 m0, s38, 5120
    s_add_u32 s32, s32, 7168
    buffer_load_dwordx4 v3, s[8:11], s32 offen lds
    s_add_u32 m0, s38, 6144
    s_add_u32 s32, s32, 7168
    buffer_load_dwordx4 v3, s[8:11], s32 offen lds
    s_add_u32 m0, s38, 7168
    s_add_u32 s32, s32, 7168
    buffer_load_dwordx4 v3, s[8:11], s32 offen lds
    s_add_u32 s32, s32, 7168
    s_add_u32 s33, s31, 147456
    buffer_load_dwordx4 v[132:135], v2, s[4:7], s31 offen offset:0 sc1
    buffer_load_dwordx4 v[136:139], v2, s[4:7], s31 offen offset:1024 sc1
    buffer_load_dwordx4 v[140:143], v2, s[4:7], s33 offen offset:0 sc1
    buffer_load_dwordx4 v[144:147], v2, s[4:7], s33 offen offset:1024 sc1
    s_add_u32 s31, s31, 2048
    buffer_load_dword v186, v185, s[4:7], 0 offen sc0 sc1
    s_waitcnt lgkmcnt(8)
    v_mfma_f32_32x32x16_bf16 v[20:35], v[84:87], v[148:151], v[20:35]
    v_mfma_f32_32x32x16_bf16 v[36:51], v[84:87], v[156:159], v[36:51]
    v_mfma_f32_32x32x16_bf16 v[52:67], v[92:95], v[148:151], v[52:67]
    v_mfma_f32_32x32x16_bf16 v[68:83], v[92:95], v[156:159], v[68:83]
    v_mfma_f32_32x32x16_bf16 v[20:35], v[88:91], v[152:155], v[20:35]
    v_mfma_f32_32x32x16_bf16 v[36:51], v[88:91], v[160:163], v[36:51]
    v_mfma_f32_32x32x16_bf16 v[52:67], v[96:99], v[152:155], v[52:67]
    v_mfma_f32_32x32x16_bf16 v[68:83], v[96:99], v[160:163], v[68:83]
    s_waitcnt vmcnt(9)
    ds_read_b64_tr_b16 v[84:85], v4 offset:0
    ds_read_b64_tr_b16 v[86:87], v4 offset:1024
    ds_read_b64_tr_b16 v[88:89], v4 offset:2048
    ds_read_b64_tr_b16 v[90:91], v4 offset:3072
    ds_read_b64_tr_b16 v[92:93], v5 offset:0
    ds_read_b64_tr_b16 v[94:95], v5 offset:1024
    ds_read_b64_tr_b16 v[96:97], v5 offset:2048
    ds_read_b64_tr_b16 v[98:99], v5 offset:3072
    s_add_u32 m0, s38, 8192
    s_nop 0
    buffer_load_dwordx4 v3, s[8:11], s32 offen lds
    s_add_u32 m0, s38, 9216
    s_add_u32 s32, s32, 7168
    buffer_load_dwordx4 v3, s[8:11], s32 offen lds
    s_add_u32 m0, s38, 10240
    s_add_u32 s32, s32, 7168
    buffer_load_dwordx4 v3, s[8:11], s32 offen lds
    s_add_u32 m0, s38, 11264
    s_add_u32 s32, s32, 7168
    buffer_load_dwordx4 v3, s[8:11], s32 offen lds
    s_add_u32 s32, s32, 7168
    s_add_u32 s33, s31, 147456
    buffer_load_dwordx4 v[148:151], v2, s[4:7], s31 offen offset:0 sc1
    buffer_load_dwordx4 v[152:155], v2, s[4:7], s31 offen offset:1024 sc1
    buffer_load_dwordx4 v[156:159], v2, s[4:7], s33 offen offset:0 sc1
    buffer_load_dwordx4 v[160:163], v2, s[4:7], s33 offen offset:1024 sc1
    s_add_u32 s31, s31, 2048
    s_waitcnt lgkmcnt(8)
    v_mfma_f32_32x32x16_bf16 v[20:35], v[100:103], v[164:167], v[20:35]
    v_mfma_f32_32x32x16_bf16 v[36:51], v[100:103], v[172:175], v[36:51]
    v_mfma_f32_32x32x16_bf16 v[52:67], v[108:111], v[164:167], v[52:67]
    v_mfma_f32_32x32x16_bf16 v[68:83], v[108:111], v[172:175], v[68:83]
    v_mfma_f32_32x32x16_bf16 v[20:35], v[104:107], v[168:171], v[20:35]
    v_mfma_f32_32x32x16_bf16 v[36:51], v[104:107], v[176:179], v[36:51]
    v_mfma_f32_32x32x16_bf16 v[52:67], v[112:115], v[168:171], v[52:67]
    v_mfma_f32_32x32x16_bf16 v[68:83], v[112:115], v[176:179], v[68:83]
    s_waitcnt vmcnt(9)
    ds_read_b64_tr_b16 v[100:101], v4 offset:4096
    ds_read_b64_tr_b16 v[102:103], v4 offset:5120
    ds_read_b64_tr_b16 v[104:105], v4 offset:6144
    ds_read_b64_tr_b16 v[106:107], v4 offset:7168
    ds_read_b64_tr_b16 v[108:109], v5 offset:4096
    ds_read_b64_tr_b16 v[110:111], v5 offset:5120
    ds_read_b64_tr_b16 v[112:113], v5 offset:6144
    ds_read_b64_tr_b16 v[114:115], v5 offset:7168
    s_add_u32 m0, s38, 12288
    s_nop 0
    buffer_load_dwordx4 v3, s[8:11], s32 offen lds
    s_add_u32 m0, s38, 13312
    s_add_u32 s32, s32, 7168
    buffer_load_dwordx4 v3, s[8:11], s32 offen lds
    s_add_u32 m0, s38, 14336
    s_add_u32 s32, s32, 7168
    buffer_load_dwordx4 v3, s[8:11], s32 offen lds
    s_add_u32 m0, s38, 15360
    s_add_u32 s32, s32, 7168
    buffer_load_dwordx4 v3, s[8:11], s32 offen lds
    s_add_u32 s32, s32, 7168
    s_add_u32 s33, s31, 147456
    buffer_load_dwordx4 v[164:167], v2, s[4:7], s31 offen offset:0 sc1
    buffer_load_dwordx4 v[168:171], v2, s[4:7], s31 offen offset:1024 sc1
    buffer_load_dwordx4 v[172:175], v2, s[4:7], s33 offen offset:0 sc1
    buffer_load_dwordx4 v[176:179], v2, s[4:7], s33 offen offset:1024 sc1
    s_add_u32 s31, s31, 2048
    s_waitcnt lgkmcnt(8)
    v_mfma_f32_32x32x16_bf16 v[20:35], v[84:87], v[116:119], v[20:35]
    v_mfma_f32_32x32x16_bf16 v[36:51], v[84:87], v[124:127], v[36:51]
    v_mfma_f32_32x32x16_bf16 v[52:67], v[92:95], v[116:119], v[52:67]
    v_mfma_f32_32x32x16_bf16 v[68:83], v[92:95], v[124:127], v[68:83]
    v_mfma_f32_32x32x16_bf16 v[20:35], v[88:91], v[120:123], v[20:35]
    v_mfma_f32_32x32x16_bf16 v[36:51], v[88:91], v[128:131], v[36:51]
    v_mfma_f32_32x32x16_bf16 v[52:67], v[96:99], v[120:123], v[52:67]
    v_mfma_f32_32x32x16_bf16 v[68:83], v[96:99], v[128:131], v[68:83]
    s_waitcnt vmcnt(8)
    ds_read_b64_tr_b16 v[84:85], v4 offset:8192
    ds_read_b64_tr_b16 v[86:87], v4 offset:9216
    ds_read_b64_tr_b16 v[88:89], v4 offset:10240
    ds_read_b64_tr_b16 v[90:91], v4 offset:11264
    ds_read_b64_tr_b16 v[92:93], v5 offset:8192
    ds_read_b64_tr_b16 v[94:95], v5 offset:9216
    ds_read_b64_tr_b16 v[96:97], v5 offset:10240
    ds_read_b64_tr_b16 v[98:99], v5 offset:11264
    s_waitcnt vmcnt(16)
    v_cmp_ne_u32 vcc, s74, v186
    s_nop 3
    s_cmp_eq_u64 vcc, 0
    s_cbranch_scc1 parallel_sum__softmax_full_mha__swiglu_ffn__prompt_kernel_hok_53
    s_add_u32 s37, s74, 0
    s_mov_b32 s36, 524288
    s_mov_b32 s68, 0xffffffff
    s_mov_b32 s69, 0xffffffff
parallel_sum__softmax_full_mha__swiglu_ffn__prompt_kernel_poll_54:
    buffer_load_dword v186, v185, s[4:7], 0 offen sc0 sc1
    s_waitcnt vmcnt(0)
    v_cmp_ne_u32 vcc, s37, v186
    s_nop 3
    s_and_b64 vcc, vcc, s[68:69]
    s_sub_u32 s36, s36, 1
    s_cmp_eq_u32 s36, 0
    s_cbranch_scc1 parallel_sum__softmax_full_mha__swiglu_ffn__prompt_kernel_pollx_55
    s_cmp_lg_u64 vcc, 0
    s_cbranch_scc0 parallel_sum__softmax_full_mha__swiglu_ffn__prompt_kernel_pollx_55
    s_sleep 1
    s_branch parallel_sum__softmax_full_mha__swiglu_ffn__prompt_kernel_poll_54
parallel_sum__softmax_full_mha__swiglu_ffn__prompt_kernel_pollx_55:
parallel_sum__softmax_full_mha__swiglu_ffn__prompt_kernel_hok_53:
    s_mov_b32 s31, s51
    s_mov_b32 s32, s50
    s_add_u32 m0, s38, 0
    s_nop 0
    buffer_load_dwordx4 v3, s[8:11], s32 offen lds
    s_add_u32 m0, s38, 1024
    s_add_u32 s32, s32, 7168
    buffer_load_dwordx4 v3, s[8:11], s32 offen lds
    s_add_u32 m0, s38, 2048
    s_add_u32 s32, s32, 7168
    buffer_load_dwordx4 v3, s[8:11], s32 offen lds
    s_add_u32 m0, s38, 3072
    s_add_u32 s32, s32, 7168
    buffer_load_dwordx4 v3, s[8:11], s32 offen lds
    s_add_u32 s32, s32, 7168
    s_add_u32 s33, s31, 147456
    buffer_load_dwordx4 v[116:119], v2, s[4:7], s31 offen offset:0 sc1
    buffer_load_dwordx4 v[120:123], v2, s[4:7], s31 offen offset:1024 sc1
    buffer_load_dwordx4 v[124:127], v2, s[4:7], s33 offen offset:0 sc1
    buffer_load_dwordx4 v[128:131], v2, s[4:7], s33 offen offset:1024 sc1
    s_add_u32 s31, s31, 2048
    s_waitcnt lgkmcnt(8)
    v_mfma_f32_32x32x16_bf16 v[20:35], v[100:103], v[132:135], v[20:35]
    v_mfma_f32_32x32x16_bf16 v[36:51], v[100:103], v[140:143], v[36:51]
    v_mfma_f32_32x32x16_bf16 v[52:67], v[108:111], v[132:135], v[52:67]
    v_mfma_f32_32x32x16_bf16 v[68:83], v[108:111], v[140:143], v[68:83]
    v_mfma_f32_32x32x16_bf16 v[20:35], v[104:107], v[136:139], v[20:35]
    v_mfma_f32_32x32x16_bf16 v[36:51], v[104:107], v[144:147], v[36:51]
    v_mfma_f32_32x32x16_bf16 v[52:67], v[112:115], v[136:139], v[52:67]
    v_mfma_f32_32x32x16_bf16 v[68:83], v[112:115], v[144:147], v[68:83]
    s_waitcnt vmcnt(8)
    ds_read_b64_tr_b16 v[100:101], v4 offset:12288
    ds_read_b64_tr_b16 v[102:103], v4 offset:13312
    ds_read_b64_tr_b16 v[104:105], v4 offset:14336
    ds_read_b64_tr_b16 v[106:107], v4 offset:15360
    ds_read_b64_tr_b16 v[108:109], v5 offset:12288
    ds_read_b64_tr_b16 v[110:111], v5 offset:13312
    ds_read_b64_tr_b16 v[112:113], v5 offset:14336
    ds_read_b64_tr_b16 v[114:115], v5 offset:15360
    s_add_u32 m0, s38, 4096
    s_nop 0
    buffer_load_dwordx4 v3, s[8:11], s32 offen lds
    s_add_u32 m0, s38, 5120
    s_add_u32 s32, s32, 7168
    buffer_load_dwordx4 v3, s[8:11], s32 offen lds
    s_add_u32 m0, s38, 6144
    s_add_u32 s32, s32, 7168
    buffer_load_dwordx4 v3, s[8:11], s32 offen lds
    s_add_u32 m0, s38, 7168
    s_add_u32 s32, s32, 7168
    buffer_load_dwordx4 v3, s[8:11], s32 offen lds
    s_add_u32 s32, s32, 7168
    s_add_u32 s33, s31, 147456
    buffer_load_dwordx4 v[132:135], v2, s[4:7], s31 offen offset:0 sc1
    buffer_load_dwordx4 v[136:139], v2, s[4:7], s31 offen offset:1024 sc1
    buffer_load_dwordx4 v[140:143], v2, s[4:7], s33 offen offset:0 sc1
    buffer_load_dwordx4 v[144:147], v2, s[4:7], s33 offen offset:1024 sc1
    s_add_u32 s31, s31, 2048
    s_waitcnt lgkmcnt(8)
    v_mfma_f32_32x32x16_bf16 v[20:35], v[84:87], v[148:151], v[20:35]
    v_mfma_f32_32x32x16_bf16 v[36:51], v[84:87], v[156:159], v[36:51]
    v_mfma_f32_32x32x16_bf16 v[52:67], v[92:95], v[148:151], v[52:67]
    v_mfma_f32_32x32x16_bf16 v[68:83], v[92:95], v[156:159], v[68:83]
    v_mfma_f32_32x32x16_bf16 v[20:35], v[88:91], v[152:155], v[20:35]
    v_mfma_f32_32x32x16_bf16 v[36:51], v[88:91], v[160:163], v[36:51]
    v_mfma_f32_32x32x16_bf16 v[52:67], v[96:99], v[152:155], v[52:67]
    v_mfma_f32_32x32x16_bf16 v[68:83], v[96:99], v[160:163], v[68:83]
    s_waitcnt vmcnt(8)
    ds_read_b64_tr_b16 v[84:85], v4 offset:0
    ds_read_b64_tr_b16 v[86:87], v4 offset:1024
    ds_read_b64_tr_b16 v[88:89], v4 offset:2048
    ds_read_b64_tr_b16 v[90:91], v4 offset:3072
    ds_read_b64_tr_b16 v[92:93], v5 offset:0
    ds_read_b64_tr_b16 v[94:95], v5 offset:1024
    ds_read_b64_tr_b16 v[96:97], v5 offset:2048
    ds_read_b64_tr_b16 v[98:99], v5 offset:3072
    s_add_u32 m0, s38, 8192
    s_nop 0
    buffer_load_dwordx4 v3, s[8:11], s32 offen lds
    s_add_u32 m0, s38, 9216
    s_add_u32 s32, s32, 7168
    buffer_load_dwordx4 v3, s[8:11], s32 offen lds
    s_add_u32 m0, s38, 10240
    s_add_u32 s32, s32, 7168
    buffer_load_dwordx4 v3, s[8:11], s32 offen lds
    s_add_u32 m0, s38, 11264
    s_add_u32 s32, s32, 7168
    buffer_load_dwordx4 v3, s[8:11], s32 offen lds
    s_add_u32 s32, s32, 7168
    s_add_u32 s33, s31, 147456
    buffer_load_dwordx4 v[148:151], v2, s[4:7], s31 offen offset:0 sc1
    buffer_load_dwordx4 v[152:155], v2, s[4:7], s31 offen offset:1024 sc1
    buffer_load_dwordx4 v[156:159], v2, s[4:7], s33 offen offset:0 sc1
    buffer_load_dwordx4 v[160:163], v2, s[4:7], s33 offen offset:1024 sc1
    s_add_u32 s31, s31, 2048
    s_waitcnt lgkmcnt(8)
    v_mfma_f32_32x32x16_bf16 v[20:35], v[100:103], v[164:167], v[20:35]
    v_mfma_f32_32x32x16_bf16 v[36:51], v[100:103], v[172:175], v[36:51]
    v_mfma_f32_32x32x16_bf16 v[52:67], v[108:111], v[164:167], v[52:67]
    v_mfma_f32_32x32x16_bf16 v[68:83], v[108:111], v[172:175], v[68:83]
    v_mfma_f32_32x32x16_bf16 v[20:35], v[104:107], v[168:171], v[20:35]
    v_mfma_f32_32x32x16_bf16 v[36:51], v[104:107], v[176:179], v[36:51]
    v_mfma_f32_32x32x16_bf16 v[52:67], v[112:115], v[168:171], v[52:67]
    v_mfma_f32_32x32x16_bf16 v[68:83], v[112:115], v[176:179], v[68:83]
    s_waitcnt vmcnt(8)
    ds_read_b64_tr_b16 v[100:101], v4 offset:4096
    ds_read_b64_tr_b16 v[102:103], v4 offset:5120
    ds_read_b64_tr_b16 v[104:105], v4 offset:6144
    ds_read_b64_tr_b16 v[106:107], v4 offset:7168
    ds_read_b64_tr_b16 v[108:109], v5 offset:4096
    ds_read_b64_tr_b16 v[110:111], v5 offset:5120
    ds_read_b64_tr_b16 v[112:113], v5 offset:6144
    ds_read_b64_tr_b16 v[114:115], v5 offset:7168
    s_add_u32 m0, s38, 12288
    s_nop 0
    buffer_load_dwordx4 v3, s[8:11], s32 offen lds
    s_add_u32 m0, s38, 13312
    s_add_u32 s32, s32, 7168
    buffer_load_dwordx4 v3, s[8:11], s32 offen lds
    s_add_u32 m0, s38, 14336
    s_add_u32 s32, s32, 7168
    buffer_load_dwordx4 v3, s[8:11], s32 offen lds
    s_add_u32 m0, s38, 15360
    s_add_u32 s32, s32, 7168
    buffer_load_dwordx4 v3, s[8:11], s32 offen lds
    s_add_u32 s32, s32, 7168
    s_add_u32 s33, s31, 147456
    buffer_load_dwordx4 v[164:167], v2, s[4:7], s31 offen offset:0 sc1
    buffer_load_dwordx4 v[168:171], v2, s[4:7], s31 offen offset:1024 sc1
    buffer_load_dwordx4 v[172:175], v2, s[4:7], s33 offen offset:0 sc1
    buffer_load_dwordx4 v[176:179], v2, s[4:7], s33 offen offset:1024 sc1
    s_add_u32 s31, s31, 2048
    s_waitcnt lgkmcnt(8)
    v_mfma_f32_32x32x16_bf16 v[20:35], v[84:87], v[116:119], v[20:35]
    v_mfma_f32_32x32x16_bf16 v[36:51], v[84:87], v[124:127], v[36:51]
    v_mfma_f32_32x32x16_bf16 v[52:67], v[92:95], v[116:119], v[52:67]
    v_mfma_f32_32x32x16_bf16 v[68:83], v[92:95], v[124:127], v[68:83]
    v_mfma_f32_32x32x16_bf16 v[20:35], v[88:91], v[120:123], v[20:35]
    v_mfma_f32_32x32x16_bf16 v[36:51], v[88:91], v[128:131], v[36:51]
    v_mfma_f32_32x32x16_bf16 v[52:67], v[96:99], v[120:123], v[52:67]
    v_mfma_f32_32x32x16_bf16 v[68:83], v[96:99], v[128:131], v[68:83]
    s_waitcnt vmcnt(8)
    ds_read_b64_tr_b16 v[84:85], v4 offset:8192
    ds_read_b64_tr_b16 v[86:87], v4 offset:9216
    ds_read_b64_tr_b16 v[88:89], v4 offset:10240
    ds_read_b64_tr_b16 v[90:91], v4 offset:11264
    ds_read_b64_tr_b16 v[92:93], v5 offset:8192
    ds_read_b64_tr_b16 v[94:95], v5 offset:9216
    ds_read_b64_tr_b16 v[96:97], v5 offset:10240
    ds_read_b64_tr_b16 v[98:99], v5 offset:11264
    s_add_u32 m0, s38, 0
    s_nop 0
    buffer_load_dwordx4 v3, s[8:11], s32 offen lds
    s_add_u32 m0, s38, 1024
    s_add_u32 s32, s32, 7168
    buffer_load_dwordx4 v3, s[8:11], s32 offen lds
    s_add_u32 m0, s38, 2048
    s_add_u32 s32, s32, 7168
    buffer_load_dwordx4 v3, s[8:11], s32 offen lds
    s_add_u32 m0, s38, 3072
    s_add_u32 s32, s32, 7168
    buffer_load_dwordx4 v3, s[8:11], s32 offen lds
    s_add_u32 s32, s32, 7168
    s_add_u32 s33, s31, 147456
    buffer_load_dwordx4 v[116:119], v2, s[4:7], s31 offen offset:0 sc1
    buffer_load_dwordx4 v[120:123], v2, s[4:7], s31 offen offset:1024 sc1
    buffer_load_dwordx4 v[124:127], v2, s[4:7], s33 offen offset:0 sc1
    buffer_load_dwordx4 v[128:131], v2, s[4:7], s33 offen offset:1024 sc1
    s_add_u32 s31, s31, 2048
    s_waitcnt lgkmcnt(8)
    v_mfma_f32_32x32x16_bf16 v[20:35], v[100:103], v[132:135], v[20:35]
    v_mfma_f32_32x32x16_bf16 v[36:51], v[100:103], v[140:143], v[36:51]
    v_mfma_f32_32x32x16_bf16 v[52:67], v[108:111], v[132:135], v[52:67]
    v_mfma_f32_32x32x16_bf16 v[68:83], v[108:111], v[140:143], v[68:83]
    v_mfma_f32_32x32x16_bf16 v[20:35], v[104:107], v[136:139], v[20:35]
    v_mfma_f32_32x32x16_bf16 v[36:51], v[104:107], v[144:147], v[36:51]
    v_mfma_f32_32x32x16_bf16 v[52:67], v[112:115], v[136:139], v[52:67]
    v_mfma_f32_32x32x16_bf16 v[68:83], v[112:115], v[144:147], v[68:83]
    s_waitcnt vmcnt(8)
    ds_read_b64_tr_b16 v[100:101], v4 offset:12288
    ds_read_b64_tr_b16 v[102:103], v4 offset:13312
    ds_read_b64_tr_b16 v[104:105], v4 offset:14336
    ds_read_b64_tr_b16 v[106:107], v4 offset:15360
    ds_read_b64_tr_b16 v[108:109], v5 offset:12288
    ds_read_b64_tr_b16 v[110:111], v5 offset:13312
    ds_read_b64_tr_b16 v[112:113], v5 offset:14336
    ds_read_b64_tr_b16 v[114:115], v5 offset:15360
    s_add_u32 m0, s38, 4096
    s_nop 0
    buffer_load_dwordx4 v3, s[8:11], s32 offen lds
    s_add_u32 m0, s38, 5120
    s_add_u32 s32, s32, 7168
    buffer_load_dwordx4 v3, s[8:11], s32 offen lds
    s_add_u32 m0, s38, 6144
    s_add_u32 s32, s32, 7168
    buffer_load_dwordx4 v3, s[8:11], s32 offen lds
    s_add_u32 m0, s38, 7168
    s_add_u32 s32, s32, 7168
    buffer_load_dwordx4 v3, s[8:11], s32 offen lds
    s_add_u32 s32, s32, 7168
    s_add_u32 s33, s31, 147456
    buffer_load_dwordx4 v[132:135], v2, s[4:7], s31 offen offset:0 sc1
    buffer_load_dwordx4 v[136:139], v2, s[4:7], s31 offen offset:1024 sc1
    buffer_load_dwordx4 v[140:143], v2, s[4:7], s33 offen offset:0 sc1
    buffer_load_dwordx4 v[144:147], v2, s[4:7], s33 offen offset:1024 sc1
    s_add_u32 s31, s31, 2048
    s_waitcnt lgkmcnt(8)
    v_mfma_f32_32x32x16_bf16 v[20:35], v[84:87], v[148:151], v[20:35]
    v_mfma_f32_32x32x16_bf16 v[36:51], v[84:87], v[156:159], v[36:51]
    v_mfma_f32_32x32x16_bf16 v[52:67], v[92:95], v[148:151], v[52:67]
    v_mfma_f32_32x32x16_bf16 v[68:83], v[92:95], v[156:159], v[68:83]
    v_mfma_f32_32x32x16_bf16 v[20:35], v[88:91], v[152:155], v[20:35]
    v_mfma_f32_32x32x16_bf16 v[36:51], v[88:91], v[160:163], v[36:51]
    v_mfma_f32_32x32x16_bf16 v[52:67], v[96:99], v[152:155], v[52:67]
    v_mfma_f32_32x32x16_bf16 v[68:83], v[96:99], v[160:163], v[68:83]
    s_waitcnt vmcnt(8)
    ds_read_b64_tr_b16 v[84:85], v4 offset:0
    ds_read_b64_tr_b16 v[86:87], v4 offset:1024
    ds_read_b64_tr_b16 v[88:89], v4 offset:2048
    ds_read_b64_tr_b16 v[90:91], v4 offset:3072
    ds_read_b64_tr_b16 v[92:93], v5 offset:0
    ds_read_b64_tr_b16 v[94:95], v5 offset:1024
    ds_read_b64_tr_b16 v[96:97], v5 offset:2048
    ds_read_b64_tr_b16 v[98:99], v5 offset:3072
    s_waitcnt lgkmcnt(8)
    v_mfma_f32_32x32x16_bf16 v[20:35], v[100:103], v[164:167], v[20:35]
    v_mfma_f32_32x32x16_bf16 v[36:51], v[100:103], v[172:175], v[36:51]
    v_mfma_f32_32x32x16_bf16 v[52:67], v[108:111], v[164:167], v[52:67]
    v_mfma_f32_32x32x16_bf16 v[68:83], v[108:111], v[172:175], v[68:83]
    v_mfma_f32_32x32x16_bf16 v[20:35], v[104:107], v[168:171], v[20:35]
    v_mfma_f32_32x32x16_bf16 v[36:51], v[104:107], v[176:179], v[36:51]
    v_mfma_f32_32x32x16_bf16 v[52:67], v[112:115], v[168:171], v[52:67]
    v_mfma_f32_32x32x16_bf16 v[68:83], v[112:115], v[176:179], v[68:83]
    s_waitcnt vmcnt(0)
    ds_read_b64_tr_b16 v[100:101], v4 offset:4096
    ds_read_b64_tr_b16 v[102:103], v4 offset:5120
    ds_read_b64_tr_b16 v[104:105], v4 offset:6144
    ds_read_b64_tr_b16 v[106:107], v4 offset:7168
    ds_read_b64_tr_b16 v[108:109], v5 offset:4096
    ds_read_b64_tr_b16 v[110:111], v5 offset:5120
    ds_read_b64_tr_b16 v[112:113], v5 offset:6144
    ds_read_b64_tr_b16 v[114:115], v5 offset:7168
    s_waitcnt lgkmcnt(8)
    v_mfma_f32_32x32x16_bf16 v[20:35], v[84:87], v[116:119], v[20:35]
    v_mfma_f32_32x32x16_bf16 v[36:51], v[84:87], v[124:127], v[36:51]
    v_mfma_f32_32x32x16_bf16 v[52:67], v[92:95], v[116:119], v[52:67]
    v_mfma_f32_32x32x16_bf16 v[68:83], v[92:95], v[124:127], v[68:83]
    v_mfma_f32_32x32x16_bf16 v[20:35], v[88:91], v[120:123], v[20:35]
    v_mfma_f32_32x32x16_bf16 v[36:51], v[88:91], v[128:131], v[36:51]
    v_mfma_f32_32x32x16_bf16 v[52:67], v[96:99], v[120:123], v[52:67]
    v_mfma_f32_32x32x16_bf16 v[68:83], v[96:99], v[128:131], v[68:83]
    s_waitcnt lgkmcnt(0)
    v_mfma_f32_32x32x16_bf16 v[20:35], v[100:103], v[132:135], v[20:35]
    v_mfma_f32_32x32x16_bf16 v[36:51], v[100:103], v[140:143], v[36:51]
    v_mfma_f32_32x32x16_bf16 v[52:67], v[108:111], v[132:135], v[52:67]
    v_mfma_f32_32x32x16_bf16 v[68:83], v[108:111], v[140:143], v[68:83]
    v_mfma_f32_32x32x16_bf16 v[20:35], v[104:107], v[136:139], v[20:35]
    v_mfma_f32_32x32x16_bf16 v[36:51], v[104:107], v[144:147], v[36:51]
    v_mfma_f32_32x32x16_bf16 v[52:67], v[112:115], v[136:139], v[52:67]
    v_mfma_f32_32x32x16_bf16 v[68:83], v[112:115], v[144:147], v[68:83]
    s_mul_i32 s32, s39, 100352
    s_add_u32 m0, s38, 0
    s_nop 0
    buffer_load_dwordx4 v3, s[12:15], s32 offen lds
    s_add_u32 m0, s38, 1024
    s_add_u32 s32, s32, 7168
    buffer_load_dwordx4 v3, s[12:15], s32 offen lds
    s_add_u32 m0, s38, 2048
    s_add_u32 s32, s32, 7168
    buffer_load_dwordx4 v3, s[12:15], s32 offen lds
    s_add_u32 m0, s38, 3072
    s_add_u32 s32, s32, 7168
    buffer_load_dwordx4 v3, s[12:15], s32 offen lds
    s_add_u32 s32, s32, 3584
    s_add_u32 m0, s38, 4096
    s_nop 0
    buffer_load_dwordx4 v3, s[12:15], s32 offen lds
    s_add_u32 m0, s38, 5120
    s_add_u32 s32, s32, 7168
    buffer_load_dwordx4 v3, s[12:15], s32 offen lds
    s_add_u32 m0, s38, 6144
    s_add_u32 s32, s32, 7168
    buffer_load_dwordx4 v3, s[12:15], s32 offen lds
    s_add_u32 m0, s38, 7168
    s_add_u32 s32, s32, 7168
    buffer_load_dwordx4 v3, s[12:15], s32 offen lds
    s_add_u32 s32, s32, 3584
    s_add_u32 m0, s38, 8192
    s_nop 0
    buffer_load_dwordx4 v3, s[12:15], s32 offen lds
    s_add_u32 m0, s38, 9216
    s_add_u32 s32, s32, 7168
    buffer_load_dwordx4 v3, s[12:15], s32 offen lds
    s_add_u32 m0, s38, 10240
    s_add_u32 s32, s32, 7168
    buffer_load_dwordx4 v3, s[12:15], s32 offen lds
    s_add_u32 m0, s38, 11264
    s_add_u32 s32, s32, 7168
    buffer_load_dwordx4 v3, s[12:15], s32 offen lds
    s_add_u32 s32, s32, 3584
    s_add_u32 m0, s38, 12288
    s_nop 0
    buffer_load_dwordx4 v3, s[12:15], s32 offen lds
    s_add_u32 m0, s38, 13312
    s_add_u32 s32, s32, 7168
    buffer_load_dwordx4 v3, s[12:15], s32 offen lds
    s_add_u32 m0, s38, 14336
    s_add_u32 s32, s32, 7168
    buffer_load_dwordx4 v3, s[12:15], s32 offen lds
    s_add_u32 m0, s38, 15360
    s_add_u32 s32, s32, 7168
    buffer_load_dwordx4 v3, s[12:15], s32 offen lds
    s_add_u32 s32, s32, 3584
    s_mul_i32 s31, s24, 288
    s_lshl_b32 s33, s39, 3
    s_add_u32 s31, s31, s33
    s_add_u32 s31, s31, 112
    s_lshl_b32 s31, s31, 10
    s_add_u32 s31, s31, 6291456
    v_bfe_u32 v7, v1, 1, 2
    s_lshl_b32 s33, s39, 2
    v_add_u32 v7, s33, v7
    v_lshrrev_b32 v8, 1, v7
    v_and_b32 v7, 1, v7
    s_lshr_b32 s33, s24, 1
    s_lshl_b32 s33, s33, 1
    v_add_u32 v7, s33, v7
    v_lshl_add_u32 v11, v7, 3, v8
    v_lshlrev_b32 v11, 2, v11
    v_and_b32 v7, 1, v1
    v_add_u32 v11, v11, v7
    s_and_b32 s33, s24, 1
    s_lshl_b32 s33, s33, 1
    v_add_u32 v11, s33, v11
    v_lshlrev_b32 v11, 6, v11
    v_add_u32 v11, 25231360, v11
    s_add_u32 s37, s74, 1
    s_mov_b32 s36, 524288
    s_mov_b32 s68, 0xffffffff
    s_mov_b32 s69, 0xffffffff
parallel_sum__softmax_full_mha__swiglu_ffn__prompt_kernel_poll_56:
    buffer_load_dword v7, v11, s[4:7], 0 offen sc0 sc1
    s_waitcnt vmcnt(0)
    v_cmp_ne_u32 vcc, s37, v7
    s_nop 3
    s_and_b64 vcc, vcc, s[68:69]
    s_sub_u32 s36, s36, 1
    s_cmp_eq_u32 s36, 0
    s_cbranch_scc1 parallel_sum__softmax_full_mha__swiglu_ffn__prompt_kernel_pollx_57
    s_cmp_lg_u64 vcc, 0
    s_cbranch_scc0 parallel_sum__softmax_full_mha__swiglu_ffn__prompt_kernel_pollx_57
    s_sleep 1
    s_branch parallel_sum__softmax_full_mha__swiglu_ffn__prompt_kernel_poll_56
parallel_sum__softmax_full_mha__swiglu_ffn__prompt_kernel_pollx_57:
    s_add_u32 s33, s31, 147456
    buffer_load_dwordx4 v[116:119], v2, s[4:7], s31 offen offset:0 sc1
    buffer_load_dwordx4 v[120:123], v2, s[4:7], s31 offen offset:1024 sc1
    buffer_load_dwordx4 v[124:127], v2, s[4:7], s33 offen offset:0 sc1
    buffer_load_dwordx4 v[128:131], v2, s[4:7], s33 offen offset:1024 sc1
    s_add_u32 s31, s31, 2048
    s_add_u32 s33, s31, 147456
    buffer_load_dwordx4 v[132:135], v2, s[4:7], s31 offen offset:0 sc1
    buffer_load_dwordx4 v[136:139], v2, s[4:7], s31 offen offset:1024 sc1
    buffer_load_dwordx4 v[140:143], v2, s[4:7], s33 offen offset:0 sc1
    buffer_load_dwordx4 v[144:147], v2, s[4:7], s33 offen offset:1024 sc1
    s_add_u32 s31, s31, 2048
    s_add_u32 s33, s31, 147456
    buffer_load_dwordx4 v[148:151], v2, s[4:7], s31 offen offset:0 sc1
    buffer_load_dwordx4 v[152:155], v2, s[4:7], s31 offen offset:1024 sc1
    buffer_load_dwordx4 v[156:159], v2, s[4:7], s33 offen offset:0 sc1
    buffer_load_dwordx4 v[160:163], v2, s[4:7], s33 offen offset:1024 sc1
    s_add_u32 s31, s31, 2048
    s_add_u32 s33, s31, 147456
    buffer_load_dwordx4 v[164:167], v2, s[4:7], s31 offen offset:0 sc1
    buffer_load_dwordx4 v[168:171], v2, s[4:7], s31 offen offset:1024 sc1
    buffer_load_dwordx4 v[172:175], v2, s[4:7], s33 offen offset:0 sc1
    buffer_load_dwordx4 v[176:179], v2, s[4:7], s33 offen offset:1024 sc1
    s_add_u32 s31, s31, 2048
    s_waitcnt vmcnt(12)
    ds_read_b64_tr_b16 v[84:85], v4 offset:0
    ds_read_b64_tr_b16 v[86:87], v4 offset:1024
    ds_read_b64_tr_b16 v[88:89], v4 offset:2048
    ds_read_b64_tr_b16 v[90:91], v4 offset:3072
    ds_read_b64_tr_b16 v[92:93], v5 offset:0
    ds_read_b64_tr_b16 v[94:95], v5 offset:1024
    ds_read_b64_tr_b16 v[96:97], v5 offset:2048
    ds_read_b64_tr_b16 v[98:99], v5 offset:3072
    s_waitcnt lgkmcnt(0)
    v_mfma_f32_32x32x16_bf16 v[20:35], v[84:87], v[116:119], v[20:35]
    v_mfma_f32_32x32x16_bf16 v[36:51], v[84:87], v[124:127], v[36:51]
    v_mfma_f32_32x32x16_bf16 v[52:67], v[92:95], v[116:119], v[52:67]
    v_mfma_f32_32x32x16_bf16 v[68:83], v[92:95], v[124:127], v[68:83]
    v_mfma_f32_32x32x16_bf16 v[20:35], v[88:91], v[120:123], v[20:35]
    v_mfma_f32_32x32x16_bf16 v[36:51], v[88:91], v[128:131], v[36:51]
    v_mfma_f32_32x32x16_bf16 v[52:67], v[96:99], v[120:123], v[52:67]
    v_mfma_f32_32x32x16_bf16 v[68:83], v[96:99], v[128:131], v[68:83]
    s_waitcnt vmcnt(8)
    ds_read_b64_tr_b16 v[100:101], v4 offset:4096
    ds_read_b64_tr_b16 v[102:103], v4 offset:5120
    ds_read_b64_tr_b16 v[104:105], v4 offset:6144
    ds_read_b64_tr_b16 v[106:107], v4 offset:7168
    ds_read_b64_tr_b16 v[108:109], v5 offset:4096
    ds_read_b64_tr_b16 v[110:111], v5 offset:5120
    ds_read_b64_tr_b16 v[112:113], v5 offset:6144
    ds_read_b64_tr_b16 v[114:115], v5 offset:7168
    s_waitcnt lgkmcnt(0)
    v_mfma_f32_32x32x16_bf16 v[20:35], v[100:103], v[132:135], v[20:35]
    v_mfma_f32_32x32x16_bf16 v[36:51], v[100:103], v[140:143], v[36:51]
    v_mfma_f32_32x32x16_bf16 v[52:67], v[108:111], v[132:135], v[52:67]
    v_mfma_f32_32x32x16_bf16 v[68:83], v[108:111], v[140:143], v[68:83]
    v_mfma_f32_32x32x16_bf16 v[20:35], v[104:107], v[136:139], v[20:35]
    v_mfma_f32_32x32x16_bf16 v[36:51], v[104:107], v[144:147], v[36:51]
    v_mfma_f32_32x32x16_bf16 v[52:67], v[112:115], v[136:139], v[52:67]
    v_mfma_f32_32x32x16_bf16 v[68:83], v[112:115], v[144:147], v[68:83]
    s_waitcnt vmcnt(4)
    ds_read_b64_tr_b16 v[84:85], v4 offset:8192
    ds_read_b64_tr_b16 v[86:87], v4 offset:9216
    ds_read_b64_tr_b16 v[88:89], v4 offset:10240
    ds_read_b64_tr_b16 v[90:91], v4 offset:11264
    ds_read_b64_tr_b16 v[92:93], v5 offset:8192
    ds_read_b64_tr_b16 v[94:95], v5 offset:9216
    ds_read_b64_tr_b16 v[96:97], v5 offset:10240
    ds_read_b64_tr_b16 v[98:99], v5 offset:11264
    s_waitcnt lgkmcnt(0)
    v_mfma_f32_32x32x16_bf16 v[20:35], v[84:87], v[148:151], v[20:35]
    v_mfma_f32_32x32x16_bf16 v[36:51], v[84:87], v[156:159], v[36:51]
    v_mfma_f32_32x32x16_bf16 v[52:67], v[92:95], v[148:151], v[52:67]
    v_mfma_f32_32x32x16_bf16 v[68:83], v[92:95], v[156:159], v[68:83]
    v_mfma_f32_32x32x16_bf16 v[20:35], v[88:91], v[152:155], v[20:35]
    v_mfma_f32_32x32x16_bf16 v[36:51], v[88:91], v[160:163], v[36:51]
    v_mfma_f32_32x32x16_bf16 v[52:67], v[96:99], v[152:155], v[52:67]
    v_mfma_f32_32x32x16_bf16 v[68:83], v[96:99], v[160:163], v[68:83]
    s_waitcnt vmcnt(0)
    ds_read_b64_tr_b16 v[100:101], v4 offset:12288
    ds_read_b64_tr_b16 v[102:103], v4 offset:13312
    ds_read_b64_tr_b16 v[104:105], v4 offset:14336
    ds_read_b64_tr_b16 v[106:107], v4 offset:15360
    ds_read_b64_tr_b16 v[108:109], v5 offset:12288
    ds_read_b64_tr_b16 v[110:111], v5 offset:13312
    ds_read_b64_tr_b16 v[112:113], v5 offset:14336
    ds_read_b64_tr_b16 v[114:115], v5 offset:15360
    s_waitcnt lgkmcnt(0)
    v_mfma_f32_32x32x16_bf16 v[20:35], v[100:103], v[164:167], v[20:35]
    v_mfma_f32_32x32x16_bf16 v[36:51], v[100:103], v[172:175], v[36:51]
    v_mfma_f32_32x32x16_bf16 v[52:67], v[108:111], v[164:167], v[52:67]
    v_mfma_f32_32x32x16_bf16 v[68:83], v[108:111], v[172:175], v[68:83]
    v_mfma_f32_32x32x16_bf16 v[20:35], v[104:107], v[168:171], v[20:35]
    v_mfma_f32_32x32x16_bf16 v[36:51], v[104:107], v[176:179], v[36:51]
    v_mfma_f32_32x32x16_bf16 v[52:67], v[112:115], v[168:171], v[52:67]
    v_mfma_f32_32x32x16_bf16 v[68:83], v[112:115], v[176:179], v[68:83]
    s_nop 11
    v_add_u32 v7, s38, v2
    ds_write_b128 v7, v[20:23] offset:0
    ds_write_b128 v7, v[24:27] offset:1024
    ds_write_b128 v7, v[28:31] offset:2048
    ds_write_b128 v7, v[32:35] offset:3072
    ds_write_b128 v7, v[36:39] offset:4096
    ds_write_b128 v7, v[40:43] offset:5120
    ds_write_b128 v7, v[44:47] offset:6144
    ds_write_b128 v7, v[48:51] offset:7168
    ds_write_b128 v7, v[52:55] offset:8192
    ds_write_b128 v7, v[56:59] offset:9216
    ds_write_b128 v7, v[60:63] offset:10240
    ds_write_b128 v7, v[64:67] offset:11264
    ds_write_b128 v7, v[68:71] offset:12288
    ds_write_b128 v7, v[72:75] offset:13312
    ds_write_b128 v7, v[76:79] offset:14336
    ds_write_b128 v7, v[80:83] offset:15360
    s_waitcnt lgkmcnt(0)
    s_barrier
    s_lshl_b32 s33, s39, 12
    s_add_u32 s33, s33, 66560
    v_add_u32 v7, s33, v2
    ds_read_b128 v[84:87], v7 offset:0
    ds_read_b128 v[88:91], v7 offset:1024
    ds_read_b128 v[92:95], v7 offset:2048
    ds_read_b128 v[96:99], v7 offset:3072
    ds_read_b128 v[100:103], v7 offset:16384
    ds_read_b128 v[104:107], v7 offset:17408
    ds_read_b128 v[108:111], v7 offset:18432
    ds_read_b128 v[112:115], v7 offset:19456
    ds_read_b128 v[116:119], v7 offset:32768
    ds_read_b128 v[120:123], v7 offset:33792
    ds_read_b128 v[124:127], v7 offset:34816
    ds_read_b128 v[128:131], v7 offset:35840
    ds_read_b128 v[132:135], v7 offset:49152
    ds_read_b128 v[136:139], v7 offset:50176
    ds_read_b128 v[140:143], v7 offset:51200
    ds_read_b128 v[144:147], v7 offset:52224
    s_waitcnt lgkmcnt(0)
    v_add_f32 v84, v84, v100
    v_add_f32 v116, v116, v132
    v_add_f32 v85, v85, v101
    v_add_f32 v117, v117, v133
    v_add_f32 v86, v86, v102
    v_add_f32 v118, v118, v134
    v_add_f32 v87, v87, v103
    v_add_f32 v119, v119, v135
    v_add_f32 v88, v88, v104
    v_add_f32 v120, v120, v136
    v_add_f32 v89, v89, v105
    v_add_f32 v121, v121, v137
    v_add_f32 v90, v90, v106
    v_add_f32 v122, v122, v138
    v_add_f32 v91, v91, v107
    v_add_f32 v123, v123, v139
    v_add_f32 v92, v92, v108
    v_add_f32 v124, v124, v140
    v_add_f32 v93, v93, v109
    v_add_f32 v125, v125, v141
    v_add_f32 v94, v94, v110
    v_add_f32 v126, v126, v142
    v_add_f32 v95, v95, v111
    v_add_f32 v127, v127, v143
    v_add_f32 v96, v96, v112
    v_add_f32 v128, v128, v144
    v_add_f32 v97, v97, v113
    v_add_f32 v129, v129, v145
    v_add_f32 v98, v98, v114
    v_add_f32 v130, v130, v146
    v_add_f32 v99, v99, v115
    v_add_f32 v131, v131, v147
    v_add_f32 v84, v84, v116
    v_add_f32 v85, v85, v117
    v_add_f32 v86, v86, v118
    v_add_f32 v87, v87, v119
    v_add_f32 v88, v88, v120
    v_add_f32 v89, v89, v121
    v_add_f32 v90, v90, v122
    v_add_f32 v91, v91, v123
    v_add_f32 v92, v92, v124
    v_add_f32 v93, v93, v125
    v_add_f32 v94, v94, v126
    v_add_f32 v95, v95, v127
    v_add_f32 v96, v96, v128
    v_add_f32 v97, v97, v129
    v_add_f32 v98, v98, v130
    v_add_f32 v99, v99, v131
    s_nop 1
    v_permlane32_swap_b32 v84, v88
    v_permlane32_swap_b32 v85, v89
    v_permlane32_swap_b32 v86, v90
    v_permlane32_swap_b32 v87, v91
    v_permlane32_swap_b32 v92, v96
    v_permlane32_swap_b32 v93, v97
    v_permlane32_swap_b32 v94, v98
    v_permlane32_swap_b32 v95, v99
    v_lshlrev_b32 v7, 16, v188
    v_and_b32 v8, 0xffff0000, v188
    v_add_f32 v84, v84, v7
    v_add_f32 v85, v85, v8
    v_lshlrev_b32 v7, 16, v189
    v_and_b32 v8, 0xffff0000, v189
    v_add_f32 v86, v86, v7
    v_add_f32 v87, v87, v8
    v_lshlrev_b32 v7, 16, v190
    v_and_b32 v8, 0xffff0000, v190
    v_add_f32 v88, v88, v7
    v_add_f32 v89, v89, v8
    v_lshlrev_b32 v7, 16, v191
    v_and_b32 v8, 0xffff0000, v191
    v_add_f32 v90, v90, v7
    v_add_f32 v91, v91, v8
    v_cvt_pk_bf16_f32 v188, v84, v85
    v_cvt_pk_bf16_f32 v189, v86, v87
    v_cvt_pk_bf16_f32 v190, v88, v89
    v_cvt_pk_bf16_f32 v191, v90, v91
    v_lshlrev_b32 v7, 16, v192
    v_and_b32 v8, 0xffff0000, v192
    v_add_f32 v92, v92, v7
    v_add_f32 v93, v93, v8
    v_lshlrev_b32 v7, 16, v193
    v_and_b32 v8, 0xffff0000, v193
    v_add_f32 v94, v94, v7
    v_add_f32 v95, v95, v8
    v_lshlrev_b32 v7, 16, v194
    v_and_b32 v8, 0xffff0000, v194
    v_add_f32 v96, v96, v7
    v_add_f32 v97, v97, v8
    v_lshlrev_b32 v7, 16, v195
    v_and_b32 v8, 0xffff0000, v195
    v_add_f32 v98, v98, v7
    v_add_f32 v99, v99, v8
    v_cvt_pk_bf16_f32 v192, v92, v93
    v_cvt_pk_bf16_f32 v193, v94, v95
    v_cvt_pk_bf16_f32 v194, v96, v97
    v_cvt_pk_bf16_f32 v195, v98, v99
    buffer_store_dwordx4 v[188:191], v6, s[60:63], 0 offen
    buffer_store_dwordx4 v[192:195], v6, s[60:63], 0 offen offset:32
    s_endpgm
parallel_sum__softmax_full_mha__swiglu_ffn__prompt_kernel_gskip:
    s_endpgm
parallel_sum__softmax_full_mha__swiglu_ffn__prompt_kernel_done:
    s_endpgm
.section .rodata,"a"
.p2align 6
.amdhsa_kernel parallel_sum__softmax_full_mha__swiglu_ffn__prompt_kernel
.amdhsa_next_free_vgpr 256
.amdhsa_next_free_sgpr 100
.amdhsa_accum_offset 256
.amdhsa_group_segment_fixed_size 0
.amdhsa_kernarg_size 80
.amdhsa_user_sgpr_count 2
.amdhsa_user_sgpr_kernarg_segment_ptr 1
.amdhsa_system_sgpr_workgroup_id_x 1
.amdhsa_float_denorm_mode_32 3
.amdhsa_float_denorm_mode_16_64 3
.end_amdhsa_kernel
```
